```python
import torch

def _softmax(x, axis=-1):
    return torch.softmax(x, dim=axis)
def _gelu(x):
    return torch.nn.functional.gelu(x, approximate="tanh")
def _silu(x):
    return torch.nn.functional.silu(x)
def _sigmoid(x):
    return torch.sigmoid(x)
def _layernorm(x, axis=-1, eps=1e-5):
    m = x.mean(dim=axis, keepdim=True)
    v = x.var(dim=axis, keepdim=True, unbiased=False)
    return (x - m) / torch.sqrt(v + eps)
def _scatter_add(tgt, idx, src, axis=0):
    return tgt.clone().index_add_(axis, idx, src)
def _segment_sum(src, seg, n):
    out = torch.zeros((n,) + src.shape[1:], dtype=src.dtype)
    return out.index_add_(0, seg, src)
def _pad(x, pw):
    flat = tuple(v for pair in reversed(pw) for v in pair)
    return torch.nn.functional.pad(x, flat)

kernel_name = 'parallel_sum__grouped_kv_mqa__mixer_channel_mlp__prompt'

def setup_inputs():

    _w = (lambda a: (lambda t: t.to(torch.bfloat16) if t.is_floating_point() else t)(torch.as_tensor(a)))
    def _A_setup():
        B, S, D, H = 1, 2048, 576, 32
        Dh = D // H
        return {
            "x": _w((lambda *s: torch.randn(*s, dtype=torch.bfloat16) * 0.05)(B, S, D)),
            "wq": _w((lambda *s: torch.randn(*s, dtype=torch.bfloat16) * 0.05)(D, H * Dh)),
            "wk": _w((lambda *s: torch.randn(*s, dtype=torch.bfloat16) * 0.05)(D, Dh)),
            "wv": _w((lambda *s: torch.randn(*s, dtype=torch.bfloat16) * 0.05)(D, Dh)),
            "wo": _w((lambda *s: torch.randn(*s, dtype=torch.bfloat16) * 0.05)(H * Dh, D)),
        }
    _A_in = _A_setup()

    def _B_setup():
        B, S, D, F = 1, 2048, 576, 4608
        return {
            "x": _w((lambda *s: torch.randn(*s, dtype=torch.bfloat16) * 0.05)(B, S, D)),
            "w1": _w((lambda *s: torch.randn(*s, dtype=torch.bfloat16) * 3.2)(D, F) * (D ** -0.5)),
            "b1": _w((lambda *s: torch.randn(*s, dtype=torch.bfloat16) * 0.8)(F)),
            "w2": _w((lambda *s: torch.randn(*s, dtype=torch.bfloat16) * 0.1)(F, D) * (F ** -0.5)),
            "b2": _w((lambda *s: torch.randn(*s, dtype=torch.bfloat16) * 0.1)(D)),
        }
    _B_in = _B_setup()

    return {
        "A_x": _A_in["x"],
        "A_wq": _A_in["wq"],
        "A_wk": _A_in["wk"],
        "A_wv": _A_in["wv"],
        "A_wo": _A_in["wo"],
        "B_x": _B_in["x"],
        "B_w1": _B_in["w1"],
        "B_b1": _B_in["b1"],
        "B_w2": _B_in["w2"],
        "B_b2": _B_in["b2"],
    }

def reference(A_x, A_wq, A_wk, A_wv, A_wo, B_x, B_w1, B_b1, B_w2, B_b2):
    def _A_ref(x, wq, wk, wv, wo):
        B, S, D = x.shape
        H = 32
        Dh = D // H
        q = (lambda x, *d: x.permute(*d))((x @ wq).reshape(B, S, H, Dh), 0, 2, 1, 3)
        k = x @ wk
        v = x @ wv
        scores = torch.einsum("bhqd,bkd->bhqk", q, k) * (Dh ** -0.5)
        p = _softmax(scores, axis=-1)
        o = torch.einsum("bhqk,bkd->bhqd", p, v)
        return (lambda x, *d: x.permute(*d))(o, 0, 2, 1, 3).reshape(B, S, H * Dh) @ wo

    def _B_ref(x, w1, b1, w2, b2):
        y = _layernorm(x, axis=-1)
        h = _gelu(torch.einsum("bsd,df->bsf", y, w1) + b1)
        return torch.einsum("bsf,fd->bsd", h, w2) + b2

    x = A_x
    xn = _layernorm(x, axis=-1)
    return x + _A_ref(xn, A_wq, A_wk, A_wv, A_wo) + _B_ref(xn, B_w1, B_b1, B_w2, B_b2)
```

```asm
; @launch kernel=ln_kernel grid=(256,1,1) block=(256,1,1) lds=0
; @launch kernel=gemm1_kernel grid=(256,1,1) block=(768,1,1) lds=159744
; @launch kernel=gemm2_kernel grid=(256,1,1) block=(1024,1,1) lds=158720
; @launch kernel=final_kernel grid=(256,1,1) block=(256,1,1) lds=141312
.amdgcn_target "amdgcn-amd-amdhsa--gfx950"
.text
.globl ln_kernel
.p2align 8
.type ln_kernel,@function
ln_kernel:
  s_cmp_ge_u32 s2, 256
  s_cbranch_scc1 ln_kernel_done1
  s_load_dwordx2 s[4:5], s[0:1], 0
  s_load_dwordx2 s[8:9], s[0:1], 96
  s_load_dwordx2 s[12:13], s[0:1], 96
  s_load_dwordx2 s[16:17], s[0:1], 16
  s_load_dwordx2 s[20:21], s[0:1], 24
  s_load_dwordx2 s[24:25], s[0:1], 96
  s_load_dwordx2 s[32:33], s[0:1], 48
  s_load_dwordx2 s[36:37], s[0:1], 8
  s_waitcnt lgkmcnt(0)
  s_mov_b32 s6, 2359296
  s_mov_b32 s7, 0x00020000
  s_mov_b32 s10, 2359296
  s_mov_b32 s11, 0x00020000
  s_add_u32 s12, s12, 2359296
  s_addc_u32 s13, s13, 0
  s_mov_b32 s14, 2359296
  s_mov_b32 s15, 0x00020000
  s_mov_b32 s18, 20736
  s_mov_b32 s19, 0x00020000
  s_mov_b32 s22, 20736
  s_mov_b32 s23, 0x00020000
  s_add_u32 s24, s24, 9437184
  s_addc_u32 s25, s25, 0
  s_mov_b32 s26, 73728
  s_mov_b32 s27, 0x00020000
  s_mov_b32 s34, 5308416
  s_mov_b32 s35, 0x00020000
  s_mov_b32 s38, 663552
  s_mov_b32 s39, 0x00020000
  v_lshrrev_b32 v1, 5, v0
  s_lshl_b32 s3, s2, 3
  v_add_u32 v1, s3, v1
  s_movk_i32 s28, 1152
  v_mul_lo_u32 v1, v1, s28
  v_and_b32 v2, 31, v0
  v_lshl_add_u32 v1, v2, 2, v1
  buffer_load_dword v4, v1, s[4:7], 0 offen offset:0
  buffer_load_dword v5, v1, s[4:7], 0 offen offset:128
  buffer_load_dword v6, v1, s[4:7], 0 offen offset:256
  buffer_load_dword v7, v1, s[4:7], 0 offen offset:384
  buffer_load_dword v8, v1, s[4:7], 0 offen offset:512
  buffer_load_dword v9, v1, s[4:7], 0 offen offset:640
  buffer_load_dword v10, v1, s[4:7], 0 offen offset:768
  buffer_load_dword v11, v1, s[4:7], 0 offen offset:896
  buffer_load_dword v12, v1, s[4:7], 0 offen offset:1024
  s_cmp_ge_u32 s2, 144
  s_cbranch_scc1 ln_kernel_skipw2
  v_lshrrev_b32 v60, 6, v0
  s_lshl_b32 s3, s2, 2
  v_add_u32 v60, s3, v60
  v_and_b32 v61, 63, v0
  v_mul_u32_u24 v62, 36, v60
  v_lshl_add_u32 v63, v61, 1, v62
  v_mov_b32 v58, 0x80000000
  v_cmp_gt_u32 vcc, 18, v61
  s_nop 1
  v_cndmask_b32 v63, v58, v63, vcc
  v_subrev_u32 v59, 32, v61
  v_lshl_add_u32 v57, v59, 1, v62
  v_cmp_gt_u32 vcc, 18, v59
  s_nop 1
  v_cndmask_b32 v57, v58, v57, vcc
  buffer_load_ushort v56, v63, s[16:19], 0 offen
  buffer_load_ushort v55, v57, s[20:23], 0 offen
  v_lshlrev_b32 v60, 7, v60
  v_lshl_add_u32 v60, v61, 1, v60
  s_waitcnt vmcnt(0)
  v_or_b32 v56, v56, v55
  buffer_store_short v56, v60, s[24:27], 0 offen
ln_kernel_skipw2:
  s_waitcnt vmcnt(0)
  v_lshlrev_b32 v74, 4, v0
  s_lshl_b32 s3, s2, 12
  s_add_u32 s29, s3, 0
  buffer_load_dwordx4 v[76:79], v74, s[32:35], s29 offen
  s_add_u32 s29, s3, 1048576
  buffer_load_dwordx4 v[76:79], v74, s[32:35], s29 offen
  s_add_u32 s29, s3, 2097152
  buffer_load_dwordx4 v[76:79], v74, s[32:35], s29 offen
  s_add_u32 s29, s3, 3145728
  buffer_load_dwordx4 v[76:79], v74, s[32:35], s29 offen
  s_add_u32 s29, s3, 4194304
  buffer_load_dwordx4 v[76:79], v74, s[32:35], s29 offen
  s_add_u32 s29, s3, 5242880
  buffer_load_dwordx4 v[76:79], v74, s[32:35], s29 offen
  buffer_load_dwordx4 v[76:79], v74, s[36:39], s3 offen
  v_lshlrev_b32 v16, 16, v4
  v_and_b32 v17, 0xffff0000, v4
  v_lshlrev_b32 v18, 16, v5
  v_and_b32 v19, 0xffff0000, v5
  v_lshlrev_b32 v20, 16, v6
  v_and_b32 v21, 0xffff0000, v6
  v_lshlrev_b32 v22, 16, v7
  v_and_b32 v23, 0xffff0000, v7
  v_lshlrev_b32 v24, 16, v8
  v_and_b32 v25, 0xffff0000, v8
  v_lshlrev_b32 v26, 16, v9
  v_and_b32 v27, 0xffff0000, v9
  v_lshlrev_b32 v28, 16, v10
  v_and_b32 v29, 0xffff0000, v10
  v_lshlrev_b32 v30, 16, v11
  v_and_b32 v31, 0xffff0000, v11
  v_lshlrev_b32 v32, 16, v12
  v_and_b32 v33, 0xffff0000, v12
  v_add_f32 v40, v16, v17
  v_add_f32 v40, v40, v18
  v_add_f32 v40, v40, v19
  v_add_f32 v40, v40, v20
  v_add_f32 v40, v40, v21
  v_add_f32 v40, v40, v22
  v_add_f32 v40, v40, v23
  v_add_f32 v40, v40, v24
  v_add_f32 v40, v40, v25
  v_add_f32 v40, v40, v26
  v_add_f32 v40, v40, v27
  v_add_f32 v40, v40, v28
  v_add_f32 v40, v40, v29
  v_add_f32 v40, v40, v30
  v_add_f32 v40, v40, v31
  v_add_f32 v40, v40, v32
  v_add_f32 v40, v40, v33
  s_nop 1
  v_add_f32_dpp v41, v40, v40 quad_perm:[1,0,3,2] row_mask:0xf bank_mask:0xf
  v_mov_b32 v40, v41
  s_nop 1
  v_add_f32_dpp v41, v40, v40 quad_perm:[2,3,0,1] row_mask:0xf bank_mask:0xf
  v_mov_b32 v40, v41
  s_nop 1
  v_add_f32_dpp v41, v40, v40 row_half_mirror row_mask:0xf bank_mask:0xf
  v_mov_b32 v40, v41
  s_nop 1
  v_add_f32_dpp v41, v40, v40 row_mirror row_mask:0xf bank_mask:0xf
  v_mov_b32 v40, v41
  ds_swizzle_b32 v41, v40 offset:0x401F
  s_waitcnt lgkmcnt(0)
  v_add_f32 v40, v40, v41
  v_mul_f32 v40, 0x3ae38e39, v40
  v_sub_f32 v42, v16, v40
  v_mul_f32 v43, v42, v42
  v_sub_f32 v42, v17, v40
  v_fmac_f32 v43, v42, v42
  v_sub_f32 v42, v18, v40
  v_fmac_f32 v43, v42, v42
  v_sub_f32 v42, v19, v40
  v_fmac_f32 v43, v42, v42
  v_sub_f32 v42, v20, v40
  v_fmac_f32 v43, v42, v42
  v_sub_f32 v42, v21, v40
  v_fmac_f32 v43, v42, v42
  v_sub_f32 v42, v22, v40
  v_fmac_f32 v43, v42, v42
  v_sub_f32 v42, v23, v40
  v_fmac_f32 v43, v42, v42
  v_sub_f32 v42, v24, v40
  v_fmac_f32 v43, v42, v42
  v_sub_f32 v42, v25, v40
  v_fmac_f32 v43, v42, v42
  v_sub_f32 v42, v26, v40
  v_fmac_f32 v43, v42, v42
  v_sub_f32 v42, v27, v40
  v_fmac_f32 v43, v42, v42
  v_sub_f32 v42, v28, v40
  v_fmac_f32 v43, v42, v42
  v_sub_f32 v42, v29, v40
  v_fmac_f32 v43, v42, v42
  v_sub_f32 v42, v30, v40
  v_fmac_f32 v43, v42, v42
  v_sub_f32 v42, v31, v40
  v_fmac_f32 v43, v42, v42
  v_sub_f32 v42, v32, v40
  v_fmac_f32 v43, v42, v42
  v_sub_f32 v42, v33, v40
  v_fmac_f32 v43, v42, v42
  s_nop 1
  v_add_f32_dpp v41, v43, v43 quad_perm:[1,0,3,2] row_mask:0xf bank_mask:0xf
  v_mov_b32 v43, v41
  s_nop 1
  v_add_f32_dpp v41, v43, v43 quad_perm:[2,3,0,1] row_mask:0xf bank_mask:0xf
  v_mov_b32 v43, v41
  s_nop 1
  v_add_f32_dpp v41, v43, v43 row_half_mirror row_mask:0xf bank_mask:0xf
  v_mov_b32 v43, v41
  s_nop 1
  v_add_f32_dpp v41, v43, v43 row_mirror row_mask:0xf bank_mask:0xf
  v_mov_b32 v43, v41
  ds_swizzle_b32 v41, v43 offset:0x401F
  s_waitcnt lgkmcnt(0)
  v_add_f32 v43, v43, v41
  v_mul_f32 v43, 0x3ae38e39, v43
  v_cvt_pk_bf16_f32 v40, v40, v40
  v_lshlrev_b32 v40, 16, v40
  v_cvt_pk_bf16_f32 v43, v43, v43
  v_lshlrev_b32 v43, 16, v43
  v_add_f32 v43, 0x3727c5ac, v43
  v_cvt_pk_bf16_f32 v43, v43, v43
  v_lshlrev_b32 v43, 16, v43
  v_sqrt_f32 v43, v43
  s_nop 0
  v_cvt_pk_bf16_f32 v43, v43, v43
  v_lshlrev_b32 v43, 16, v43
  v_rcp_f32 v43, v43
  v_sub_f32 v44, v16, v40
  v_sub_f32 v45, v17, v40
  v_cvt_pk_bf16_f32 v44, v44, v45
  v_and_b32 v45, 0xffff0000, v44
  v_lshlrev_b32 v44, 16, v44
  v_mul_f32 v44, v44, v43
  v_mul_f32 v45, v45, v43
  v_cvt_pk_bf16_f32 v4, v44, v45
  v_sub_f32 v44, v18, v40
  v_sub_f32 v45, v19, v40
  v_cvt_pk_bf16_f32 v44, v44, v45
  v_and_b32 v45, 0xffff0000, v44
  v_lshlrev_b32 v44, 16, v44
  v_mul_f32 v44, v44, v43
  v_mul_f32 v45, v45, v43
  v_cvt_pk_bf16_f32 v5, v44, v45
  v_sub_f32 v44, v20, v40
  v_sub_f32 v45, v21, v40
  v_cvt_pk_bf16_f32 v44, v44, v45
  v_and_b32 v45, 0xffff0000, v44
  v_lshlrev_b32 v44, 16, v44
  v_mul_f32 v44, v44, v43
  v_mul_f32 v45, v45, v43
  v_cvt_pk_bf16_f32 v6, v44, v45
  v_sub_f32 v44, v22, v40
  v_sub_f32 v45, v23, v40
  v_cvt_pk_bf16_f32 v44, v44, v45
  v_and_b32 v45, 0xffff0000, v44
  v_lshlrev_b32 v44, 16, v44
  v_mul_f32 v44, v44, v43
  v_mul_f32 v45, v45, v43
  v_cvt_pk_bf16_f32 v7, v44, v45
  v_sub_f32 v44, v24, v40
  v_sub_f32 v45, v25, v40
  v_cvt_pk_bf16_f32 v44, v44, v45
  v_and_b32 v45, 0xffff0000, v44
  v_lshlrev_b32 v44, 16, v44
  v_mul_f32 v44, v44, v43
  v_mul_f32 v45, v45, v43
  v_cvt_pk_bf16_f32 v8, v44, v45
  v_sub_f32 v44, v26, v40
  v_sub_f32 v45, v27, v40
  v_cvt_pk_bf16_f32 v44, v44, v45
  v_and_b32 v45, 0xffff0000, v44
  v_lshlrev_b32 v44, 16, v44
  v_mul_f32 v44, v44, v43
  v_mul_f32 v45, v45, v43
  v_cvt_pk_bf16_f32 v9, v44, v45
  v_sub_f32 v44, v28, v40
  v_sub_f32 v45, v29, v40
  v_cvt_pk_bf16_f32 v44, v44, v45
  v_and_b32 v45, 0xffff0000, v44
  v_lshlrev_b32 v44, 16, v44
  v_mul_f32 v44, v44, v43
  v_mul_f32 v45, v45, v43
  v_cvt_pk_bf16_f32 v10, v44, v45
  v_sub_f32 v44, v30, v40
  v_sub_f32 v45, v31, v40
  v_cvt_pk_bf16_f32 v44, v44, v45
  v_and_b32 v45, 0xffff0000, v44
  v_lshlrev_b32 v44, 16, v44
  v_mul_f32 v44, v44, v43
  v_mul_f32 v45, v45, v43
  v_cvt_pk_bf16_f32 v11, v44, v45
  v_sub_f32 v44, v32, v40
  v_sub_f32 v45, v33, v40
  v_cvt_pk_bf16_f32 v44, v44, v45
  v_and_b32 v45, 0xffff0000, v44
  v_lshlrev_b32 v44, 16, v44
  v_mul_f32 v44, v44, v43
  v_mul_f32 v45, v45, v43
  v_cvt_pk_bf16_f32 v12, v44, v45
  buffer_store_dword v4, v1, s[8:11], 0 offen offset:0
  buffer_store_dword v5, v1, s[8:11], 0 offen offset:128
  buffer_store_dword v6, v1, s[8:11], 0 offen offset:256
  buffer_store_dword v7, v1, s[8:11], 0 offen offset:384
  buffer_store_dword v8, v1, s[8:11], 0 offen offset:512
  buffer_store_dword v9, v1, s[8:11], 0 offen offset:640
  buffer_store_dword v10, v1, s[8:11], 0 offen offset:768
  buffer_store_dword v11, v1, s[8:11], 0 offen offset:896
  buffer_store_dword v12, v1, s[8:11], 0 offen offset:1024
  v_lshlrev_b32 v16, 16, v4
  v_and_b32 v17, 0xffff0000, v4
  v_lshlrev_b32 v18, 16, v5
  v_and_b32 v19, 0xffff0000, v5
  v_lshlrev_b32 v20, 16, v6
  v_and_b32 v21, 0xffff0000, v6
  v_lshlrev_b32 v22, 16, v7
  v_and_b32 v23, 0xffff0000, v7
  v_lshlrev_b32 v24, 16, v8
  v_and_b32 v25, 0xffff0000, v8
  v_lshlrev_b32 v26, 16, v9
  v_and_b32 v27, 0xffff0000, v9
  v_lshlrev_b32 v28, 16, v10
  v_and_b32 v29, 0xffff0000, v10
  v_lshlrev_b32 v30, 16, v11
  v_and_b32 v31, 0xffff0000, v11
  v_lshlrev_b32 v32, 16, v12
  v_and_b32 v33, 0xffff0000, v12
  v_add_f32 v40, v16, v17
  v_add_f32 v40, v40, v18
  v_add_f32 v40, v40, v19
  v_add_f32 v40, v40, v20
  v_add_f32 v40, v40, v21
  v_add_f32 v40, v40, v22
  v_add_f32 v40, v40, v23
  v_add_f32 v40, v40, v24
  v_add_f32 v40, v40, v25
  v_add_f32 v40, v40, v26
  v_add_f32 v40, v40, v27
  v_add_f32 v40, v40, v28
  v_add_f32 v40, v40, v29
  v_add_f32 v40, v40, v30
  v_add_f32 v40, v40, v31
  v_add_f32 v40, v40, v32
  v_add_f32 v40, v40, v33
  s_nop 1
  v_add_f32_dpp v41, v40, v40 quad_perm:[1,0,3,2] row_mask:0xf bank_mask:0xf
  v_mov_b32 v40, v41
  s_nop 1
  v_add_f32_dpp v41, v40, v40 quad_perm:[2,3,0,1] row_mask:0xf bank_mask:0xf
  v_mov_b32 v40, v41
  s_nop 1
  v_add_f32_dpp v41, v40, v40 row_half_mirror row_mask:0xf bank_mask:0xf
  v_mov_b32 v40, v41
  s_nop 1
  v_add_f32_dpp v41, v40, v40 row_mirror row_mask:0xf bank_mask:0xf
  v_mov_b32 v40, v41
  ds_swizzle_b32 v41, v40 offset:0x401F
  s_waitcnt lgkmcnt(0)
  v_add_f32 v40, v40, v41
  v_mul_f32 v40, 0x3ae38e39, v40
  v_sub_f32 v42, v16, v40
  v_mul_f32 v43, v42, v42
  v_sub_f32 v42, v17, v40
  v_fmac_f32 v43, v42, v42
  v_sub_f32 v42, v18, v40
  v_fmac_f32 v43, v42, v42
  v_sub_f32 v42, v19, v40
  v_fmac_f32 v43, v42, v42
  v_sub_f32 v42, v20, v40
  v_fmac_f32 v43, v42, v42
  v_sub_f32 v42, v21, v40
  v_fmac_f32 v43, v42, v42
  v_sub_f32 v42, v22, v40
  v_fmac_f32 v43, v42, v42
  v_sub_f32 v42, v23, v40
  v_fmac_f32 v43, v42, v42
  v_sub_f32 v42, v24, v40
  v_fmac_f32 v43, v42, v42
  v_sub_f32 v42, v25, v40
  v_fmac_f32 v43, v42, v42
  v_sub_f32 v42, v26, v40
  v_fmac_f32 v43, v42, v42
  v_sub_f32 v42, v27, v40
  v_fmac_f32 v43, v42, v42
  v_sub_f32 v42, v28, v40
  v_fmac_f32 v43, v42, v42
  v_sub_f32 v42, v29, v40
  v_fmac_f32 v43, v42, v42
  v_sub_f32 v42, v30, v40
  v_fmac_f32 v43, v42, v42
  v_sub_f32 v42, v31, v40
  v_fmac_f32 v43, v42, v42
  v_sub_f32 v42, v32, v40
  v_fmac_f32 v43, v42, v42
  v_sub_f32 v42, v33, v40
  v_fmac_f32 v43, v42, v42
  s_nop 1
  v_add_f32_dpp v41, v43, v43 quad_perm:[1,0,3,2] row_mask:0xf bank_mask:0xf
  v_mov_b32 v43, v41
  s_nop 1
  v_add_f32_dpp v41, v43, v43 quad_perm:[2,3,0,1] row_mask:0xf bank_mask:0xf
  v_mov_b32 v43, v41
  s_nop 1
  v_add_f32_dpp v41, v43, v43 row_half_mirror row_mask:0xf bank_mask:0xf
  v_mov_b32 v43, v41
  s_nop 1
  v_add_f32_dpp v41, v43, v43 row_mirror row_mask:0xf bank_mask:0xf
  v_mov_b32 v43, v41
  ds_swizzle_b32 v41, v43 offset:0x401F
  s_waitcnt lgkmcnt(0)
  v_add_f32 v43, v43, v41
  v_mul_f32 v43, 0x3ae38e39, v43
  v_cvt_pk_bf16_f32 v40, v40, v40
  v_lshlrev_b32 v40, 16, v40
  v_cvt_pk_bf16_f32 v43, v43, v43
  v_lshlrev_b32 v43, 16, v43
  v_add_f32 v43, 0x3727c5ac, v43
  v_cvt_pk_bf16_f32 v43, v43, v43
  v_lshlrev_b32 v43, 16, v43
  v_sqrt_f32 v43, v43
  s_nop 0
  v_cvt_pk_bf16_f32 v43, v43, v43
  v_lshlrev_b32 v43, 16, v43
  v_rcp_f32 v43, v43
  v_sub_f32 v44, v16, v40
  v_sub_f32 v45, v17, v40
  v_cvt_pk_bf16_f32 v44, v44, v45
  v_and_b32 v45, 0xffff0000, v44
  v_lshlrev_b32 v44, 16, v44
  v_mul_f32 v44, v44, v43
  v_mul_f32 v45, v45, v43
  v_cvt_pk_bf16_f32 v64, v44, v45
  v_sub_f32 v44, v18, v40
  v_sub_f32 v45, v19, v40
  v_cvt_pk_bf16_f32 v44, v44, v45
  v_and_b32 v45, 0xffff0000, v44
  v_lshlrev_b32 v44, 16, v44
  v_mul_f32 v44, v44, v43
  v_mul_f32 v45, v45, v43
  v_cvt_pk_bf16_f32 v65, v44, v45
  v_sub_f32 v44, v20, v40
  v_sub_f32 v45, v21, v40
  v_cvt_pk_bf16_f32 v44, v44, v45
  v_and_b32 v45, 0xffff0000, v44
  v_lshlrev_b32 v44, 16, v44
  v_mul_f32 v44, v44, v43
  v_mul_f32 v45, v45, v43
  v_cvt_pk_bf16_f32 v66, v44, v45
  v_sub_f32 v44, v22, v40
  v_sub_f32 v45, v23, v40
  v_cvt_pk_bf16_f32 v44, v44, v45
  v_and_b32 v45, 0xffff0000, v44
  v_lshlrev_b32 v44, 16, v44
  v_mul_f32 v44, v44, v43
  v_mul_f32 v45, v45, v43
  v_cvt_pk_bf16_f32 v67, v44, v45
  v_sub_f32 v44, v24, v40
  v_sub_f32 v45, v25, v40
  v_cvt_pk_bf16_f32 v44, v44, v45
  v_and_b32 v45, 0xffff0000, v44
  v_lshlrev_b32 v44, 16, v44
  v_mul_f32 v44, v44, v43
  v_mul_f32 v45, v45, v43
  v_cvt_pk_bf16_f32 v68, v44, v45
  v_sub_f32 v44, v26, v40
  v_sub_f32 v45, v27, v40
  v_cvt_pk_bf16_f32 v44, v44, v45
  v_and_b32 v45, 0xffff0000, v44
  v_lshlrev_b32 v44, 16, v44
  v_mul_f32 v44, v44, v43
  v_mul_f32 v45, v45, v43
  v_cvt_pk_bf16_f32 v69, v44, v45
  v_sub_f32 v44, v28, v40
  v_sub_f32 v45, v29, v40
  v_cvt_pk_bf16_f32 v44, v44, v45
  v_and_b32 v45, 0xffff0000, v44
  v_lshlrev_b32 v44, 16, v44
  v_mul_f32 v44, v44, v43
  v_mul_f32 v45, v45, v43
  v_cvt_pk_bf16_f32 v70, v44, v45
  v_sub_f32 v44, v30, v40
  v_sub_f32 v45, v31, v40
  v_cvt_pk_bf16_f32 v44, v44, v45
  v_and_b32 v45, 0xffff0000, v44
  v_lshlrev_b32 v44, 16, v44
  v_mul_f32 v44, v44, v43
  v_mul_f32 v45, v45, v43
  v_cvt_pk_bf16_f32 v71, v44, v45
  v_sub_f32 v44, v32, v40
  v_sub_f32 v45, v33, v40
  v_cvt_pk_bf16_f32 v44, v44, v45
  v_and_b32 v45, 0xffff0000, v44
  v_lshlrev_b32 v44, 16, v44
  v_mul_f32 v44, v44, v43
  v_mul_f32 v45, v45, v43
  v_cvt_pk_bf16_f32 v72, v44, v45
  buffer_store_dword v64, v1, s[12:15], 0 offen offset:0
  buffer_store_dword v65, v1, s[12:15], 0 offen offset:128
  buffer_store_dword v66, v1, s[12:15], 0 offen offset:256
  buffer_store_dword v67, v1, s[12:15], 0 offen offset:384
  buffer_store_dword v68, v1, s[12:15], 0 offen offset:512
  buffer_store_dword v69, v1, s[12:15], 0 offen offset:640
  buffer_store_dword v70, v1, s[12:15], 0 offen offset:768
  buffer_store_dword v71, v1, s[12:15], 0 offen offset:896
  buffer_store_dword v72, v1, s[12:15], 0 offen offset:1024
ln_kernel_done1:
  s_endpgm
.globl gemm1_kernel
.p2align 8
.type gemm1_kernel,@function
gemm1_kernel:
  s_cmp_ge_u32 s2, 256
  s_cbranch_scc1 gemm1_kernel_done1
  v_lshrrev_b32 v1, 9, v0
  s_nop 0
  v_readfirstlane_b32 s3, v1
  s_nop 3
  s_cmp_lg_u32 s3, 0
  s_cbranch_scc1 gemm1_kernel_att2
  s_load_dwordx2 s[4:5], s[0:1], 96
  s_load_dwordx2 s[8:9], s[0:1], 48
  s_load_dwordx2 s[12:13], s[0:1], 96
  s_load_dwordx2 s[16:17], s[0:1], 56
  s_waitcnt lgkmcnt(0)
  s_add_u32 s4, s4, 2359296
  s_addc_u32 s5, s5, 0
  s_mov_b32 s6, 2359296
  s_mov_b32 s7, 0x00020000
  s_mov_b32 s10, 5308416
  s_mov_b32 s11, 0x00020000
  s_add_u32 s12, s12, 9723904
  s_addc_u32 s13, s13, 0
  s_mov_b32 s14, 18874368
  s_mov_b32 s15, 0x00020000
  s_mov_b32 s18, 9216
  s_mov_b32 s19, 0x00020000
  s_and_b32 s34, s2, 1
  s_lshl_b32 s34, s34, 2
  s_bfe_u32 s35, s2, 0x20003
  s_add_u32 s30, s34, s35
  s_bfe_u32 s34, s2, 0x20001
  s_lshl_b32 s34, s34, 3
  s_lshr_b32 s35, s2, 5
  s_add_u32 s31, s34, s35
  s_mul_i32 s32, s30, 294912
  s_mul_i32 s33, s31, 288
  v_lshrrev_b32 v119, 6, v0
  s_nop 0
  v_readfirstlane_b32 s40, v119
  v_and_b32 v120, 63, v0
  s_nop 2
  s_mov_b32 s41, s40
  s_mov_b32 s42, 0
  v_lshrrev_b32 v119, 3, v120
  s_mov_b32 s46, 1152
  v_mul_lo_u32 v119, v119, s46
  v_lshrrev_b32 v121, 4, v120
  v_and_b32 v122, 7, v120
  v_xor_b32 v121, v121, v122
  v_lshl_add_u32 v114, v121, 4, v119
  v_xor_b32 v121, 4, v121
  v_lshl_add_u32 v115, v121, 4, v119
  s_mul_i32 s43, s40, 36864
  s_add_u32 s43, s43, s32
  s_mul_i32 s44, s40, 4096
  s_lshl_b32 s45, s40, 10
  s_add_u32 s45, s45, 32768
  s_lshl_b32 s46, s40, 6
  s_add_u32 s46, s46, 0
  v_add_u32 v119, s46, v120
  s_mov_b32 s46, 1725
  v_mul_lo_u32 v121, v119, s46
  v_lshrrev_b32 v121, 18, v121
  v_mul_u32_u24 v122, 152, v121
  v_sub_u32 v119, v119, v122
  v_mul_u32_u24 v122, 57, v119
  v_lshrrev_b32 v122, 10, v122
  v_mul_u32_u24 v116, 18, v122
  v_sub_u32 v116, v119, v116
  v_lshlrev_b32 v116, 4, v116
  v_lshl_add_u32 v122, v121, 3, v122
  s_mov_b32 s46, 9216
  v_mul_lo_u32 v122, v122, s46
  v_add_u32 v116, v116, v122
  v_cmp_gt_u32 vcc, 144, v119
  v_cmp_gt_u32 s[48:49], 8, v121
  s_nop 1
  s_and_b64 vcc, vcc, s[48:49]
  v_mov_b32 v122, 0x80000000
  s_nop 1
  v_cndmask_b32 v116, v122, v116, vcc
  s_lshl_b32 s46, s40, 6
  s_add_u32 s46, s46, 512
  v_add_u32 v119, s46, v120
  s_mov_b32 s46, 1725
  v_mul_lo_u32 v121, v119, s46
  v_lshrrev_b32 v121, 18, v121
  v_mul_u32_u24 v122, 152, v121
  v_sub_u32 v119, v119, v122
  v_mul_u32_u24 v122, 57, v119
  v_lshrrev_b32 v122, 10, v122
  v_mul_u32_u24 v117, 18, v122
  v_sub_u32 v117, v119, v117
  v_lshlrev_b32 v117, 4, v117
  v_lshl_add_u32 v122, v121, 3, v122
  s_mov_b32 s46, 9216
  v_mul_lo_u32 v122, v122, s46
  v_add_u32 v117, v117, v122
  v_cmp_gt_u32 vcc, 144, v119
  v_cmp_gt_u32 s[48:49], 8, v121
  s_nop 1
  s_and_b64 vcc, vcc, s[48:49]
  v_mov_b32 v122, 0x80000000
  s_nop 1
  v_cndmask_b32 v117, v122, v117, vcc
  s_lshl_b32 s46, s40, 6
  s_add_u32 s46, s46, 1024
  v_add_u32 v119, s46, v120
  s_mov_b32 s46, 1725
  v_mul_lo_u32 v121, v119, s46
  v_lshrrev_b32 v121, 18, v121
  v_mul_u32_u24 v122, 152, v121
  v_sub_u32 v119, v119, v122
  v_mul_u32_u24 v122, 57, v119
  v_lshrrev_b32 v122, 10, v122
  v_mul_u32_u24 v118, 18, v122
  v_sub_u32 v118, v119, v118
  v_lshlrev_b32 v118, 4, v118
  v_lshl_add_u32 v122, v121, 3, v122
  s_mov_b32 s46, 9216
  v_mul_lo_u32 v122, v122, s46
  v_add_u32 v118, v118, v122
  v_cmp_gt_u32 vcc, 144, v119
  v_cmp_gt_u32 s[48:49], 8, v121
  s_nop 1
  s_and_b64 vcc, vcc, s[48:49]
  v_mov_b32 v122, 0x80000000
  s_nop 1
  v_cndmask_b32 v118, v122, v118, vcc
  v_bfe_u32 v119, v0, 4, 2
  v_lshlrev_b32 v119, 3, v119
  buffer_load_dwordx2 v[4:5], v119, s[16:19], s33 offen offset:0
  buffer_load_dwordx2 v[8:9], v119, s[16:19], s33 offen offset:32
  buffer_load_dwordx2 v[12:13], v119, s[16:19], s33 offen offset:64
  buffer_load_dwordx2 v[16:17], v119, s[16:19], s33 offen offset:96
  buffer_load_dwordx2 v[20:21], v119, s[16:19], s33 offen offset:128
  buffer_load_dwordx2 v[24:25], v119, s[16:19], s33 offen offset:160
  buffer_load_dwordx2 v[28:29], v119, s[16:19], s33 offen offset:192
  buffer_load_dwordx2 v[32:33], v119, s[16:19], s33 offen offset:224
  buffer_load_dwordx2 v[36:37], v119, s[16:19], s33 offen offset:256
  s_add_u32 m0, s44, 0
  s_add_u32 s46, s43, 0
  buffer_load_dwordx4 v114, s[4:7], s46 offen lds
  s_add_u32 m0, s44, 1024
  s_add_u32 s46, s43, 9216
  buffer_load_dwordx4 v115, s[4:7], s46 offen lds
  s_add_u32 m0, s44, 2048
  s_add_u32 s46, s43, 18432
  buffer_load_dwordx4 v114, s[4:7], s46 offen lds
  s_add_u32 m0, s44, 3072
  s_add_u32 s46, s43, 27648
  buffer_load_dwordx4 v115, s[4:7], s46 offen lds
  s_add_u32 m0, s45, 0
  s_add_u32 s46, s33, 0
  buffer_load_dwordx4 v116, s[8:11], s46 offen lds
  s_add_u32 m0, s45, 8192
  s_add_u32 s46, s33, 0
  buffer_load_dwordx4 v117, s[8:11], s46 offen lds
  s_cmp_ge_u32 s40, 3
  s_cbranch_scc1 gemm1_kernel_wsk3
  s_add_u32 m0, s45, 16384
  s_add_u32 s46, s33, 0
  buffer_load_dwordx4 v118, s[8:11], s46 offen lds
  gemm1_kernel_wsk3:
  v_and_b32 v119, 15, v120
  v_lshrrev_b32 v121, 4, v120
  v_lshrrev_b32 v122, 1, v119
  v_xor_b32 v122, v122, v121
  v_lshlrev_b32 v119, 7, v119
  v_lshl_add_u32 v108, v122, 4, v119
  s_mul_i32 s46, s41, 4096
  v_add_u32 v108, s46, v108
  v_xor_b32 v109, 64, v108
  v_bfe_u32 v119, v120, 2, 2
  v_lshl_add_u32 v119, v121, 3, v119
  v_mul_u32_u24 v119, 288, v119
  v_mul_u32_u24 v122, 128, v121
  v_add_u32 v119, v119, v122
  v_and_b32 v122, 3, v120
  v_lshl_add_u32 v112, v122, 3, v119
  s_mov_b32 s46, 32768
  v_add_u32 v112, s46, v112
  v_add_u32 v110, 52224, v108
  v_add_u32 v111, 52224, v109
  v_add_u32 v113, 52224, v112
  s_waitcnt vmcnt(6)
  v_and_b32 v7, 0xffff0000, v5
  v_lshlrev_b32 v6, 16, v5
  v_and_b32 v5, 0xffff0000, v4
  v_lshlrev_b32 v4, 16, v4
  v_and_b32 v11, 0xffff0000, v9
  v_lshlrev_b32 v10, 16, v9
  v_and_b32 v9, 0xffff0000, v8
  v_lshlrev_b32 v8, 16, v8
  v_and_b32 v15, 0xffff0000, v13
  v_lshlrev_b32 v14, 16, v13
  v_and_b32 v13, 0xffff0000, v12
  v_lshlrev_b32 v12, 16, v12
  v_and_b32 v19, 0xffff0000, v17
  v_lshlrev_b32 v18, 16, v17
  v_and_b32 v17, 0xffff0000, v16
  v_lshlrev_b32 v16, 16, v16
  v_and_b32 v23, 0xffff0000, v21
  v_lshlrev_b32 v22, 16, v21
  v_and_b32 v21, 0xffff0000, v20
  v_lshlrev_b32 v20, 16, v20
  v_and_b32 v27, 0xffff0000, v25
  v_lshlrev_b32 v26, 16, v25
  v_and_b32 v25, 0xffff0000, v24
  v_lshlrev_b32 v24, 16, v24
  v_and_b32 v31, 0xffff0000, v29
  v_lshlrev_b32 v30, 16, v29
  v_and_b32 v29, 0xffff0000, v28
  v_lshlrev_b32 v28, 16, v28
  v_and_b32 v35, 0xffff0000, v33
  v_lshlrev_b32 v34, 16, v33
  v_and_b32 v33, 0xffff0000, v32
  v_lshlrev_b32 v32, 16, v32
  v_and_b32 v39, 0xffff0000, v37
  v_lshlrev_b32 v38, 16, v37
  v_and_b32 v37, 0xffff0000, v36
  v_lshlrev_b32 v36, 16, v36
  v_mov_b32 v40, v4
  v_mov_b32 v41, v5
  v_mov_b32 v42, v6
  v_mov_b32 v43, v7
  v_mov_b32 v44, v8
  v_mov_b32 v45, v9
  v_mov_b32 v46, v10
  v_mov_b32 v47, v11
  v_mov_b32 v48, v12
  v_mov_b32 v49, v13
  v_mov_b32 v50, v14
  v_mov_b32 v51, v15
  v_mov_b32 v52, v16
  v_mov_b32 v53, v17
  v_mov_b32 v54, v18
  v_mov_b32 v55, v19
  v_mov_b32 v56, v20
  v_mov_b32 v57, v21
  v_mov_b32 v58, v22
  v_mov_b32 v59, v23
  v_mov_b32 v60, v24
  v_mov_b32 v61, v25
  v_mov_b32 v62, v26
  v_mov_b32 v63, v27
  v_mov_b32 v64, v28
  v_mov_b32 v65, v29
  v_mov_b32 v66, v30
  v_mov_b32 v67, v31
  v_mov_b32 v68, v32
  v_mov_b32 v69, v33
  v_mov_b32 v70, v34
  v_mov_b32 v71, v35
  v_mov_b32 v72, v36
  v_mov_b32 v73, v37
  v_mov_b32 v74, v38
  v_mov_b32 v75, v39
  s_waitcnt vmcnt(0)
  s_barrier
  ds_read_b64_tr_b16 v[92:93], v112 offset:0
  ds_read_b64_tr_b16 v[94:95], v112 offset:1152
  ds_read_b128 v[76:79], v108 offset:0
  ds_read_b128 v[80:83], v108 offset:2048
  ds_read_b64_tr_b16 v[96:97], v112 offset:32
  ds_read_b64_tr_b16 v[98:99], v112 offset:1184
  ds_read_b64_tr_b16 v[100:101], v112 offset:64
  ds_read_b64_tr_b16 v[102:103], v112 offset:1216
  ds_read_b64_tr_b16 v[104:105], v112 offset:96
  ds_read_b64_tr_b16 v[106:107], v112 offset:1248
  s_add_u32 m0, s44, 52224
  s_add_u32 s46, s43, 128
  buffer_load_dwordx4 v114, s[4:7], s46 offen lds
  s_waitcnt lgkmcnt(6)
  v_mfma_f32_16x16x32_bf16 v[4:7], v[92:95], v[76:79], v[4:7]
  v_mfma_f32_16x16x32_bf16 v[40:43], v[92:95], v[80:83], v[40:43]
  ds_read_b64_tr_b16 v[92:93], v112 offset:128
  ds_read_b64_tr_b16 v[94:95], v112 offset:1280
  s_add_u32 m0, s44, 53248
  s_add_u32 s46, s43, 9344
  buffer_load_dwordx4 v115, s[4:7], s46 offen lds
  s_waitcnt lgkmcnt(6)
  v_mfma_f32_16x16x32_bf16 v[8:11], v[96:99], v[76:79], v[8:11]
  v_mfma_f32_16x16x32_bf16 v[44:47], v[96:99], v[80:83], v[44:47]
  ds_read_b64_tr_b16 v[96:97], v112 offset:160
  ds_read_b64_tr_b16 v[98:99], v112 offset:1312
  ds_read_b128 v[84:87], v109 offset:0
  ds_read_b128 v[88:91], v109 offset:2048
  s_add_u32 m0, s44, 54272
  s_add_u32 s46, s43, 18560
  buffer_load_dwordx4 v114, s[4:7], s46 offen lds
  s_waitcnt lgkmcnt(8)
  v_mfma_f32_16x16x32_bf16 v[12:15], v[100:103], v[76:79], v[12:15]
  v_mfma_f32_16x16x32_bf16 v[48:51], v[100:103], v[80:83], v[48:51]
  ds_read_b64_tr_b16 v[100:101], v112 offset:192
  ds_read_b64_tr_b16 v[102:103], v112 offset:1344
  s_add_u32 m0, s44, 55296
  s_add_u32 s46, s43, 27776
  buffer_load_dwordx4 v115, s[4:7], s46 offen lds
  s_waitcnt lgkmcnt(8)
  v_mfma_f32_16x16x32_bf16 v[16:19], v[104:107], v[76:79], v[16:19]
  v_mfma_f32_16x16x32_bf16 v[52:55], v[104:107], v[80:83], v[52:55]
  ds_read_b64_tr_b16 v[104:105], v112 offset:224
  ds_read_b64_tr_b16 v[106:107], v112 offset:1376
  s_add_u32 m0, s45, 52224
  s_add_u32 s46, s33, 589824
  buffer_load_dwordx4 v116, s[8:11], s46 offen lds
  s_waitcnt lgkmcnt(8)
  v_mfma_f32_16x16x32_bf16 v[20:23], v[92:95], v[76:79], v[20:23]
  v_mfma_f32_16x16x32_bf16 v[56:59], v[92:95], v[80:83], v[56:59]
  ds_read_b64_tr_b16 v[92:93], v112 offset:256
  ds_read_b64_tr_b16 v[94:95], v112 offset:1408
  s_add_u32 m0, s45, 60416
  s_add_u32 s46, s33, 589824
  buffer_load_dwordx4 v117, s[8:11], s46 offen lds
  s_waitcnt lgkmcnt(8)
  v_mfma_f32_16x16x32_bf16 v[24:27], v[96:99], v[76:79], v[24:27]
  v_mfma_f32_16x16x32_bf16 v[60:63], v[96:99], v[80:83], v[60:63]
  ds_read_b64_tr_b16 v[96:97], v112 offset:9728
  ds_read_b64_tr_b16 v[98:99], v112 offset:10880
  s_cmp_ge_u32 s40, 3
  s_cbranch_scc1 gemm1_kernel_wsk4
  s_add_u32 m0, s45, 68608
  s_add_u32 s46, s33, 589824
  buffer_load_dwordx4 v118, s[8:11], s46 offen lds
  gemm1_kernel_wsk4:
  s_waitcnt lgkmcnt(6)
  v_mfma_f32_16x16x32_bf16 v[28:31], v[100:103], v[76:79], v[28:31]
  v_mfma_f32_16x16x32_bf16 v[64:67], v[100:103], v[80:83], v[64:67]
  ds_read_b64_tr_b16 v[100:101], v112 offset:9760
  ds_read_b64_tr_b16 v[102:103], v112 offset:10912
  s_waitcnt lgkmcnt(6)
  v_mfma_f32_16x16x32_bf16 v[32:35], v[104:107], v[76:79], v[32:35]
  v_mfma_f32_16x16x32_bf16 v[68:71], v[104:107], v[80:83], v[68:71]
  ds_read_b64_tr_b16 v[104:105], v112 offset:9792
  ds_read_b64_tr_b16 v[106:107], v112 offset:10944
  s_waitcnt lgkmcnt(6)
  v_mfma_f32_16x16x32_bf16 v[36:39], v[92:95], v[76:79], v[36:39]
  v_mfma_f32_16x16x32_bf16 v[72:75], v[92:95], v[80:83], v[72:75]
  ds_read_b64_tr_b16 v[92:93], v112 offset:9824
  ds_read_b64_tr_b16 v[94:95], v112 offset:10976
  s_waitcnt lgkmcnt(6)
  v_mfma_f32_16x16x32_bf16 v[4:7], v[96:99], v[84:87], v[4:7]
  v_mfma_f32_16x16x32_bf16 v[40:43], v[96:99], v[88:91], v[40:43]
  ds_read_b64_tr_b16 v[96:97], v112 offset:9856
  ds_read_b64_tr_b16 v[98:99], v112 offset:11008
  s_waitcnt lgkmcnt(6)
  v_mfma_f32_16x16x32_bf16 v[8:11], v[100:103], v[84:87], v[8:11]
  v_mfma_f32_16x16x32_bf16 v[44:47], v[100:103], v[88:91], v[44:47]
  ds_read_b64_tr_b16 v[100:101], v112 offset:9888
  ds_read_b64_tr_b16 v[102:103], v112 offset:11040
  s_waitcnt lgkmcnt(6)
  v_mfma_f32_16x16x32_bf16 v[12:15], v[104:107], v[84:87], v[12:15]
  v_mfma_f32_16x16x32_bf16 v[48:51], v[104:107], v[88:91], v[48:51]
  ds_read_b64_tr_b16 v[104:105], v112 offset:9920
  ds_read_b64_tr_b16 v[106:107], v112 offset:11072
  s_waitcnt lgkmcnt(6)
  v_mfma_f32_16x16x32_bf16 v[16:19], v[92:95], v[84:87], v[16:19]
  v_mfma_f32_16x16x32_bf16 v[52:55], v[92:95], v[88:91], v[52:55]
  ds_read_b64_tr_b16 v[92:93], v112 offset:9952
  ds_read_b64_tr_b16 v[94:95], v112 offset:11104
  s_waitcnt lgkmcnt(6)
  v_mfma_f32_16x16x32_bf16 v[20:23], v[96:99], v[84:87], v[20:23]
  v_mfma_f32_16x16x32_bf16 v[56:59], v[96:99], v[88:91], v[56:59]
  ds_read_b64_tr_b16 v[96:97], v112 offset:9984
  ds_read_b64_tr_b16 v[98:99], v112 offset:11136
  s_waitcnt lgkmcnt(6)
  v_mfma_f32_16x16x32_bf16 v[24:27], v[100:103], v[84:87], v[24:27]
  v_mfma_f32_16x16x32_bf16 v[60:63], v[100:103], v[88:91], v[60:63]
  s_waitcnt lgkmcnt(4)
  v_mfma_f32_16x16x32_bf16 v[28:31], v[104:107], v[84:87], v[28:31]
  v_mfma_f32_16x16x32_bf16 v[64:67], v[104:107], v[88:91], v[64:67]
  s_waitcnt lgkmcnt(2)
  v_mfma_f32_16x16x32_bf16 v[32:35], v[92:95], v[84:87], v[32:35]
  v_mfma_f32_16x16x32_bf16 v[68:71], v[92:95], v[88:91], v[68:71]
  s_waitcnt lgkmcnt(0)
  v_mfma_f32_16x16x32_bf16 v[36:39], v[96:99], v[84:87], v[36:39]
  v_mfma_f32_16x16x32_bf16 v[72:75], v[96:99], v[88:91], v[72:75]
  s_waitcnt vmcnt(0)
  s_barrier
  ds_read_b64_tr_b16 v[92:93], v113 offset:0
  ds_read_b64_tr_b16 v[94:95], v113 offset:1152
  ds_read_b128 v[76:79], v110 offset:0
  ds_read_b128 v[80:83], v110 offset:2048
  ds_read_b64_tr_b16 v[96:97], v113 offset:32
  ds_read_b64_tr_b16 v[98:99], v113 offset:1184
  ds_read_b64_tr_b16 v[100:101], v113 offset:64
  ds_read_b64_tr_b16 v[102:103], v113 offset:1216
  ds_read_b64_tr_b16 v[104:105], v113 offset:96
  ds_read_b64_tr_b16 v[106:107], v113 offset:1248
  s_add_u32 m0, s44, 0
  s_add_u32 s46, s43, 256
  buffer_load_dwordx4 v114, s[4:7], s46 offen lds
  s_waitcnt lgkmcnt(6)
  v_mfma_f32_16x16x32_bf16 v[4:7], v[92:95], v[76:79], v[4:7]
  v_mfma_f32_16x16x32_bf16 v[40:43], v[92:95], v[80:83], v[40:43]
  ds_read_b64_tr_b16 v[92:93], v113 offset:128
  ds_read_b64_tr_b16 v[94:95], v113 offset:1280
  s_add_u32 m0, s44, 1024
  s_add_u32 s46, s43, 9472
  buffer_load_dwordx4 v115, s[4:7], s46 offen lds
  s_waitcnt lgkmcnt(6)
  v_mfma_f32_16x16x32_bf16 v[8:11], v[96:99], v[76:79], v[8:11]
  v_mfma_f32_16x16x32_bf16 v[44:47], v[96:99], v[80:83], v[44:47]
  ds_read_b64_tr_b16 v[96:97], v113 offset:160
  ds_read_b64_tr_b16 v[98:99], v113 offset:1312
  ds_read_b128 v[84:87], v111 offset:0
  ds_read_b128 v[88:91], v111 offset:2048
  s_add_u32 m0, s44, 2048
  s_add_u32 s46, s43, 18688
  buffer_load_dwordx4 v114, s[4:7], s46 offen lds
  s_waitcnt lgkmcnt(8)
  v_mfma_f32_16x16x32_bf16 v[12:15], v[100:103], v[76:79], v[12:15]
  v_mfma_f32_16x16x32_bf16 v[48:51], v[100:103], v[80:83], v[48:51]
  ds_read_b64_tr_b16 v[100:101], v113 offset:192
  ds_read_b64_tr_b16 v[102:103], v113 offset:1344
  s_add_u32 m0, s44, 3072
  s_add_u32 s46, s43, 27904
  buffer_load_dwordx4 v115, s[4:7], s46 offen lds
  s_waitcnt lgkmcnt(8)
  v_mfma_f32_16x16x32_bf16 v[16:19], v[104:107], v[76:79], v[16:19]
  v_mfma_f32_16x16x32_bf16 v[52:55], v[104:107], v[80:83], v[52:55]
  ds_read_b64_tr_b16 v[104:105], v113 offset:224
  ds_read_b64_tr_b16 v[106:107], v113 offset:1376
  s_add_u32 m0, s45, 0
  s_add_u32 s46, s33, 1179648
  buffer_load_dwordx4 v116, s[8:11], s46 offen lds
  s_waitcnt lgkmcnt(8)
  v_mfma_f32_16x16x32_bf16 v[20:23], v[92:95], v[76:79], v[20:23]
  v_mfma_f32_16x16x32_bf16 v[56:59], v[92:95], v[80:83], v[56:59]
  ds_read_b64_tr_b16 v[92:93], v113 offset:256
  ds_read_b64_tr_b16 v[94:95], v113 offset:1408
  s_add_u32 m0, s45, 8192
  s_add_u32 s46, s33, 1179648
  buffer_load_dwordx4 v117, s[8:11], s46 offen lds
  s_waitcnt lgkmcnt(8)
  v_mfma_f32_16x16x32_bf16 v[24:27], v[96:99], v[76:79], v[24:27]
  v_mfma_f32_16x16x32_bf16 v[60:63], v[96:99], v[80:83], v[60:63]
  ds_read_b64_tr_b16 v[96:97], v113 offset:9728
  ds_read_b64_tr_b16 v[98:99], v113 offset:10880
  s_cmp_ge_u32 s40, 3
  s_cbranch_scc1 gemm1_kernel_wsk5
  s_add_u32 m0, s45, 16384
  s_add_u32 s46, s33, 1179648
  buffer_load_dwordx4 v118, s[8:11], s46 offen lds
  gemm1_kernel_wsk5:
  s_waitcnt lgkmcnt(6)
  v_mfma_f32_16x16x32_bf16 v[28:31], v[100:103], v[76:79], v[28:31]
  v_mfma_f32_16x16x32_bf16 v[64:67], v[100:103], v[80:83], v[64:67]
  ds_read_b64_tr_b16 v[100:101], v113 offset:9760
  ds_read_b64_tr_b16 v[102:103], v113 offset:10912
  s_waitcnt lgkmcnt(6)
  v_mfma_f32_16x16x32_bf16 v[32:35], v[104:107], v[76:79], v[32:35]
  v_mfma_f32_16x16x32_bf16 v[68:71], v[104:107], v[80:83], v[68:71]
  ds_read_b64_tr_b16 v[104:105], v113 offset:9792
  ds_read_b64_tr_b16 v[106:107], v113 offset:10944
  s_waitcnt lgkmcnt(6)
  v_mfma_f32_16x16x32_bf16 v[36:39], v[92:95], v[76:79], v[36:39]
  v_mfma_f32_16x16x32_bf16 v[72:75], v[92:95], v[80:83], v[72:75]
  ds_read_b64_tr_b16 v[92:93], v113 offset:9824
  ds_read_b64_tr_b16 v[94:95], v113 offset:10976
  s_waitcnt lgkmcnt(6)
  v_mfma_f32_16x16x32_bf16 v[4:7], v[96:99], v[84:87], v[4:7]
  v_mfma_f32_16x16x32_bf16 v[40:43], v[96:99], v[88:91], v[40:43]
  ds_read_b64_tr_b16 v[96:97], v113 offset:9856
  ds_read_b64_tr_b16 v[98:99], v113 offset:11008
  s_waitcnt lgkmcnt(6)
  v_mfma_f32_16x16x32_bf16 v[8:11], v[100:103], v[84:87], v[8:11]
  v_mfma_f32_16x16x32_bf16 v[44:47], v[100:103], v[88:91], v[44:47]
  ds_read_b64_tr_b16 v[100:101], v113 offset:9888
  ds_read_b64_tr_b16 v[102:103], v113 offset:11040
  s_waitcnt lgkmcnt(6)
  v_mfma_f32_16x16x32_bf16 v[12:15], v[104:107], v[84:87], v[12:15]
  v_mfma_f32_16x16x32_bf16 v[48:51], v[104:107], v[88:91], v[48:51]
  ds_read_b64_tr_b16 v[104:105], v113 offset:9920
  ds_read_b64_tr_b16 v[106:107], v113 offset:11072
  s_waitcnt lgkmcnt(6)
  v_mfma_f32_16x16x32_bf16 v[16:19], v[92:95], v[84:87], v[16:19]
  v_mfma_f32_16x16x32_bf16 v[52:55], v[92:95], v[88:91], v[52:55]
  ds_read_b64_tr_b16 v[92:93], v113 offset:9952
  ds_read_b64_tr_b16 v[94:95], v113 offset:11104
  s_waitcnt lgkmcnt(6)
  v_mfma_f32_16x16x32_bf16 v[20:23], v[96:99], v[84:87], v[20:23]
  v_mfma_f32_16x16x32_bf16 v[56:59], v[96:99], v[88:91], v[56:59]
  ds_read_b64_tr_b16 v[96:97], v113 offset:9984
  ds_read_b64_tr_b16 v[98:99], v113 offset:11136
  s_waitcnt lgkmcnt(6)
  v_mfma_f32_16x16x32_bf16 v[24:27], v[100:103], v[84:87], v[24:27]
  v_mfma_f32_16x16x32_bf16 v[60:63], v[100:103], v[88:91], v[60:63]
  s_waitcnt lgkmcnt(4)
  v_mfma_f32_16x16x32_bf16 v[28:31], v[104:107], v[84:87], v[28:31]
  v_mfma_f32_16x16x32_bf16 v[64:67], v[104:107], v[88:91], v[64:67]
  s_waitcnt lgkmcnt(2)
  v_mfma_f32_16x16x32_bf16 v[32:35], v[92:95], v[84:87], v[32:35]
  v_mfma_f32_16x16x32_bf16 v[68:71], v[92:95], v[88:91], v[68:71]
  s_waitcnt lgkmcnt(0)
  v_mfma_f32_16x16x32_bf16 v[36:39], v[96:99], v[84:87], v[36:39]
  v_mfma_f32_16x16x32_bf16 v[72:75], v[96:99], v[88:91], v[72:75]
  s_waitcnt vmcnt(0)
  s_barrier
  ds_read_b64_tr_b16 v[92:93], v112 offset:0
  ds_read_b64_tr_b16 v[94:95], v112 offset:1152
  ds_read_b128 v[76:79], v108 offset:0
  ds_read_b128 v[80:83], v108 offset:2048
  ds_read_b64_tr_b16 v[96:97], v112 offset:32
  ds_read_b64_tr_b16 v[98:99], v112 offset:1184
  ds_read_b64_tr_b16 v[100:101], v112 offset:64
  ds_read_b64_tr_b16 v[102:103], v112 offset:1216
  ds_read_b64_tr_b16 v[104:105], v112 offset:96
  ds_read_b64_tr_b16 v[106:107], v112 offset:1248
  s_add_u32 m0, s44, 52224
  s_add_u32 s46, s43, 384
  buffer_load_dwordx4 v114, s[4:7], s46 offen lds
  s_waitcnt lgkmcnt(6)
  v_mfma_f32_16x16x32_bf16 v[4:7], v[92:95], v[76:79], v[4:7]
  v_mfma_f32_16x16x32_bf16 v[40:43], v[92:95], v[80:83], v[40:43]
  ds_read_b64_tr_b16 v[92:93], v112 offset:128
  ds_read_b64_tr_b16 v[94:95], v112 offset:1280
  s_add_u32 m0, s44, 53248
  s_add_u32 s46, s43, 9600
  buffer_load_dwordx4 v115, s[4:7], s46 offen lds
  s_waitcnt lgkmcnt(6)
  v_mfma_f32_16x16x32_bf16 v[8:11], v[96:99], v[76:79], v[8:11]
  v_mfma_f32_16x16x32_bf16 v[44:47], v[96:99], v[80:83], v[44:47]
  ds_read_b64_tr_b16 v[96:97], v112 offset:160
  ds_read_b64_tr_b16 v[98:99], v112 offset:1312
  ds_read_b128 v[84:87], v109 offset:0
  ds_read_b128 v[88:91], v109 offset:2048
  s_add_u32 m0, s44, 54272
  s_add_u32 s46, s43, 18816
  buffer_load_dwordx4 v114, s[4:7], s46 offen lds
  s_waitcnt lgkmcnt(8)
  v_mfma_f32_16x16x32_bf16 v[12:15], v[100:103], v[76:79], v[12:15]
  v_mfma_f32_16x16x32_bf16 v[48:51], v[100:103], v[80:83], v[48:51]
  ds_read_b64_tr_b16 v[100:101], v112 offset:192
  ds_read_b64_tr_b16 v[102:103], v112 offset:1344
  s_add_u32 m0, s44, 55296
  s_add_u32 s46, s43, 28032
  buffer_load_dwordx4 v115, s[4:7], s46 offen lds
  s_waitcnt lgkmcnt(8)
  v_mfma_f32_16x16x32_bf16 v[16:19], v[104:107], v[76:79], v[16:19]
  v_mfma_f32_16x16x32_bf16 v[52:55], v[104:107], v[80:83], v[52:55]
  ds_read_b64_tr_b16 v[104:105], v112 offset:224
  ds_read_b64_tr_b16 v[106:107], v112 offset:1376
  s_add_u32 m0, s45, 52224
  s_add_u32 s46, s33, 1769472
  buffer_load_dwordx4 v116, s[8:11], s46 offen lds
  s_waitcnt lgkmcnt(8)
  v_mfma_f32_16x16x32_bf16 v[20:23], v[92:95], v[76:79], v[20:23]
  v_mfma_f32_16x16x32_bf16 v[56:59], v[92:95], v[80:83], v[56:59]
  ds_read_b64_tr_b16 v[92:93], v112 offset:256
  ds_read_b64_tr_b16 v[94:95], v112 offset:1408
  s_add_u32 m0, s45, 60416
  s_add_u32 s46, s33, 1769472
  buffer_load_dwordx4 v117, s[8:11], s46 offen lds
  s_waitcnt lgkmcnt(8)
  v_mfma_f32_16x16x32_bf16 v[24:27], v[96:99], v[76:79], v[24:27]
  v_mfma_f32_16x16x32_bf16 v[60:63], v[96:99], v[80:83], v[60:63]
  ds_read_b64_tr_b16 v[96:97], v112 offset:9728
  ds_read_b64_tr_b16 v[98:99], v112 offset:10880
  s_cmp_ge_u32 s40, 3
  s_cbranch_scc1 gemm1_kernel_wsk6
  s_add_u32 m0, s45, 68608
  s_add_u32 s46, s33, 1769472
  buffer_load_dwordx4 v118, s[8:11], s46 offen lds
  gemm1_kernel_wsk6:
  s_waitcnt lgkmcnt(6)
  v_mfma_f32_16x16x32_bf16 v[28:31], v[100:103], v[76:79], v[28:31]
  v_mfma_f32_16x16x32_bf16 v[64:67], v[100:103], v[80:83], v[64:67]
  ds_read_b64_tr_b16 v[100:101], v112 offset:9760
  ds_read_b64_tr_b16 v[102:103], v112 offset:10912
  s_waitcnt lgkmcnt(6)
  v_mfma_f32_16x16x32_bf16 v[32:35], v[104:107], v[76:79], v[32:35]
  v_mfma_f32_16x16x32_bf16 v[68:71], v[104:107], v[80:83], v[68:71]
  ds_read_b64_tr_b16 v[104:105], v112 offset:9792
  ds_read_b64_tr_b16 v[106:107], v112 offset:10944
  s_waitcnt lgkmcnt(6)
  v_mfma_f32_16x16x32_bf16 v[36:39], v[92:95], v[76:79], v[36:39]
  v_mfma_f32_16x16x32_bf16 v[72:75], v[92:95], v[80:83], v[72:75]
  ds_read_b64_tr_b16 v[92:93], v112 offset:9824
  ds_read_b64_tr_b16 v[94:95], v112 offset:10976
  s_waitcnt lgkmcnt(6)
  v_mfma_f32_16x16x32_bf16 v[4:7], v[96:99], v[84:87], v[4:7]
  v_mfma_f32_16x16x32_bf16 v[40:43], v[96:99], v[88:91], v[40:43]
  ds_read_b64_tr_b16 v[96:97], v112 offset:9856
  ds_read_b64_tr_b16 v[98:99], v112 offset:11008
  s_waitcnt lgkmcnt(6)
  v_mfma_f32_16x16x32_bf16 v[8:11], v[100:103], v[84:87], v[8:11]
  v_mfma_f32_16x16x32_bf16 v[44:47], v[100:103], v[88:91], v[44:47]
  ds_read_b64_tr_b16 v[100:101], v112 offset:9888
  ds_read_b64_tr_b16 v[102:103], v112 offset:11040
  s_waitcnt lgkmcnt(6)
  v_mfma_f32_16x16x32_bf16 v[12:15], v[104:107], v[84:87], v[12:15]
  v_mfma_f32_16x16x32_bf16 v[48:51], v[104:107], v[88:91], v[48:51]
  ds_read_b64_tr_b16 v[104:105], v112 offset:9920
  ds_read_b64_tr_b16 v[106:107], v112 offset:11072
  s_waitcnt lgkmcnt(6)
  v_mfma_f32_16x16x32_bf16 v[16:19], v[92:95], v[84:87], v[16:19]
  v_mfma_f32_16x16x32_bf16 v[52:55], v[92:95], v[88:91], v[52:55]
  ds_read_b64_tr_b16 v[92:93], v112 offset:9952
  ds_read_b64_tr_b16 v[94:95], v112 offset:11104
  s_waitcnt lgkmcnt(6)
  v_mfma_f32_16x16x32_bf16 v[20:23], v[96:99], v[84:87], v[20:23]
  v_mfma_f32_16x16x32_bf16 v[56:59], v[96:99], v[88:91], v[56:59]
  ds_read_b64_tr_b16 v[96:97], v112 offset:9984
  ds_read_b64_tr_b16 v[98:99], v112 offset:11136
  s_waitcnt lgkmcnt(6)
  v_mfma_f32_16x16x32_bf16 v[24:27], v[100:103], v[84:87], v[24:27]
  v_mfma_f32_16x16x32_bf16 v[60:63], v[100:103], v[88:91], v[60:63]
  s_waitcnt lgkmcnt(4)
  v_mfma_f32_16x16x32_bf16 v[28:31], v[104:107], v[84:87], v[28:31]
  v_mfma_f32_16x16x32_bf16 v[64:67], v[104:107], v[88:91], v[64:67]
  s_waitcnt lgkmcnt(2)
  v_mfma_f32_16x16x32_bf16 v[32:35], v[92:95], v[84:87], v[32:35]
  v_mfma_f32_16x16x32_bf16 v[68:71], v[92:95], v[88:91], v[68:71]
  s_waitcnt lgkmcnt(0)
  v_mfma_f32_16x16x32_bf16 v[36:39], v[96:99], v[84:87], v[36:39]
  v_mfma_f32_16x16x32_bf16 v[72:75], v[96:99], v[88:91], v[72:75]
  s_waitcnt vmcnt(0)
  s_barrier
  ds_read_b64_tr_b16 v[92:93], v113 offset:0
  ds_read_b64_tr_b16 v[94:95], v113 offset:1152
  ds_read_b128 v[76:79], v110 offset:0
  ds_read_b128 v[80:83], v110 offset:2048
  ds_read_b64_tr_b16 v[96:97], v113 offset:32
  ds_read_b64_tr_b16 v[98:99], v113 offset:1184
  ds_read_b64_tr_b16 v[100:101], v113 offset:64
  ds_read_b64_tr_b16 v[102:103], v113 offset:1216
  ds_read_b64_tr_b16 v[104:105], v113 offset:96
  ds_read_b64_tr_b16 v[106:107], v113 offset:1248
  s_add_u32 m0, s44, 0
  s_add_u32 s46, s43, 512
  buffer_load_dwordx4 v114, s[4:7], s46 offen lds
  s_waitcnt lgkmcnt(6)
  v_mfma_f32_16x16x32_bf16 v[4:7], v[92:95], v[76:79], v[4:7]
  v_mfma_f32_16x16x32_bf16 v[40:43], v[92:95], v[80:83], v[40:43]
  ds_read_b64_tr_b16 v[92:93], v113 offset:128
  ds_read_b64_tr_b16 v[94:95], v113 offset:1280
  s_add_u32 m0, s44, 1024
  s_add_u32 s46, s43, 9728
  buffer_load_dwordx4 v115, s[4:7], s46 offen lds
  s_waitcnt lgkmcnt(6)
  v_mfma_f32_16x16x32_bf16 v[8:11], v[96:99], v[76:79], v[8:11]
  v_mfma_f32_16x16x32_bf16 v[44:47], v[96:99], v[80:83], v[44:47]
  ds_read_b64_tr_b16 v[96:97], v113 offset:160
  ds_read_b64_tr_b16 v[98:99], v113 offset:1312
  ds_read_b128 v[84:87], v111 offset:0
  ds_read_b128 v[88:91], v111 offset:2048
  s_add_u32 m0, s44, 2048
  s_add_u32 s46, s43, 18944
  buffer_load_dwordx4 v114, s[4:7], s46 offen lds
  s_waitcnt lgkmcnt(8)
  v_mfma_f32_16x16x32_bf16 v[12:15], v[100:103], v[76:79], v[12:15]
  v_mfma_f32_16x16x32_bf16 v[48:51], v[100:103], v[80:83], v[48:51]
  ds_read_b64_tr_b16 v[100:101], v113 offset:192
  ds_read_b64_tr_b16 v[102:103], v113 offset:1344
  s_add_u32 m0, s44, 3072
  s_add_u32 s46, s43, 28160
  buffer_load_dwordx4 v115, s[4:7], s46 offen lds
  s_waitcnt lgkmcnt(8)
  v_mfma_f32_16x16x32_bf16 v[16:19], v[104:107], v[76:79], v[16:19]
  v_mfma_f32_16x16x32_bf16 v[52:55], v[104:107], v[80:83], v[52:55]
  ds_read_b64_tr_b16 v[104:105], v113 offset:224
  ds_read_b64_tr_b16 v[106:107], v113 offset:1376
  s_add_u32 m0, s45, 0
  s_add_u32 s46, s33, 2359296
  buffer_load_dwordx4 v116, s[8:11], s46 offen lds
  s_waitcnt lgkmcnt(8)
  v_mfma_f32_16x16x32_bf16 v[20:23], v[92:95], v[76:79], v[20:23]
  v_mfma_f32_16x16x32_bf16 v[56:59], v[92:95], v[80:83], v[56:59]
  ds_read_b64_tr_b16 v[92:93], v113 offset:256
  ds_read_b64_tr_b16 v[94:95], v113 offset:1408
  s_add_u32 m0, s45, 8192
  s_add_u32 s46, s33, 2359296
  buffer_load_dwordx4 v117, s[8:11], s46 offen lds
  s_waitcnt lgkmcnt(8)
  v_mfma_f32_16x16x32_bf16 v[24:27], v[96:99], v[76:79], v[24:27]
  v_mfma_f32_16x16x32_bf16 v[60:63], v[96:99], v[80:83], v[60:63]
  ds_read_b64_tr_b16 v[96:97], v113 offset:9728
  ds_read_b64_tr_b16 v[98:99], v113 offset:10880
  s_cmp_ge_u32 s40, 3
  s_cbranch_scc1 gemm1_kernel_wsk7
  s_add_u32 m0, s45, 16384
  s_add_u32 s46, s33, 2359296
  buffer_load_dwordx4 v118, s[8:11], s46 offen lds
  gemm1_kernel_wsk7:
  s_waitcnt lgkmcnt(6)
  v_mfma_f32_16x16x32_bf16 v[28:31], v[100:103], v[76:79], v[28:31]
  v_mfma_f32_16x16x32_bf16 v[64:67], v[100:103], v[80:83], v[64:67]
  ds_read_b64_tr_b16 v[100:101], v113 offset:9760
  ds_read_b64_tr_b16 v[102:103], v113 offset:10912
  s_waitcnt lgkmcnt(6)
  v_mfma_f32_16x16x32_bf16 v[32:35], v[104:107], v[76:79], v[32:35]
  v_mfma_f32_16x16x32_bf16 v[68:71], v[104:107], v[80:83], v[68:71]
  ds_read_b64_tr_b16 v[104:105], v113 offset:9792
  ds_read_b64_tr_b16 v[106:107], v113 offset:10944
  s_waitcnt lgkmcnt(6)
  v_mfma_f32_16x16x32_bf16 v[36:39], v[92:95], v[76:79], v[36:39]
  v_mfma_f32_16x16x32_bf16 v[72:75], v[92:95], v[80:83], v[72:75]
  ds_read_b64_tr_b16 v[92:93], v113 offset:9824
  ds_read_b64_tr_b16 v[94:95], v113 offset:10976
  s_waitcnt lgkmcnt(6)
  v_mfma_f32_16x16x32_bf16 v[4:7], v[96:99], v[84:87], v[4:7]
  v_mfma_f32_16x16x32_bf16 v[40:43], v[96:99], v[88:91], v[40:43]
  ds_read_b64_tr_b16 v[96:97], v113 offset:9856
  ds_read_b64_tr_b16 v[98:99], v113 offset:11008
  s_waitcnt lgkmcnt(6)
  v_mfma_f32_16x16x32_bf16 v[8:11], v[100:103], v[84:87], v[8:11]
  v_mfma_f32_16x16x32_bf16 v[44:47], v[100:103], v[88:91], v[44:47]
  ds_read_b64_tr_b16 v[100:101], v113 offset:9888
  ds_read_b64_tr_b16 v[102:103], v113 offset:11040
  s_waitcnt lgkmcnt(6)
  v_mfma_f32_16x16x32_bf16 v[12:15], v[104:107], v[84:87], v[12:15]
  v_mfma_f32_16x16x32_bf16 v[48:51], v[104:107], v[88:91], v[48:51]
  ds_read_b64_tr_b16 v[104:105], v113 offset:9920
  ds_read_b64_tr_b16 v[106:107], v113 offset:11072
  s_waitcnt lgkmcnt(6)
  v_mfma_f32_16x16x32_bf16 v[16:19], v[92:95], v[84:87], v[16:19]
  v_mfma_f32_16x16x32_bf16 v[52:55], v[92:95], v[88:91], v[52:55]
  ds_read_b64_tr_b16 v[92:93], v113 offset:9952
  ds_read_b64_tr_b16 v[94:95], v113 offset:11104
  s_waitcnt lgkmcnt(6)
  v_mfma_f32_16x16x32_bf16 v[20:23], v[96:99], v[84:87], v[20:23]
  v_mfma_f32_16x16x32_bf16 v[56:59], v[96:99], v[88:91], v[56:59]
  ds_read_b64_tr_b16 v[96:97], v113 offset:9984
  ds_read_b64_tr_b16 v[98:99], v113 offset:11136
  s_waitcnt lgkmcnt(6)
  v_mfma_f32_16x16x32_bf16 v[24:27], v[100:103], v[84:87], v[24:27]
  v_mfma_f32_16x16x32_bf16 v[60:63], v[100:103], v[88:91], v[60:63]
  s_waitcnt lgkmcnt(4)
  v_mfma_f32_16x16x32_bf16 v[28:31], v[104:107], v[84:87], v[28:31]
  v_mfma_f32_16x16x32_bf16 v[64:67], v[104:107], v[88:91], v[64:67]
  s_waitcnt lgkmcnt(2)
  v_mfma_f32_16x16x32_bf16 v[32:35], v[92:95], v[84:87], v[32:35]
  v_mfma_f32_16x16x32_bf16 v[68:71], v[92:95], v[88:91], v[68:71]
  s_waitcnt lgkmcnt(0)
  v_mfma_f32_16x16x32_bf16 v[36:39], v[96:99], v[84:87], v[36:39]
  v_mfma_f32_16x16x32_bf16 v[72:75], v[96:99], v[88:91], v[72:75]
  s_waitcnt vmcnt(0)
  s_barrier
  ds_read_b64_tr_b16 v[92:93], v112 offset:0
  ds_read_b64_tr_b16 v[94:95], v112 offset:1152
  ds_read_b128 v[76:79], v108 offset:0
  ds_read_b128 v[80:83], v108 offset:2048
  ds_read_b64_tr_b16 v[96:97], v112 offset:32
  ds_read_b64_tr_b16 v[98:99], v112 offset:1184
  ds_read_b64_tr_b16 v[100:101], v112 offset:64
  ds_read_b64_tr_b16 v[102:103], v112 offset:1216
  ds_read_b64_tr_b16 v[104:105], v112 offset:96
  ds_read_b64_tr_b16 v[106:107], v112 offset:1248
  s_add_u32 m0, s44, 52224
  s_add_u32 s46, s43, 640
  buffer_load_dwordx4 v114, s[4:7], s46 offen lds
  s_waitcnt lgkmcnt(6)
  v_mfma_f32_16x16x32_bf16 v[4:7], v[92:95], v[76:79], v[4:7]
  v_mfma_f32_16x16x32_bf16 v[40:43], v[92:95], v[80:83], v[40:43]
  ds_read_b64_tr_b16 v[92:93], v112 offset:128
  ds_read_b64_tr_b16 v[94:95], v112 offset:1280
  s_add_u32 m0, s44, 53248
  s_add_u32 s46, s43, 9856
  buffer_load_dwordx4 v115, s[4:7], s46 offen lds
  s_waitcnt lgkmcnt(6)
  v_mfma_f32_16x16x32_bf16 v[8:11], v[96:99], v[76:79], v[8:11]
  v_mfma_f32_16x16x32_bf16 v[44:47], v[96:99], v[80:83], v[44:47]
  ds_read_b64_tr_b16 v[96:97], v112 offset:160
  ds_read_b64_tr_b16 v[98:99], v112 offset:1312
  ds_read_b128 v[84:87], v109 offset:0
  ds_read_b128 v[88:91], v109 offset:2048
  s_add_u32 m0, s44, 54272
  s_add_u32 s46, s43, 19072
  buffer_load_dwordx4 v114, s[4:7], s46 offen lds
  s_waitcnt lgkmcnt(8)
  v_mfma_f32_16x16x32_bf16 v[12:15], v[100:103], v[76:79], v[12:15]
  v_mfma_f32_16x16x32_bf16 v[48:51], v[100:103], v[80:83], v[48:51]
  ds_read_b64_tr_b16 v[100:101], v112 offset:192
  ds_read_b64_tr_b16 v[102:103], v112 offset:1344
  s_add_u32 m0, s44, 55296
  s_add_u32 s46, s43, 28288
  buffer_load_dwordx4 v115, s[4:7], s46 offen lds
  s_waitcnt lgkmcnt(8)
  v_mfma_f32_16x16x32_bf16 v[16:19], v[104:107], v[76:79], v[16:19]
  v_mfma_f32_16x16x32_bf16 v[52:55], v[104:107], v[80:83], v[52:55]
  ds_read_b64_tr_b16 v[104:105], v112 offset:224
  ds_read_b64_tr_b16 v[106:107], v112 offset:1376
  s_add_u32 m0, s45, 52224
  s_add_u32 s46, s33, 2949120
  buffer_load_dwordx4 v116, s[8:11], s46 offen lds
  s_waitcnt lgkmcnt(8)
  v_mfma_f32_16x16x32_bf16 v[20:23], v[92:95], v[76:79], v[20:23]
  v_mfma_f32_16x16x32_bf16 v[56:59], v[92:95], v[80:83], v[56:59]
  ds_read_b64_tr_b16 v[92:93], v112 offset:256
  ds_read_b64_tr_b16 v[94:95], v112 offset:1408
  s_add_u32 m0, s45, 60416
  s_add_u32 s46, s33, 2949120
  buffer_load_dwordx4 v117, s[8:11], s46 offen lds
  s_waitcnt lgkmcnt(8)
  v_mfma_f32_16x16x32_bf16 v[24:27], v[96:99], v[76:79], v[24:27]
  v_mfma_f32_16x16x32_bf16 v[60:63], v[96:99], v[80:83], v[60:63]
  ds_read_b64_tr_b16 v[96:97], v112 offset:9728
  ds_read_b64_tr_b16 v[98:99], v112 offset:10880
  s_cmp_ge_u32 s40, 3
  s_cbranch_scc1 gemm1_kernel_wsk8
  s_add_u32 m0, s45, 68608
  s_add_u32 s46, s33, 2949120
  buffer_load_dwordx4 v118, s[8:11], s46 offen lds
  gemm1_kernel_wsk8:
  s_waitcnt lgkmcnt(6)
  v_mfma_f32_16x16x32_bf16 v[28:31], v[100:103], v[76:79], v[28:31]
  v_mfma_f32_16x16x32_bf16 v[64:67], v[100:103], v[80:83], v[64:67]
  ds_read_b64_tr_b16 v[100:101], v112 offset:9760
  ds_read_b64_tr_b16 v[102:103], v112 offset:10912
  s_waitcnt lgkmcnt(6)
  v_mfma_f32_16x16x32_bf16 v[32:35], v[104:107], v[76:79], v[32:35]
  v_mfma_f32_16x16x32_bf16 v[68:71], v[104:107], v[80:83], v[68:71]
  ds_read_b64_tr_b16 v[104:105], v112 offset:9792
  ds_read_b64_tr_b16 v[106:107], v112 offset:10944
  s_waitcnt lgkmcnt(6)
  v_mfma_f32_16x16x32_bf16 v[36:39], v[92:95], v[76:79], v[36:39]
  v_mfma_f32_16x16x32_bf16 v[72:75], v[92:95], v[80:83], v[72:75]
  ds_read_b64_tr_b16 v[92:93], v112 offset:9824
  ds_read_b64_tr_b16 v[94:95], v112 offset:10976
  s_waitcnt lgkmcnt(6)
  v_mfma_f32_16x16x32_bf16 v[4:7], v[96:99], v[84:87], v[4:7]
  v_mfma_f32_16x16x32_bf16 v[40:43], v[96:99], v[88:91], v[40:43]
  ds_read_b64_tr_b16 v[96:97], v112 offset:9856
  ds_read_b64_tr_b16 v[98:99], v112 offset:11008
  s_waitcnt lgkmcnt(6)
  v_mfma_f32_16x16x32_bf16 v[8:11], v[100:103], v[84:87], v[8:11]
  v_mfma_f32_16x16x32_bf16 v[44:47], v[100:103], v[88:91], v[44:47]
  ds_read_b64_tr_b16 v[100:101], v112 offset:9888
  ds_read_b64_tr_b16 v[102:103], v112 offset:11040
  s_waitcnt lgkmcnt(6)
  v_mfma_f32_16x16x32_bf16 v[12:15], v[104:107], v[84:87], v[12:15]
  v_mfma_f32_16x16x32_bf16 v[48:51], v[104:107], v[88:91], v[48:51]
  ds_read_b64_tr_b16 v[104:105], v112 offset:9920
  ds_read_b64_tr_b16 v[106:107], v112 offset:11072
  s_waitcnt lgkmcnt(6)
  v_mfma_f32_16x16x32_bf16 v[16:19], v[92:95], v[84:87], v[16:19]
  v_mfma_f32_16x16x32_bf16 v[52:55], v[92:95], v[88:91], v[52:55]
  ds_read_b64_tr_b16 v[92:93], v112 offset:9952
  ds_read_b64_tr_b16 v[94:95], v112 offset:11104
  s_waitcnt lgkmcnt(6)
  v_mfma_f32_16x16x32_bf16 v[20:23], v[96:99], v[84:87], v[20:23]
  v_mfma_f32_16x16x32_bf16 v[56:59], v[96:99], v[88:91], v[56:59]
  ds_read_b64_tr_b16 v[96:97], v112 offset:9984
  ds_read_b64_tr_b16 v[98:99], v112 offset:11136
  s_waitcnt lgkmcnt(6)
  v_mfma_f32_16x16x32_bf16 v[24:27], v[100:103], v[84:87], v[24:27]
  v_mfma_f32_16x16x32_bf16 v[60:63], v[100:103], v[88:91], v[60:63]
  s_waitcnt lgkmcnt(4)
  v_mfma_f32_16x16x32_bf16 v[28:31], v[104:107], v[84:87], v[28:31]
  v_mfma_f32_16x16x32_bf16 v[64:67], v[104:107], v[88:91], v[64:67]
  s_waitcnt lgkmcnt(2)
  v_mfma_f32_16x16x32_bf16 v[32:35], v[92:95], v[84:87], v[32:35]
  v_mfma_f32_16x16x32_bf16 v[68:71], v[92:95], v[88:91], v[68:71]
  s_waitcnt lgkmcnt(0)
  v_mfma_f32_16x16x32_bf16 v[36:39], v[96:99], v[84:87], v[36:39]
  v_mfma_f32_16x16x32_bf16 v[72:75], v[96:99], v[88:91], v[72:75]
  s_waitcnt vmcnt(0)
  s_barrier
  ds_read_b64_tr_b16 v[92:93], v113 offset:0
  ds_read_b64_tr_b16 v[94:95], v113 offset:1152
  ds_read_b128 v[76:79], v110 offset:0
  ds_read_b128 v[80:83], v110 offset:2048
  ds_read_b64_tr_b16 v[96:97], v113 offset:32
  ds_read_b64_tr_b16 v[98:99], v113 offset:1184
  ds_read_b64_tr_b16 v[100:101], v113 offset:64
  ds_read_b64_tr_b16 v[102:103], v113 offset:1216
  ds_read_b64_tr_b16 v[104:105], v113 offset:96
  ds_read_b64_tr_b16 v[106:107], v113 offset:1248
  s_add_u32 m0, s44, 0
  s_add_u32 s46, s43, 768
  buffer_load_dwordx4 v114, s[4:7], s46 offen lds
  s_waitcnt lgkmcnt(6)
  v_mfma_f32_16x16x32_bf16 v[4:7], v[92:95], v[76:79], v[4:7]
  v_mfma_f32_16x16x32_bf16 v[40:43], v[92:95], v[80:83], v[40:43]
  ds_read_b64_tr_b16 v[92:93], v113 offset:128
  ds_read_b64_tr_b16 v[94:95], v113 offset:1280
  s_add_u32 m0, s44, 1024
  s_add_u32 s46, s43, 9984
  buffer_load_dwordx4 v115, s[4:7], s46 offen lds
  s_waitcnt lgkmcnt(6)
  v_mfma_f32_16x16x32_bf16 v[8:11], v[96:99], v[76:79], v[8:11]
  v_mfma_f32_16x16x32_bf16 v[44:47], v[96:99], v[80:83], v[44:47]
  ds_read_b64_tr_b16 v[96:97], v113 offset:160
  ds_read_b64_tr_b16 v[98:99], v113 offset:1312
  ds_read_b128 v[84:87], v111 offset:0
  ds_read_b128 v[88:91], v111 offset:2048
  s_add_u32 m0, s44, 2048
  s_add_u32 s46, s43, 19200
  buffer_load_dwordx4 v114, s[4:7], s46 offen lds
  s_waitcnt lgkmcnt(8)
  v_mfma_f32_16x16x32_bf16 v[12:15], v[100:103], v[76:79], v[12:15]
  v_mfma_f32_16x16x32_bf16 v[48:51], v[100:103], v[80:83], v[48:51]
  ds_read_b64_tr_b16 v[100:101], v113 offset:192
  ds_read_b64_tr_b16 v[102:103], v113 offset:1344
  s_add_u32 m0, s44, 3072
  s_add_u32 s46, s43, 28416
  buffer_load_dwordx4 v115, s[4:7], s46 offen lds
  s_waitcnt lgkmcnt(8)
  v_mfma_f32_16x16x32_bf16 v[16:19], v[104:107], v[76:79], v[16:19]
  v_mfma_f32_16x16x32_bf16 v[52:55], v[104:107], v[80:83], v[52:55]
  ds_read_b64_tr_b16 v[104:105], v113 offset:224
  ds_read_b64_tr_b16 v[106:107], v113 offset:1376
  s_add_u32 m0, s45, 0
  s_add_u32 s46, s33, 3538944
  buffer_load_dwordx4 v116, s[8:11], s46 offen lds
  s_waitcnt lgkmcnt(8)
  v_mfma_f32_16x16x32_bf16 v[20:23], v[92:95], v[76:79], v[20:23]
  v_mfma_f32_16x16x32_bf16 v[56:59], v[92:95], v[80:83], v[56:59]
  ds_read_b64_tr_b16 v[92:93], v113 offset:256
  ds_read_b64_tr_b16 v[94:95], v113 offset:1408
  s_add_u32 m0, s45, 8192
  s_add_u32 s46, s33, 3538944
  buffer_load_dwordx4 v117, s[8:11], s46 offen lds
  s_waitcnt lgkmcnt(8)
  v_mfma_f32_16x16x32_bf16 v[24:27], v[96:99], v[76:79], v[24:27]
  v_mfma_f32_16x16x32_bf16 v[60:63], v[96:99], v[80:83], v[60:63]
  ds_read_b64_tr_b16 v[96:97], v113 offset:9728
  ds_read_b64_tr_b16 v[98:99], v113 offset:10880
  s_cmp_ge_u32 s40, 3
  s_cbranch_scc1 gemm1_kernel_wsk9
  s_add_u32 m0, s45, 16384
  s_add_u32 s46, s33, 3538944
  buffer_load_dwordx4 v118, s[8:11], s46 offen lds
  gemm1_kernel_wsk9:
  s_waitcnt lgkmcnt(6)
  v_mfma_f32_16x16x32_bf16 v[28:31], v[100:103], v[76:79], v[28:31]
  v_mfma_f32_16x16x32_bf16 v[64:67], v[100:103], v[80:83], v[64:67]
  ds_read_b64_tr_b16 v[100:101], v113 offset:9760
  ds_read_b64_tr_b16 v[102:103], v113 offset:10912
  s_waitcnt lgkmcnt(6)
  v_mfma_f32_16x16x32_bf16 v[32:35], v[104:107], v[76:79], v[32:35]
  v_mfma_f32_16x16x32_bf16 v[68:71], v[104:107], v[80:83], v[68:71]
  ds_read_b64_tr_b16 v[104:105], v113 offset:9792
  ds_read_b64_tr_b16 v[106:107], v113 offset:10944
  s_waitcnt lgkmcnt(6)
  v_mfma_f32_16x16x32_bf16 v[36:39], v[92:95], v[76:79], v[36:39]
  v_mfma_f32_16x16x32_bf16 v[72:75], v[92:95], v[80:83], v[72:75]
  ds_read_b64_tr_b16 v[92:93], v113 offset:9824
  ds_read_b64_tr_b16 v[94:95], v113 offset:10976
  s_waitcnt lgkmcnt(6)
  v_mfma_f32_16x16x32_bf16 v[4:7], v[96:99], v[84:87], v[4:7]
  v_mfma_f32_16x16x32_bf16 v[40:43], v[96:99], v[88:91], v[40:43]
  ds_read_b64_tr_b16 v[96:97], v113 offset:9856
  ds_read_b64_tr_b16 v[98:99], v113 offset:11008
  s_waitcnt lgkmcnt(6)
  v_mfma_f32_16x16x32_bf16 v[8:11], v[100:103], v[84:87], v[8:11]
  v_mfma_f32_16x16x32_bf16 v[44:47], v[100:103], v[88:91], v[44:47]
  ds_read_b64_tr_b16 v[100:101], v113 offset:9888
  ds_read_b64_tr_b16 v[102:103], v113 offset:11040
  s_waitcnt lgkmcnt(6)
  v_mfma_f32_16x16x32_bf16 v[12:15], v[104:107], v[84:87], v[12:15]
  v_mfma_f32_16x16x32_bf16 v[48:51], v[104:107], v[88:91], v[48:51]
  ds_read_b64_tr_b16 v[104:105], v113 offset:9920
  ds_read_b64_tr_b16 v[106:107], v113 offset:11072
  s_waitcnt lgkmcnt(6)
  v_mfma_f32_16x16x32_bf16 v[16:19], v[92:95], v[84:87], v[16:19]
  v_mfma_f32_16x16x32_bf16 v[52:55], v[92:95], v[88:91], v[52:55]
  ds_read_b64_tr_b16 v[92:93], v113 offset:9952
  ds_read_b64_tr_b16 v[94:95], v113 offset:11104
  s_waitcnt lgkmcnt(6)
  v_mfma_f32_16x16x32_bf16 v[20:23], v[96:99], v[84:87], v[20:23]
  v_mfma_f32_16x16x32_bf16 v[56:59], v[96:99], v[88:91], v[56:59]
  ds_read_b64_tr_b16 v[96:97], v113 offset:9984
  ds_read_b64_tr_b16 v[98:99], v113 offset:11136
  s_waitcnt lgkmcnt(6)
  v_mfma_f32_16x16x32_bf16 v[24:27], v[100:103], v[84:87], v[24:27]
  v_mfma_f32_16x16x32_bf16 v[60:63], v[100:103], v[88:91], v[60:63]
  s_waitcnt lgkmcnt(4)
  v_mfma_f32_16x16x32_bf16 v[28:31], v[104:107], v[84:87], v[28:31]
  v_mfma_f32_16x16x32_bf16 v[64:67], v[104:107], v[88:91], v[64:67]
  s_waitcnt lgkmcnt(2)
  v_mfma_f32_16x16x32_bf16 v[32:35], v[92:95], v[84:87], v[32:35]
  v_mfma_f32_16x16x32_bf16 v[68:71], v[92:95], v[88:91], v[68:71]
  s_waitcnt lgkmcnt(0)
  v_mfma_f32_16x16x32_bf16 v[36:39], v[96:99], v[84:87], v[36:39]
  v_mfma_f32_16x16x32_bf16 v[72:75], v[96:99], v[88:91], v[72:75]
  s_waitcnt vmcnt(0)
  s_barrier
  ds_read_b64_tr_b16 v[92:93], v112 offset:0
  ds_read_b64_tr_b16 v[94:95], v112 offset:1152
  ds_read_b128 v[76:79], v108 offset:0
  ds_read_b128 v[80:83], v108 offset:2048
  ds_read_b64_tr_b16 v[96:97], v112 offset:32
  ds_read_b64_tr_b16 v[98:99], v112 offset:1184
  ds_read_b64_tr_b16 v[100:101], v112 offset:64
  ds_read_b64_tr_b16 v[102:103], v112 offset:1216
  ds_read_b64_tr_b16 v[104:105], v112 offset:96
  ds_read_b64_tr_b16 v[106:107], v112 offset:1248
  s_add_u32 m0, s44, 52224
  s_add_u32 s46, s43, 896
  buffer_load_dwordx4 v114, s[4:7], s46 offen lds
  s_waitcnt lgkmcnt(6)
  v_mfma_f32_16x16x32_bf16 v[4:7], v[92:95], v[76:79], v[4:7]
  v_mfma_f32_16x16x32_bf16 v[40:43], v[92:95], v[80:83], v[40:43]
  ds_read_b64_tr_b16 v[92:93], v112 offset:128
  ds_read_b64_tr_b16 v[94:95], v112 offset:1280
  s_add_u32 m0, s44, 53248
  s_add_u32 s46, s43, 10112
  buffer_load_dwordx4 v115, s[4:7], s46 offen lds
  s_waitcnt lgkmcnt(6)
  v_mfma_f32_16x16x32_bf16 v[8:11], v[96:99], v[76:79], v[8:11]
  v_mfma_f32_16x16x32_bf16 v[44:47], v[96:99], v[80:83], v[44:47]
  ds_read_b64_tr_b16 v[96:97], v112 offset:160
  ds_read_b64_tr_b16 v[98:99], v112 offset:1312
  ds_read_b128 v[84:87], v109 offset:0
  ds_read_b128 v[88:91], v109 offset:2048
  s_add_u32 m0, s44, 54272
  s_add_u32 s46, s43, 19328
  buffer_load_dwordx4 v114, s[4:7], s46 offen lds
  s_waitcnt lgkmcnt(8)
  v_mfma_f32_16x16x32_bf16 v[12:15], v[100:103], v[76:79], v[12:15]
  v_mfma_f32_16x16x32_bf16 v[48:51], v[100:103], v[80:83], v[48:51]
  ds_read_b64_tr_b16 v[100:101], v112 offset:192
  ds_read_b64_tr_b16 v[102:103], v112 offset:1344
  s_add_u32 m0, s44, 55296
  s_add_u32 s46, s43, 28544
  buffer_load_dwordx4 v115, s[4:7], s46 offen lds
  s_waitcnt lgkmcnt(8)
  v_mfma_f32_16x16x32_bf16 v[16:19], v[104:107], v[76:79], v[16:19]
  v_mfma_f32_16x16x32_bf16 v[52:55], v[104:107], v[80:83], v[52:55]
  ds_read_b64_tr_b16 v[104:105], v112 offset:224
  ds_read_b64_tr_b16 v[106:107], v112 offset:1376
  s_add_u32 m0, s45, 52224
  s_add_u32 s46, s33, 4128768
  buffer_load_dwordx4 v116, s[8:11], s46 offen lds
  s_waitcnt lgkmcnt(8)
  v_mfma_f32_16x16x32_bf16 v[20:23], v[92:95], v[76:79], v[20:23]
  v_mfma_f32_16x16x32_bf16 v[56:59], v[92:95], v[80:83], v[56:59]
  ds_read_b64_tr_b16 v[92:93], v112 offset:256
  ds_read_b64_tr_b16 v[94:95], v112 offset:1408
  s_add_u32 m0, s45, 60416
  s_add_u32 s46, s33, 4128768
  buffer_load_dwordx4 v117, s[8:11], s46 offen lds
  s_waitcnt lgkmcnt(8)
  v_mfma_f32_16x16x32_bf16 v[24:27], v[96:99], v[76:79], v[24:27]
  v_mfma_f32_16x16x32_bf16 v[60:63], v[96:99], v[80:83], v[60:63]
  ds_read_b64_tr_b16 v[96:97], v112 offset:9728
  ds_read_b64_tr_b16 v[98:99], v112 offset:10880
  s_cmp_ge_u32 s40, 3
  s_cbranch_scc1 gemm1_kernel_wsk10
  s_add_u32 m0, s45, 68608
  s_add_u32 s46, s33, 4128768
  buffer_load_dwordx4 v118, s[8:11], s46 offen lds
  gemm1_kernel_wsk10:
  s_waitcnt lgkmcnt(6)
  v_mfma_f32_16x16x32_bf16 v[28:31], v[100:103], v[76:79], v[28:31]
  v_mfma_f32_16x16x32_bf16 v[64:67], v[100:103], v[80:83], v[64:67]
  ds_read_b64_tr_b16 v[100:101], v112 offset:9760
  ds_read_b64_tr_b16 v[102:103], v112 offset:10912
  s_waitcnt lgkmcnt(6)
  v_mfma_f32_16x16x32_bf16 v[32:35], v[104:107], v[76:79], v[32:35]
  v_mfma_f32_16x16x32_bf16 v[68:71], v[104:107], v[80:83], v[68:71]
  ds_read_b64_tr_b16 v[104:105], v112 offset:9792
  ds_read_b64_tr_b16 v[106:107], v112 offset:10944
  s_waitcnt lgkmcnt(6)
  v_mfma_f32_16x16x32_bf16 v[36:39], v[92:95], v[76:79], v[36:39]
  v_mfma_f32_16x16x32_bf16 v[72:75], v[92:95], v[80:83], v[72:75]
  ds_read_b64_tr_b16 v[92:93], v112 offset:9824
  ds_read_b64_tr_b16 v[94:95], v112 offset:10976
  s_waitcnt lgkmcnt(6)
  v_mfma_f32_16x16x32_bf16 v[4:7], v[96:99], v[84:87], v[4:7]
  v_mfma_f32_16x16x32_bf16 v[40:43], v[96:99], v[88:91], v[40:43]
  ds_read_b64_tr_b16 v[96:97], v112 offset:9856
  ds_read_b64_tr_b16 v[98:99], v112 offset:11008
  s_waitcnt lgkmcnt(6)
  v_mfma_f32_16x16x32_bf16 v[8:11], v[100:103], v[84:87], v[8:11]
  v_mfma_f32_16x16x32_bf16 v[44:47], v[100:103], v[88:91], v[44:47]
  ds_read_b64_tr_b16 v[100:101], v112 offset:9888
  ds_read_b64_tr_b16 v[102:103], v112 offset:11040
  s_waitcnt lgkmcnt(6)
  v_mfma_f32_16x16x32_bf16 v[12:15], v[104:107], v[84:87], v[12:15]
  v_mfma_f32_16x16x32_bf16 v[48:51], v[104:107], v[88:91], v[48:51]
  ds_read_b64_tr_b16 v[104:105], v112 offset:9920
  ds_read_b64_tr_b16 v[106:107], v112 offset:11072
  s_waitcnt lgkmcnt(6)
  v_mfma_f32_16x16x32_bf16 v[16:19], v[92:95], v[84:87], v[16:19]
  v_mfma_f32_16x16x32_bf16 v[52:55], v[92:95], v[88:91], v[52:55]
  ds_read_b64_tr_b16 v[92:93], v112 offset:9952
  ds_read_b64_tr_b16 v[94:95], v112 offset:11104
  s_waitcnt lgkmcnt(6)
  v_mfma_f32_16x16x32_bf16 v[20:23], v[96:99], v[84:87], v[20:23]
  v_mfma_f32_16x16x32_bf16 v[56:59], v[96:99], v[88:91], v[56:59]
  ds_read_b64_tr_b16 v[96:97], v112 offset:9984
  ds_read_b64_tr_b16 v[98:99], v112 offset:11136
  s_waitcnt lgkmcnt(6)
  v_mfma_f32_16x16x32_bf16 v[24:27], v[100:103], v[84:87], v[24:27]
  v_mfma_f32_16x16x32_bf16 v[60:63], v[100:103], v[88:91], v[60:63]
  s_waitcnt lgkmcnt(4)
  v_mfma_f32_16x16x32_bf16 v[28:31], v[104:107], v[84:87], v[28:31]
  v_mfma_f32_16x16x32_bf16 v[64:67], v[104:107], v[88:91], v[64:67]
  s_waitcnt lgkmcnt(2)
  v_mfma_f32_16x16x32_bf16 v[32:35], v[92:95], v[84:87], v[32:35]
  v_mfma_f32_16x16x32_bf16 v[68:71], v[92:95], v[88:91], v[68:71]
  s_waitcnt lgkmcnt(0)
  v_mfma_f32_16x16x32_bf16 v[36:39], v[96:99], v[84:87], v[36:39]
  v_mfma_f32_16x16x32_bf16 v[72:75], v[96:99], v[88:91], v[72:75]
  s_waitcnt vmcnt(0)
  s_barrier
  ds_read_b64_tr_b16 v[92:93], v113 offset:0
  ds_read_b64_tr_b16 v[94:95], v113 offset:1152
  ds_read_b128 v[76:79], v110 offset:0
  ds_read_b128 v[80:83], v110 offset:2048
  ds_read_b64_tr_b16 v[96:97], v113 offset:32
  ds_read_b64_tr_b16 v[98:99], v113 offset:1184
  ds_read_b64_tr_b16 v[100:101], v113 offset:64
  ds_read_b64_tr_b16 v[102:103], v113 offset:1216
  ds_read_b64_tr_b16 v[104:105], v113 offset:96
  ds_read_b64_tr_b16 v[106:107], v113 offset:1248
  s_add_u32 m0, s44, 0
  s_add_u32 s46, s43, 1024
  buffer_load_dwordx4 v114, s[4:7], s46 offen lds
  s_waitcnt lgkmcnt(6)
  v_mfma_f32_16x16x32_bf16 v[4:7], v[92:95], v[76:79], v[4:7]
  v_mfma_f32_16x16x32_bf16 v[40:43], v[92:95], v[80:83], v[40:43]
  ds_read_b64_tr_b16 v[92:93], v113 offset:128
  ds_read_b64_tr_b16 v[94:95], v113 offset:1280
  s_add_u32 m0, s44, 1024
  s_add_u32 s46, s43, 10240
  buffer_load_dwordx4 v115, s[4:7], s46 offen lds
  s_waitcnt lgkmcnt(6)
  v_mfma_f32_16x16x32_bf16 v[8:11], v[96:99], v[76:79], v[8:11]
  v_mfma_f32_16x16x32_bf16 v[44:47], v[96:99], v[80:83], v[44:47]
  ds_read_b64_tr_b16 v[96:97], v113 offset:160
  ds_read_b64_tr_b16 v[98:99], v113 offset:1312
  ds_read_b128 v[84:87], v111 offset:0
  ds_read_b128 v[88:91], v111 offset:2048
  s_add_u32 m0, s44, 2048
  s_add_u32 s46, s43, 19456
  buffer_load_dwordx4 v114, s[4:7], s46 offen lds
  s_waitcnt lgkmcnt(8)
  v_mfma_f32_16x16x32_bf16 v[12:15], v[100:103], v[76:79], v[12:15]
  v_mfma_f32_16x16x32_bf16 v[48:51], v[100:103], v[80:83], v[48:51]
  ds_read_b64_tr_b16 v[100:101], v113 offset:192
  ds_read_b64_tr_b16 v[102:103], v113 offset:1344
  s_add_u32 m0, s44, 3072
  s_add_u32 s46, s43, 28672
  buffer_load_dwordx4 v115, s[4:7], s46 offen lds
  s_waitcnt lgkmcnt(8)
  v_mfma_f32_16x16x32_bf16 v[16:19], v[104:107], v[76:79], v[16:19]
  v_mfma_f32_16x16x32_bf16 v[52:55], v[104:107], v[80:83], v[52:55]
  ds_read_b64_tr_b16 v[104:105], v113 offset:224
  ds_read_b64_tr_b16 v[106:107], v113 offset:1376
  s_add_u32 m0, s45, 0
  s_add_u32 s46, s33, 4718592
  buffer_load_dwordx4 v116, s[8:11], s46 offen lds
  s_waitcnt lgkmcnt(8)
  v_mfma_f32_16x16x32_bf16 v[20:23], v[92:95], v[76:79], v[20:23]
  v_mfma_f32_16x16x32_bf16 v[56:59], v[92:95], v[80:83], v[56:59]
  ds_read_b64_tr_b16 v[92:93], v113 offset:256
  ds_read_b64_tr_b16 v[94:95], v113 offset:1408
  s_add_u32 m0, s45, 8192
  s_add_u32 s46, s33, 4718592
  buffer_load_dwordx4 v117, s[8:11], s46 offen lds
  s_waitcnt lgkmcnt(8)
  v_mfma_f32_16x16x32_bf16 v[24:27], v[96:99], v[76:79], v[24:27]
  v_mfma_f32_16x16x32_bf16 v[60:63], v[96:99], v[80:83], v[60:63]
  ds_read_b64_tr_b16 v[96:97], v113 offset:9728
  ds_read_b64_tr_b16 v[98:99], v113 offset:10880
  s_cmp_ge_u32 s40, 3
  s_cbranch_scc1 gemm1_kernel_wsk11
  s_add_u32 m0, s45, 16384
  s_add_u32 s46, s33, 4718592
  buffer_load_dwordx4 v118, s[8:11], s46 offen lds
  gemm1_kernel_wsk11:
  s_waitcnt lgkmcnt(6)
  v_mfma_f32_16x16x32_bf16 v[28:31], v[100:103], v[76:79], v[28:31]
  v_mfma_f32_16x16x32_bf16 v[64:67], v[100:103], v[80:83], v[64:67]
  ds_read_b64_tr_b16 v[100:101], v113 offset:9760
  ds_read_b64_tr_b16 v[102:103], v113 offset:10912
  s_waitcnt lgkmcnt(6)
  v_mfma_f32_16x16x32_bf16 v[32:35], v[104:107], v[76:79], v[32:35]
  v_mfma_f32_16x16x32_bf16 v[68:71], v[104:107], v[80:83], v[68:71]
  ds_read_b64_tr_b16 v[104:105], v113 offset:9792
  ds_read_b64_tr_b16 v[106:107], v113 offset:10944
  s_waitcnt lgkmcnt(6)
  v_mfma_f32_16x16x32_bf16 v[36:39], v[92:95], v[76:79], v[36:39]
  v_mfma_f32_16x16x32_bf16 v[72:75], v[92:95], v[80:83], v[72:75]
  ds_read_b64_tr_b16 v[92:93], v113 offset:9824
  ds_read_b64_tr_b16 v[94:95], v113 offset:10976
  s_waitcnt lgkmcnt(6)
  v_mfma_f32_16x16x32_bf16 v[4:7], v[96:99], v[84:87], v[4:7]
  v_mfma_f32_16x16x32_bf16 v[40:43], v[96:99], v[88:91], v[40:43]
  ds_read_b64_tr_b16 v[96:97], v113 offset:9856
  ds_read_b64_tr_b16 v[98:99], v113 offset:11008
  s_waitcnt lgkmcnt(6)
  v_mfma_f32_16x16x32_bf16 v[8:11], v[100:103], v[84:87], v[8:11]
  v_mfma_f32_16x16x32_bf16 v[44:47], v[100:103], v[88:91], v[44:47]
  ds_read_b64_tr_b16 v[100:101], v113 offset:9888
  ds_read_b64_tr_b16 v[102:103], v113 offset:11040
  s_waitcnt lgkmcnt(6)
  v_mfma_f32_16x16x32_bf16 v[12:15], v[104:107], v[84:87], v[12:15]
  v_mfma_f32_16x16x32_bf16 v[48:51], v[104:107], v[88:91], v[48:51]
  ds_read_b64_tr_b16 v[104:105], v113 offset:9920
  ds_read_b64_tr_b16 v[106:107], v113 offset:11072
  s_waitcnt lgkmcnt(6)
  v_mfma_f32_16x16x32_bf16 v[16:19], v[92:95], v[84:87], v[16:19]
  v_mfma_f32_16x16x32_bf16 v[52:55], v[92:95], v[88:91], v[52:55]
  ds_read_b64_tr_b16 v[92:93], v113 offset:9952
  ds_read_b64_tr_b16 v[94:95], v113 offset:11104
  s_waitcnt lgkmcnt(6)
  v_mfma_f32_16x16x32_bf16 v[20:23], v[96:99], v[84:87], v[20:23]
  v_mfma_f32_16x16x32_bf16 v[56:59], v[96:99], v[88:91], v[56:59]
  ds_read_b64_tr_b16 v[96:97], v113 offset:9984
  ds_read_b64_tr_b16 v[98:99], v113 offset:11136
  s_waitcnt lgkmcnt(6)
  v_mfma_f32_16x16x32_bf16 v[24:27], v[100:103], v[84:87], v[24:27]
  v_mfma_f32_16x16x32_bf16 v[60:63], v[100:103], v[88:91], v[60:63]
  s_waitcnt lgkmcnt(4)
  v_mfma_f32_16x16x32_bf16 v[28:31], v[104:107], v[84:87], v[28:31]
  v_mfma_f32_16x16x32_bf16 v[64:67], v[104:107], v[88:91], v[64:67]
  s_waitcnt lgkmcnt(2)
  v_mfma_f32_16x16x32_bf16 v[32:35], v[92:95], v[84:87], v[32:35]
  v_mfma_f32_16x16x32_bf16 v[68:71], v[92:95], v[88:91], v[68:71]
  s_waitcnt lgkmcnt(0)
  v_mfma_f32_16x16x32_bf16 v[36:39], v[96:99], v[84:87], v[36:39]
  v_mfma_f32_16x16x32_bf16 v[72:75], v[96:99], v[88:91], v[72:75]
  s_waitcnt vmcnt(0)
  s_barrier
  ds_read_b64_tr_b16 v[92:93], v112 offset:0
  ds_read_b64_tr_b16 v[94:95], v112 offset:1152
  ds_read_b128 v[76:79], v108 offset:0
  ds_read_b128 v[80:83], v108 offset:2048
  ds_read_b64_tr_b16 v[96:97], v112 offset:32
  ds_read_b64_tr_b16 v[98:99], v112 offset:1184
  ds_read_b64_tr_b16 v[100:101], v112 offset:64
  ds_read_b64_tr_b16 v[102:103], v112 offset:1216
  ds_read_b64_tr_b16 v[104:105], v112 offset:96
  ds_read_b64_tr_b16 v[106:107], v112 offset:1248
  s_waitcnt lgkmcnt(6)
  v_mfma_f32_16x16x32_bf16 v[4:7], v[92:95], v[76:79], v[4:7]
  v_mfma_f32_16x16x32_bf16 v[40:43], v[92:95], v[80:83], v[40:43]
  ds_read_b64_tr_b16 v[92:93], v112 offset:128
  ds_read_b64_tr_b16 v[94:95], v112 offset:1280
  s_waitcnt lgkmcnt(6)
  v_mfma_f32_16x16x32_bf16 v[8:11], v[96:99], v[76:79], v[8:11]
  v_mfma_f32_16x16x32_bf16 v[44:47], v[96:99], v[80:83], v[44:47]
  ds_read_b64_tr_b16 v[96:97], v112 offset:160
  ds_read_b64_tr_b16 v[98:99], v112 offset:1312
  ds_read_b128 v[84:87], v109 offset:0
  ds_read_b128 v[88:91], v109 offset:2048
  s_waitcnt lgkmcnt(8)
  v_mfma_f32_16x16x32_bf16 v[12:15], v[100:103], v[76:79], v[12:15]
  v_mfma_f32_16x16x32_bf16 v[48:51], v[100:103], v[80:83], v[48:51]
  ds_read_b64_tr_b16 v[100:101], v112 offset:192
  ds_read_b64_tr_b16 v[102:103], v112 offset:1344
  s_waitcnt lgkmcnt(8)
  v_mfma_f32_16x16x32_bf16 v[16:19], v[104:107], v[76:79], v[16:19]
  v_mfma_f32_16x16x32_bf16 v[52:55], v[104:107], v[80:83], v[52:55]
  ds_read_b64_tr_b16 v[104:105], v112 offset:224
  ds_read_b64_tr_b16 v[106:107], v112 offset:1376
  s_waitcnt lgkmcnt(8)
  v_mfma_f32_16x16x32_bf16 v[20:23], v[92:95], v[76:79], v[20:23]
  v_mfma_f32_16x16x32_bf16 v[56:59], v[92:95], v[80:83], v[56:59]
  ds_read_b64_tr_b16 v[92:93], v112 offset:256
  ds_read_b64_tr_b16 v[94:95], v112 offset:1408
  s_waitcnt lgkmcnt(8)
  v_mfma_f32_16x16x32_bf16 v[24:27], v[96:99], v[76:79], v[24:27]
  v_mfma_f32_16x16x32_bf16 v[60:63], v[96:99], v[80:83], v[60:63]
  ds_read_b64_tr_b16 v[96:97], v112 offset:9728
  ds_read_b64_tr_b16 v[98:99], v112 offset:10880
  s_waitcnt lgkmcnt(6)
  v_mfma_f32_16x16x32_bf16 v[28:31], v[100:103], v[76:79], v[28:31]
  v_mfma_f32_16x16x32_bf16 v[64:67], v[100:103], v[80:83], v[64:67]
  ds_read_b64_tr_b16 v[100:101], v112 offset:9760
  ds_read_b64_tr_b16 v[102:103], v112 offset:10912
  s_waitcnt lgkmcnt(6)
  v_mfma_f32_16x16x32_bf16 v[32:35], v[104:107], v[76:79], v[32:35]
  v_mfma_f32_16x16x32_bf16 v[68:71], v[104:107], v[80:83], v[68:71]
  ds_read_b64_tr_b16 v[104:105], v112 offset:9792
  ds_read_b64_tr_b16 v[106:107], v112 offset:10944
  s_waitcnt lgkmcnt(6)
  v_mfma_f32_16x16x32_bf16 v[36:39], v[92:95], v[76:79], v[36:39]
  v_mfma_f32_16x16x32_bf16 v[72:75], v[92:95], v[80:83], v[72:75]
  ds_read_b64_tr_b16 v[92:93], v112 offset:9824
  ds_read_b64_tr_b16 v[94:95], v112 offset:10976
  s_waitcnt lgkmcnt(6)
  v_mfma_f32_16x16x32_bf16 v[4:7], v[96:99], v[84:87], v[4:7]
  v_mfma_f32_16x16x32_bf16 v[40:43], v[96:99], v[88:91], v[40:43]
  ds_read_b64_tr_b16 v[96:97], v112 offset:9856
  ds_read_b64_tr_b16 v[98:99], v112 offset:11008
  s_waitcnt lgkmcnt(6)
  v_mfma_f32_16x16x32_bf16 v[8:11], v[100:103], v[84:87], v[8:11]
  v_mfma_f32_16x16x32_bf16 v[44:47], v[100:103], v[88:91], v[44:47]
  ds_read_b64_tr_b16 v[100:101], v112 offset:9888
  ds_read_b64_tr_b16 v[102:103], v112 offset:11040
  s_waitcnt lgkmcnt(6)
  v_mfma_f32_16x16x32_bf16 v[12:15], v[104:107], v[84:87], v[12:15]
  v_mfma_f32_16x16x32_bf16 v[48:51], v[104:107], v[88:91], v[48:51]
  ds_read_b64_tr_b16 v[104:105], v112 offset:9920
  ds_read_b64_tr_b16 v[106:107], v112 offset:11072
  s_waitcnt lgkmcnt(6)
  v_mfma_f32_16x16x32_bf16 v[16:19], v[92:95], v[84:87], v[16:19]
  v_mfma_f32_16x16x32_bf16 v[52:55], v[92:95], v[88:91], v[52:55]
  ds_read_b64_tr_b16 v[92:93], v112 offset:9952
  ds_read_b64_tr_b16 v[94:95], v112 offset:11104
  s_waitcnt lgkmcnt(6)
  v_mfma_f32_16x16x32_bf16 v[20:23], v[96:99], v[84:87], v[20:23]
  v_mfma_f32_16x16x32_bf16 v[56:59], v[96:99], v[88:91], v[56:59]
  ds_read_b64_tr_b16 v[96:97], v112 offset:9984
  ds_read_b64_tr_b16 v[98:99], v112 offset:11136
  s_waitcnt lgkmcnt(6)
  v_mfma_f32_16x16x32_bf16 v[24:27], v[100:103], v[84:87], v[24:27]
  v_mfma_f32_16x16x32_bf16 v[60:63], v[100:103], v[88:91], v[60:63]
  s_waitcnt lgkmcnt(4)
  v_mfma_f32_16x16x32_bf16 v[28:31], v[104:107], v[84:87], v[28:31]
  v_mfma_f32_16x16x32_bf16 v[64:67], v[104:107], v[88:91], v[64:67]
  s_waitcnt lgkmcnt(2)
  v_mfma_f32_16x16x32_bf16 v[32:35], v[92:95], v[84:87], v[32:35]
  v_mfma_f32_16x16x32_bf16 v[68:71], v[92:95], v[88:91], v[68:71]
  s_waitcnt lgkmcnt(0)
  v_mfma_f32_16x16x32_bf16 v[36:39], v[96:99], v[84:87], v[36:39]
  v_mfma_f32_16x16x32_bf16 v[72:75], v[96:99], v[88:91], v[72:75]
  s_nop 7
  s_nop 7
  v_and_b32 v119, 15, v0
  v_bfe_u32 v120, v0, 4, 2
  v_lshlrev_b32 v119, 4, v119
  v_and_b32 v121, 1, v120
  v_lshrrev_b32 v122, 1, v120
  v_lshl_add_u32 v76, v122, 8, v119
  v_lshl_add_u32 v76, v121, 3, v76
  v_lshl_add_u32 v119, v121, 9, v119
  v_lshl_add_u32 v119, v122, 8, v119
  s_lshl_b32 s34, s30, 4
  s_lshl_b32 s35, s41, 1
  s_add_u32 s34, s34, s35
  s_mul_i32 s34, s34, 147456
  s_mul_i32 s35, s31, 4608
  s_add_u32 s34, s34, s35
  s_mov_b32 s36, 0xc0135761
  s_mov_b32 s37, 0xbdd2d3e8
  v_mov_b32 v120, s36
  s_add_u32 s35, s34, 0
  v_mul_f32 v78, v4, v4
  v_mul_f32 v79, v5, v5
  v_mul_f32 v80, v6, v6
  v_mul_f32 v81, v7, v7
  v_fma_f32 v78, v78, s37, v120
  v_fma_f32 v79, v79, s37, v120
  v_fma_f32 v80, v80, s37, v120
  v_fma_f32 v81, v81, s37, v120
  v_mul_f32 v78, v78, v4
  v_mul_f32 v79, v79, v5
  v_mul_f32 v80, v80, v6
  v_mul_f32 v81, v81, v7
  v_exp_f32 v78, v78
  v_exp_f32 v79, v79
  v_exp_f32 v80, v80
  v_exp_f32 v81, v81
  v_add_f32 v78, 1.0, v78
  v_add_f32 v79, 1.0, v79
  v_add_f32 v80, 1.0, v80
  v_add_f32 v81, 1.0, v81
  v_rcp_f32 v78, v78
  v_rcp_f32 v79, v79
  v_rcp_f32 v80, v80
  v_rcp_f32 v81, v81
  v_mul_f32 v4, v4, v78
  v_mul_f32 v5, v5, v79
  v_mul_f32 v6, v6, v80
  v_mul_f32 v7, v7, v81
  v_cvt_pk_bf16_f32 v4, v4, v5
  v_cvt_pk_bf16_f32 v5, v6, v7
  v_mul_f32 v78, v8, v8
  v_mul_f32 v79, v9, v9
  v_mul_f32 v80, v10, v10
  v_mul_f32 v81, v11, v11
  v_fma_f32 v78, v78, s37, v120
  v_fma_f32 v79, v79, s37, v120
  v_fma_f32 v80, v80, s37, v120
  v_fma_f32 v81, v81, s37, v120
  v_mul_f32 v78, v78, v8
  v_mul_f32 v79, v79, v9
  v_mul_f32 v80, v80, v10
  v_mul_f32 v81, v81, v11
  v_exp_f32 v78, v78
  v_exp_f32 v79, v79
  v_exp_f32 v80, v80
  v_exp_f32 v81, v81
  v_add_f32 v78, 1.0, v78
  v_add_f32 v79, 1.0, v79
  v_add_f32 v80, 1.0, v80
  v_add_f32 v81, 1.0, v81
  v_rcp_f32 v78, v78
  v_rcp_f32 v79, v79
  v_rcp_f32 v80, v80
  v_rcp_f32 v81, v81
  v_mul_f32 v8, v8, v78
  v_mul_f32 v9, v9, v79
  v_mul_f32 v10, v10, v80
  v_mul_f32 v11, v11, v81
  v_cvt_pk_bf16_f32 v6, v8, v9
  v_cvt_pk_bf16_f32 v7, v10, v11
  s_nop 1
  v_permlane16_swap_b32 v4, v6
  v_permlane16_swap_b32 v5, v7
  buffer_store_dwordx4 v[4:7], v119, s[12:15], s35 offen sc1
  s_add_u32 s35, s34, 1024
  v_mul_f32 v78, v12, v12
  v_mul_f32 v79, v13, v13
  v_mul_f32 v80, v14, v14
  v_mul_f32 v81, v15, v15
  v_fma_f32 v78, v78, s37, v120
  v_fma_f32 v79, v79, s37, v120
  v_fma_f32 v80, v80, s37, v120
  v_fma_f32 v81, v81, s37, v120
  v_mul_f32 v78, v78, v12
  v_mul_f32 v79, v79, v13
  v_mul_f32 v80, v80, v14
  v_mul_f32 v81, v81, v15
  v_exp_f32 v78, v78
  v_exp_f32 v79, v79
  v_exp_f32 v80, v80
  v_exp_f32 v81, v81
  v_add_f32 v78, 1.0, v78
  v_add_f32 v79, 1.0, v79
  v_add_f32 v80, 1.0, v80
  v_add_f32 v81, 1.0, v81
  v_rcp_f32 v78, v78
  v_rcp_f32 v79, v79
  v_rcp_f32 v80, v80
  v_rcp_f32 v81, v81
  v_mul_f32 v12, v12, v78
  v_mul_f32 v13, v13, v79
  v_mul_f32 v14, v14, v80
  v_mul_f32 v15, v15, v81
  v_cvt_pk_bf16_f32 v12, v12, v13
  v_cvt_pk_bf16_f32 v13, v14, v15
  v_mul_f32 v78, v16, v16
  v_mul_f32 v79, v17, v17
  v_mul_f32 v80, v18, v18
  v_mul_f32 v81, v19, v19
  v_fma_f32 v78, v78, s37, v120
  v_fma_f32 v79, v79, s37, v120
  v_fma_f32 v80, v80, s37, v120
  v_fma_f32 v81, v81, s37, v120
  v_mul_f32 v78, v78, v16
  v_mul_f32 v79, v79, v17
  v_mul_f32 v80, v80, v18
  v_mul_f32 v81, v81, v19
  v_exp_f32 v78, v78
  v_exp_f32 v79, v79
  v_exp_f32 v80, v80
  v_exp_f32 v81, v81
  v_add_f32 v78, 1.0, v78
  v_add_f32 v79, 1.0, v79
  v_add_f32 v80, 1.0, v80
  v_add_f32 v81, 1.0, v81
  v_rcp_f32 v78, v78
  v_rcp_f32 v79, v79
  v_rcp_f32 v80, v80
  v_rcp_f32 v81, v81
  v_mul_f32 v16, v16, v78
  v_mul_f32 v17, v17, v79
  v_mul_f32 v18, v18, v80
  v_mul_f32 v19, v19, v81
  v_cvt_pk_bf16_f32 v14, v16, v17
  v_cvt_pk_bf16_f32 v15, v18, v19
  s_nop 1
  v_permlane16_swap_b32 v12, v14
  v_permlane16_swap_b32 v13, v15
  buffer_store_dwordx4 v[12:15], v119, s[12:15], s35 offen sc1
  s_add_u32 s35, s34, 2048
  v_mul_f32 v78, v20, v20
  v_mul_f32 v79, v21, v21
  v_mul_f32 v80, v22, v22
  v_mul_f32 v81, v23, v23
  v_fma_f32 v78, v78, s37, v120
  v_fma_f32 v79, v79, s37, v120
  v_fma_f32 v80, v80, s37, v120
  v_fma_f32 v81, v81, s37, v120
  v_mul_f32 v78, v78, v20
  v_mul_f32 v79, v79, v21
  v_mul_f32 v80, v80, v22
  v_mul_f32 v81, v81, v23
  v_exp_f32 v78, v78
  v_exp_f32 v79, v79
  v_exp_f32 v80, v80
  v_exp_f32 v81, v81
  v_add_f32 v78, 1.0, v78
  v_add_f32 v79, 1.0, v79
  v_add_f32 v80, 1.0, v80
  v_add_f32 v81, 1.0, v81
  v_rcp_f32 v78, v78
  v_rcp_f32 v79, v79
  v_rcp_f32 v80, v80
  v_rcp_f32 v81, v81
  v_mul_f32 v20, v20, v78
  v_mul_f32 v21, v21, v79
  v_mul_f32 v22, v22, v80
  v_mul_f32 v23, v23, v81
  v_cvt_pk_bf16_f32 v20, v20, v21
  v_cvt_pk_bf16_f32 v21, v22, v23
  v_mul_f32 v78, v24, v24
  v_mul_f32 v79, v25, v25
  v_mul_f32 v80, v26, v26
  v_mul_f32 v81, v27, v27
  v_fma_f32 v78, v78, s37, v120
  v_fma_f32 v79, v79, s37, v120
  v_fma_f32 v80, v80, s37, v120
  v_fma_f32 v81, v81, s37, v120
  v_mul_f32 v78, v78, v24
  v_mul_f32 v79, v79, v25
  v_mul_f32 v80, v80, v26
  v_mul_f32 v81, v81, v27
  v_exp_f32 v78, v78
  v_exp_f32 v79, v79
  v_exp_f32 v80, v80
  v_exp_f32 v81, v81
  v_add_f32 v78, 1.0, v78
  v_add_f32 v79, 1.0, v79
  v_add_f32 v80, 1.0, v80
  v_add_f32 v81, 1.0, v81
  v_rcp_f32 v78, v78
  v_rcp_f32 v79, v79
  v_rcp_f32 v80, v80
  v_rcp_f32 v81, v81
  v_mul_f32 v24, v24, v78
  v_mul_f32 v25, v25, v79
  v_mul_f32 v26, v26, v80
  v_mul_f32 v27, v27, v81
  v_cvt_pk_bf16_f32 v22, v24, v25
  v_cvt_pk_bf16_f32 v23, v26, v27
  s_nop 1
  v_permlane16_swap_b32 v20, v22
  v_permlane16_swap_b32 v21, v23
  buffer_store_dwordx4 v[20:23], v119, s[12:15], s35 offen sc1
  s_add_u32 s35, s34, 3072
  v_mul_f32 v78, v28, v28
  v_mul_f32 v79, v29, v29
  v_mul_f32 v80, v30, v30
  v_mul_f32 v81, v31, v31
  v_fma_f32 v78, v78, s37, v120
  v_fma_f32 v79, v79, s37, v120
  v_fma_f32 v80, v80, s37, v120
  v_fma_f32 v81, v81, s37, v120
  v_mul_f32 v78, v78, v28
  v_mul_f32 v79, v79, v29
  v_mul_f32 v80, v80, v30
  v_mul_f32 v81, v81, v31
  v_exp_f32 v78, v78
  v_exp_f32 v79, v79
  v_exp_f32 v80, v80
  v_exp_f32 v81, v81
  v_add_f32 v78, 1.0, v78
  v_add_f32 v79, 1.0, v79
  v_add_f32 v80, 1.0, v80
  v_add_f32 v81, 1.0, v81
  v_rcp_f32 v78, v78
  v_rcp_f32 v79, v79
  v_rcp_f32 v80, v80
  v_rcp_f32 v81, v81
  v_mul_f32 v28, v28, v78
  v_mul_f32 v29, v29, v79
  v_mul_f32 v30, v30, v80
  v_mul_f32 v31, v31, v81
  v_cvt_pk_bf16_f32 v28, v28, v29
  v_cvt_pk_bf16_f32 v29, v30, v31
  v_mul_f32 v78, v32, v32
  v_mul_f32 v79, v33, v33
  v_mul_f32 v80, v34, v34
  v_mul_f32 v81, v35, v35
  v_fma_f32 v78, v78, s37, v120
  v_fma_f32 v79, v79, s37, v120
  v_fma_f32 v80, v80, s37, v120
  v_fma_f32 v81, v81, s37, v120
  v_mul_f32 v78, v78, v32
  v_mul_f32 v79, v79, v33
  v_mul_f32 v80, v80, v34
  v_mul_f32 v81, v81, v35
  v_exp_f32 v78, v78
  v_exp_f32 v79, v79
  v_exp_f32 v80, v80
  v_exp_f32 v81, v81
  v_add_f32 v78, 1.0, v78
  v_add_f32 v79, 1.0, v79
  v_add_f32 v80, 1.0, v80
  v_add_f32 v81, 1.0, v81
  v_rcp_f32 v78, v78
  v_rcp_f32 v79, v79
  v_rcp_f32 v80, v80
  v_rcp_f32 v81, v81
  v_mul_f32 v32, v32, v78
  v_mul_f32 v33, v33, v79
  v_mul_f32 v34, v34, v80
  v_mul_f32 v35, v35, v81
  v_cvt_pk_bf16_f32 v30, v32, v33
  v_cvt_pk_bf16_f32 v31, v34, v35
  s_nop 1
  v_permlane16_swap_b32 v28, v30
  v_permlane16_swap_b32 v29, v31
  buffer_store_dwordx4 v[28:31], v119, s[12:15], s35 offen sc1
  s_add_u32 s35, s34, 4096
  v_mul_f32 v78, v36, v36
  v_mul_f32 v79, v37, v37
  v_mul_f32 v80, v38, v38
  v_mul_f32 v81, v39, v39
  v_fma_f32 v78, v78, s37, v120
  v_fma_f32 v79, v79, s37, v120
  v_fma_f32 v80, v80, s37, v120
  v_fma_f32 v81, v81, s37, v120
  v_mul_f32 v78, v78, v36
  v_mul_f32 v79, v79, v37
  v_mul_f32 v80, v80, v38
  v_mul_f32 v81, v81, v39
  v_exp_f32 v78, v78
  v_exp_f32 v79, v79
  v_exp_f32 v80, v80
  v_exp_f32 v81, v81
  v_add_f32 v78, 1.0, v78
  v_add_f32 v79, 1.0, v79
  v_add_f32 v80, 1.0, v80
  v_add_f32 v81, 1.0, v81
  v_rcp_f32 v78, v78
  v_rcp_f32 v79, v79
  v_rcp_f32 v80, v80
  v_rcp_f32 v81, v81
  v_mul_f32 v36, v36, v78
  v_mul_f32 v37, v37, v79
  v_mul_f32 v38, v38, v80
  v_mul_f32 v39, v39, v81
  v_cvt_pk_bf16_f32 v36, v36, v37
  v_cvt_pk_bf16_f32 v37, v38, v39
  buffer_store_dwordx2 v[36:37], v76, s[12:15], s35 offen sc1
  s_add_u32 s35, s34, 147456
  v_mul_f32 v78, v40, v40
  v_mul_f32 v79, v41, v41
  v_mul_f32 v80, v42, v42
  v_mul_f32 v81, v43, v43
  v_fma_f32 v78, v78, s37, v120
  v_fma_f32 v79, v79, s37, v120
  v_fma_f32 v80, v80, s37, v120
  v_fma_f32 v81, v81, s37, v120
  v_mul_f32 v78, v78, v40
  v_mul_f32 v79, v79, v41
  v_mul_f32 v80, v80, v42
  v_mul_f32 v81, v81, v43
  v_exp_f32 v78, v78
  v_exp_f32 v79, v79
  v_exp_f32 v80, v80
  v_exp_f32 v81, v81
  v_add_f32 v78, 1.0, v78
  v_add_f32 v79, 1.0, v79
  v_add_f32 v80, 1.0, v80
  v_add_f32 v81, 1.0, v81
  v_rcp_f32 v78, v78
  v_rcp_f32 v79, v79
  v_rcp_f32 v80, v80
  v_rcp_f32 v81, v81
  v_mul_f32 v40, v40, v78
  v_mul_f32 v41, v41, v79
  v_mul_f32 v42, v42, v80
  v_mul_f32 v43, v43, v81
  v_cvt_pk_bf16_f32 v40, v40, v41
  v_cvt_pk_bf16_f32 v41, v42, v43
  v_mul_f32 v78, v44, v44
  v_mul_f32 v79, v45, v45
  v_mul_f32 v80, v46, v46
  v_mul_f32 v81, v47, v47
  v_fma_f32 v78, v78, s37, v120
  v_fma_f32 v79, v79, s37, v120
  v_fma_f32 v80, v80, s37, v120
  v_fma_f32 v81, v81, s37, v120
  v_mul_f32 v78, v78, v44
  v_mul_f32 v79, v79, v45
  v_mul_f32 v80, v80, v46
  v_mul_f32 v81, v81, v47
  v_exp_f32 v78, v78
  v_exp_f32 v79, v79
  v_exp_f32 v80, v80
  v_exp_f32 v81, v81
  v_add_f32 v78, 1.0, v78
  v_add_f32 v79, 1.0, v79
  v_add_f32 v80, 1.0, v80
  v_add_f32 v81, 1.0, v81
  v_rcp_f32 v78, v78
  v_rcp_f32 v79, v79
  v_rcp_f32 v80, v80
  v_rcp_f32 v81, v81
  v_mul_f32 v44, v44, v78
  v_mul_f32 v45, v45, v79
  v_mul_f32 v46, v46, v80
  v_mul_f32 v47, v47, v81
  v_cvt_pk_bf16_f32 v42, v44, v45
  v_cvt_pk_bf16_f32 v43, v46, v47
  s_nop 1
  v_permlane16_swap_b32 v40, v42
  v_permlane16_swap_b32 v41, v43
  buffer_store_dwordx4 v[40:43], v119, s[12:15], s35 offen sc1
  s_add_u32 s35, s34, 148480
  v_mul_f32 v78, v48, v48
  v_mul_f32 v79, v49, v49
  v_mul_f32 v80, v50, v50
  v_mul_f32 v81, v51, v51
  v_fma_f32 v78, v78, s37, v120
  v_fma_f32 v79, v79, s37, v120
  v_fma_f32 v80, v80, s37, v120
  v_fma_f32 v81, v81, s37, v120
  v_mul_f32 v78, v78, v48
  v_mul_f32 v79, v79, v49
  v_mul_f32 v80, v80, v50
  v_mul_f32 v81, v81, v51
  v_exp_f32 v78, v78
  v_exp_f32 v79, v79
  v_exp_f32 v80, v80
  v_exp_f32 v81, v81
  v_add_f32 v78, 1.0, v78
  v_add_f32 v79, 1.0, v79
  v_add_f32 v80, 1.0, v80
  v_add_f32 v81, 1.0, v81
  v_rcp_f32 v78, v78
  v_rcp_f32 v79, v79
  v_rcp_f32 v80, v80
  v_rcp_f32 v81, v81
  v_mul_f32 v48, v48, v78
  v_mul_f32 v49, v49, v79
  v_mul_f32 v50, v50, v80
  v_mul_f32 v51, v51, v81
  v_cvt_pk_bf16_f32 v48, v48, v49
  v_cvt_pk_bf16_f32 v49, v50, v51
  v_mul_f32 v78, v52, v52
  v_mul_f32 v79, v53, v53
  v_mul_f32 v80, v54, v54
  v_mul_f32 v81, v55, v55
  v_fma_f32 v78, v78, s37, v120
  v_fma_f32 v79, v79, s37, v120
  v_fma_f32 v80, v80, s37, v120
  v_fma_f32 v81, v81, s37, v120
  v_mul_f32 v78, v78, v52
  v_mul_f32 v79, v79, v53
  v_mul_f32 v80, v80, v54
  v_mul_f32 v81, v81, v55
  v_exp_f32 v78, v78
  v_exp_f32 v79, v79
  v_exp_f32 v80, v80
  v_exp_f32 v81, v81
  v_add_f32 v78, 1.0, v78
  v_add_f32 v79, 1.0, v79
  v_add_f32 v80, 1.0, v80
  v_add_f32 v81, 1.0, v81
  v_rcp_f32 v78, v78
  v_rcp_f32 v79, v79
  v_rcp_f32 v80, v80
  v_rcp_f32 v81, v81
  v_mul_f32 v52, v52, v78
  v_mul_f32 v53, v53, v79
  v_mul_f32 v54, v54, v80
  v_mul_f32 v55, v55, v81
  v_cvt_pk_bf16_f32 v50, v52, v53
  v_cvt_pk_bf16_f32 v51, v54, v55
  s_nop 1
  v_permlane16_swap_b32 v48, v50
  v_permlane16_swap_b32 v49, v51
  buffer_store_dwordx4 v[48:51], v119, s[12:15], s35 offen sc1
  s_add_u32 s35, s34, 149504
  v_mul_f32 v78, v56, v56
  v_mul_f32 v79, v57, v57
  v_mul_f32 v80, v58, v58
  v_mul_f32 v81, v59, v59
  v_fma_f32 v78, v78, s37, v120
  v_fma_f32 v79, v79, s37, v120
  v_fma_f32 v80, v80, s37, v120
  v_fma_f32 v81, v81, s37, v120
  v_mul_f32 v78, v78, v56
  v_mul_f32 v79, v79, v57
  v_mul_f32 v80, v80, v58
  v_mul_f32 v81, v81, v59
  v_exp_f32 v78, v78
  v_exp_f32 v79, v79
  v_exp_f32 v80, v80
  v_exp_f32 v81, v81
  v_add_f32 v78, 1.0, v78
  v_add_f32 v79, 1.0, v79
  v_add_f32 v80, 1.0, v80
  v_add_f32 v81, 1.0, v81
  v_rcp_f32 v78, v78
  v_rcp_f32 v79, v79
  v_rcp_f32 v80, v80
  v_rcp_f32 v81, v81
  v_mul_f32 v56, v56, v78
  v_mul_f32 v57, v57, v79
  v_mul_f32 v58, v58, v80
  v_mul_f32 v59, v59, v81
  v_cvt_pk_bf16_f32 v56, v56, v57
  v_cvt_pk_bf16_f32 v57, v58, v59
  v_mul_f32 v78, v60, v60
  v_mul_f32 v79, v61, v61
  v_mul_f32 v80, v62, v62
  v_mul_f32 v81, v63, v63
  v_fma_f32 v78, v78, s37, v120
  v_fma_f32 v79, v79, s37, v120
  v_fma_f32 v80, v80, s37, v120
  v_fma_f32 v81, v81, s37, v120
  v_mul_f32 v78, v78, v60
  v_mul_f32 v79, v79, v61
  v_mul_f32 v80, v80, v62
  v_mul_f32 v81, v81, v63
  v_exp_f32 v78, v78
  v_exp_f32 v79, v79
  v_exp_f32 v80, v80
  v_exp_f32 v81, v81
  v_add_f32 v78, 1.0, v78
  v_add_f32 v79, 1.0, v79
  v_add_f32 v80, 1.0, v80
  v_add_f32 v81, 1.0, v81
  v_rcp_f32 v78, v78
  v_rcp_f32 v79, v79
  v_rcp_f32 v80, v80
  v_rcp_f32 v81, v81
  v_mul_f32 v60, v60, v78
  v_mul_f32 v61, v61, v79
  v_mul_f32 v62, v62, v80
  v_mul_f32 v63, v63, v81
  v_cvt_pk_bf16_f32 v58, v60, v61
  v_cvt_pk_bf16_f32 v59, v62, v63
  s_nop 1
  v_permlane16_swap_b32 v56, v58
  v_permlane16_swap_b32 v57, v59
  buffer_store_dwordx4 v[56:59], v119, s[12:15], s35 offen sc1
  s_add_u32 s35, s34, 150528
  v_mul_f32 v78, v64, v64
  v_mul_f32 v79, v65, v65
  v_mul_f32 v80, v66, v66
  v_mul_f32 v81, v67, v67
  v_fma_f32 v78, v78, s37, v120
  v_fma_f32 v79, v79, s37, v120
  v_fma_f32 v80, v80, s37, v120
  v_fma_f32 v81, v81, s37, v120
  v_mul_f32 v78, v78, v64
  v_mul_f32 v79, v79, v65
  v_mul_f32 v80, v80, v66
  v_mul_f32 v81, v81, v67
  v_exp_f32 v78, v78
  v_exp_f32 v79, v79
  v_exp_f32 v80, v80
  v_exp_f32 v81, v81
  v_add_f32 v78, 1.0, v78
  v_add_f32 v79, 1.0, v79
  v_add_f32 v80, 1.0, v80
  v_add_f32 v81, 1.0, v81
  v_rcp_f32 v78, v78
  v_rcp_f32 v79, v79
  v_rcp_f32 v80, v80
  v_rcp_f32 v81, v81
  v_mul_f32 v64, v64, v78
  v_mul_f32 v65, v65, v79
  v_mul_f32 v66, v66, v80
  v_mul_f32 v67, v67, v81
  v_cvt_pk_bf16_f32 v64, v64, v65
  v_cvt_pk_bf16_f32 v65, v66, v67
  v_mul_f32 v78, v68, v68
  v_mul_f32 v79, v69, v69
  v_mul_f32 v80, v70, v70
  v_mul_f32 v81, v71, v71
  v_fma_f32 v78, v78, s37, v120
  v_fma_f32 v79, v79, s37, v120
  v_fma_f32 v80, v80, s37, v120
  v_fma_f32 v81, v81, s37, v120
  v_mul_f32 v78, v78, v68
  v_mul_f32 v79, v79, v69
  v_mul_f32 v80, v80, v70
  v_mul_f32 v81, v81, v71
  v_exp_f32 v78, v78
  v_exp_f32 v79, v79
  v_exp_f32 v80, v80
  v_exp_f32 v81, v81
  v_add_f32 v78, 1.0, v78
  v_add_f32 v79, 1.0, v79
  v_add_f32 v80, 1.0, v80
  v_add_f32 v81, 1.0, v81
  v_rcp_f32 v78, v78
  v_rcp_f32 v79, v79
  v_rcp_f32 v80, v80
  v_rcp_f32 v81, v81
  v_mul_f32 v68, v68, v78
  v_mul_f32 v69, v69, v79
  v_mul_f32 v70, v70, v80
  v_mul_f32 v71, v71, v81
  v_cvt_pk_bf16_f32 v66, v68, v69
  v_cvt_pk_bf16_f32 v67, v70, v71
  s_nop 1
  v_permlane16_swap_b32 v64, v66
  v_permlane16_swap_b32 v65, v67
  buffer_store_dwordx4 v[64:67], v119, s[12:15], s35 offen sc1
  s_add_u32 s35, s34, 151552
  v_mul_f32 v78, v72, v72
  v_mul_f32 v79, v73, v73
  v_mul_f32 v80, v74, v74
  v_mul_f32 v81, v75, v75
  v_fma_f32 v78, v78, s37, v120
  v_fma_f32 v79, v79, s37, v120
  v_fma_f32 v80, v80, s37, v120
  v_fma_f32 v81, v81, s37, v120
  v_mul_f32 v78, v78, v72
  v_mul_f32 v79, v79, v73
  v_mul_f32 v80, v80, v74
  v_mul_f32 v81, v81, v75
  v_exp_f32 v78, v78
  v_exp_f32 v79, v79
  v_exp_f32 v80, v80
  v_exp_f32 v81, v81
  v_add_f32 v78, 1.0, v78
  v_add_f32 v79, 1.0, v79
  v_add_f32 v80, 1.0, v80
  v_add_f32 v81, 1.0, v81
  v_rcp_f32 v78, v78
  v_rcp_f32 v79, v79
  v_rcp_f32 v80, v80
  v_rcp_f32 v81, v81
  v_mul_f32 v72, v72, v78
  v_mul_f32 v73, v73, v79
  v_mul_f32 v74, v74, v80
  v_mul_f32 v75, v75, v81
  v_cvt_pk_bf16_f32 v72, v72, v73
  v_cvt_pk_bf16_f32 v73, v74, v75
  buffer_store_dwordx2 v[72:73], v76, s[12:15], s35 offen sc1
  s_endpgm
gemm1_kernel_att2:
  v_subrev_u32 v0, 512, v0
  s_cmp_ge_u32 s2, 160
  s_cbranch_scc1 gemm1_kernel_pf13
  s_load_dwordx2 s[4:5], s[0:1], 96
  s_load_dwordx2 s[8:9], s[0:1], 8
  s_load_dwordx2 s[12:13], s[0:1], 96
  s_load_dwordx2 s[16:17], s[0:1], 96
  s_load_dwordx2 s[20:21], s[0:1], 96
  s_waitcnt lgkmcnt(0)
  s_mov_b32 s6, 2359296
  s_mov_b32 s7, 0x00020000
  s_mov_b32 s10, 663552
  s_mov_b32 s11, 0x00020000
  s_add_u32 s12, s12, 4718592
  s_addc_u32 s13, s13, 0
  s_mov_b32 s14, 2359296
  s_mov_b32 s15, 0x00020000
  s_add_u32 s16, s16, 9437184
  s_addc_u32 s17, s17, 0
  s_mov_b32 s18, 73728
  s_mov_b32 s19, 0x00020000
  s_add_u32 s20, s20, 9510912
  s_addc_u32 s21, s21, 0
  s_mov_b32 s22, 212992
  s_mov_b32 s23, 0x00020000
  s_cmp_ge_u32 s2, 128
  s_cbranch_scc1 gemm1_kernel_kv12
  s_lshr_b32 s30, s2, 2
  s_and_b32 s31, s2, 3
  s_mul_i32 s32, s30, 73728
  s_mul_i32 s33, s31, 288
  v_lshrrev_b32 v93, 6, v0
  s_nop 0
  v_readfirstlane_b32 s40, v93
  v_and_b32 v94, 63, v0
  s_nop 2
  s_mov_b32 s41, s40
  s_mov_b32 s42, 0
  v_lshrrev_b32 v93, 3, v94
  s_mov_b32 s46, 1152
  v_mul_lo_u32 v93, v93, s46
  v_lshrrev_b32 v95, 4, v94
  v_and_b32 v96, 7, v94
  v_xor_b32 v95, v95, v96
  v_lshl_add_u32 v86, v95, 4, v93
  v_xor_b32 v95, 4, v95
  v_lshl_add_u32 v87, v95, 4, v93
  s_mul_i32 s43, s40, 18432
  s_add_u32 s43, s43, s32
  s_mul_i32 s44, s40, 2048
  s_lshl_b32 s45, s40, 10
  s_add_u32 s45, s45, 8192
  s_lshl_b32 s46, s40, 6
  s_add_u32 s46, s46, 0
  v_add_u32 v93, s46, v94
  s_mov_b32 s46, 863
  v_mul_lo_u32 v95, v93, s46
  v_lshrrev_b32 v95, 17, v95
  v_mul_u32_u24 v96, 152, v95
  v_sub_u32 v93, v93, v96
  v_mul_u32_u24 v96, 57, v93
  v_lshrrev_b32 v96, 10, v96
  v_mul_u32_u24 v88, 18, v96
  v_sub_u32 v88, v93, v88
  v_lshlrev_b32 v88, 4, v88
  v_lshl_add_u32 v96, v95, 3, v96
  s_mov_b32 s46, 1152
  v_mul_lo_u32 v96, v96, s46
  v_add_u32 v88, v88, v96
  v_cmp_gt_u32 vcc, 144, v93
  v_cmp_gt_u32 s[48:49], 8, v95
  s_nop 1
  s_and_b64 vcc, vcc, s[48:49]
  v_mov_b32 v96, 0x80000000
  s_nop 1
  v_cndmask_b32 v88, v96, v88, vcc
  s_lshl_b32 s46, s40, 6
  s_add_u32 s46, s46, 256
  v_add_u32 v93, s46, v94
  s_mov_b32 s46, 863
  v_mul_lo_u32 v95, v93, s46
  v_lshrrev_b32 v95, 17, v95
  v_mul_u32_u24 v96, 152, v95
  v_sub_u32 v93, v93, v96
  v_mul_u32_u24 v96, 57, v93
  v_lshrrev_b32 v96, 10, v96
  v_mul_u32_u24 v89, 18, v96
  v_sub_u32 v89, v93, v89
  v_lshlrev_b32 v89, 4, v89
  v_lshl_add_u32 v96, v95, 3, v96
  s_mov_b32 s46, 1152
  v_mul_lo_u32 v96, v96, s46
  v_add_u32 v89, v89, v96
  v_cmp_gt_u32 vcc, 144, v93
  v_cmp_gt_u32 s[48:49], 8, v95
  s_nop 1
  s_and_b64 vcc, vcc, s[48:49]
  v_mov_b32 v96, 0x80000000
  s_nop 1
  v_cndmask_b32 v89, v96, v89, vcc
  s_lshl_b32 s46, s40, 6
  s_add_u32 s46, s46, 512
  v_add_u32 v93, s46, v94
  s_mov_b32 s46, 863
  v_mul_lo_u32 v95, v93, s46
  v_lshrrev_b32 v95, 17, v95
  v_mul_u32_u24 v96, 152, v95
  v_sub_u32 v93, v93, v96
  v_mul_u32_u24 v96, 57, v93
  v_lshrrev_b32 v96, 10, v96
  v_mul_u32_u24 v90, 18, v96
  v_sub_u32 v90, v93, v90
  v_lshlrev_b32 v90, 4, v90
  v_lshl_add_u32 v96, v95, 3, v96
  s_mov_b32 s46, 1152
  v_mul_lo_u32 v96, v96, s46
  v_add_u32 v90, v90, v96
  v_cmp_gt_u32 vcc, 144, v93
  v_cmp_gt_u32 s[48:49], 8, v95
  s_nop 1
  s_and_b64 vcc, vcc, s[48:49]
  v_mov_b32 v96, 0x80000000
  s_nop 1
  v_cndmask_b32 v90, v96, v90, vcc
  s_lshl_b32 s46, s40, 6
  s_add_u32 s46, s46, 768
  v_add_u32 v93, s46, v94
  s_mov_b32 s46, 863
  v_mul_lo_u32 v95, v93, s46
  v_lshrrev_b32 v95, 17, v95
  v_mul_u32_u24 v96, 152, v95
  v_sub_u32 v93, v93, v96
  v_mul_u32_u24 v96, 57, v93
  v_lshrrev_b32 v96, 10, v96
  v_mul_u32_u24 v91, 18, v96
  v_sub_u32 v91, v93, v91
  v_lshlrev_b32 v91, 4, v91
  v_lshl_add_u32 v96, v95, 3, v96
  s_mov_b32 s46, 1152
  v_mul_lo_u32 v96, v96, s46
  v_add_u32 v91, v91, v96
  v_cmp_gt_u32 vcc, 144, v93
  v_cmp_gt_u32 s[48:49], 8, v95
  s_nop 1
  s_and_b64 vcc, vcc, s[48:49]
  v_mov_b32 v96, 0x80000000
  s_nop 1
  v_cndmask_b32 v91, v96, v91, vcc
  s_lshl_b32 s46, s40, 6
  s_add_u32 s46, s46, 1024
  v_add_u32 v93, s46, v94
  s_mov_b32 s46, 863
  v_mul_lo_u32 v95, v93, s46
  v_lshrrev_b32 v95, 17, v95
  v_mul_u32_u24 v96, 152, v95
  v_sub_u32 v93, v93, v96
  v_mul_u32_u24 v96, 57, v93
  v_lshrrev_b32 v96, 10, v96
  v_mul_u32_u24 v92, 18, v96
  v_sub_u32 v92, v93, v92
  v_lshlrev_b32 v92, 4, v92
  v_lshl_add_u32 v96, v95, 3, v96
  s_mov_b32 s46, 1152
  v_mul_lo_u32 v96, v96, s46
  v_add_u32 v92, v92, v96
  v_cmp_gt_u32 vcc, 144, v93
  v_cmp_gt_u32 s[48:49], 8, v95
  s_nop 1
  s_and_b64 vcc, vcc, s[48:49]
  v_mov_b32 v96, 0x80000000
  s_nop 1
  v_cndmask_b32 v92, v96, v92, vcc
  s_add_u32 m0, s44, 104448
  s_add_u32 s46, s43, 0
  buffer_load_dwordx4 v86, s[4:7], s46 offen lds
  s_add_u32 m0, s44, 105472
  s_add_u32 s46, s43, 9216
  buffer_load_dwordx4 v87, s[4:7], s46 offen lds
  s_add_u32 m0, s45, 104448
  s_add_u32 s46, s33, 0
  buffer_load_dwordx4 v88, s[8:11], s46 offen lds
  s_add_u32 m0, s45, 108544
  s_add_u32 s46, s33, 0
  buffer_load_dwordx4 v89, s[8:11], s46 offen lds
  s_add_u32 m0, s45, 112640
  s_add_u32 s46, s33, 0
  buffer_load_dwordx4 v90, s[8:11], s46 offen lds
  s_add_u32 m0, s45, 116736
  s_add_u32 s46, s33, 0
  buffer_load_dwordx4 v91, s[8:11], s46 offen lds
  s_cmp_ge_u32 s40, 3
  s_cbranch_scc1 gemm1_kernel_wsk14
  s_add_u32 m0, s45, 120832
  s_add_u32 s46, s33, 0
  buffer_load_dwordx4 v92, s[8:11], s46 offen lds
  gemm1_kernel_wsk14:
  v_and_b32 v93, 15, v94
  v_lshrrev_b32 v95, 4, v94
  v_lshrrev_b32 v96, 1, v93
  v_xor_b32 v96, v96, v95
  v_lshlrev_b32 v93, 7, v93
  v_lshl_add_u32 v80, v96, 4, v93
  s_mul_i32 s46, s41, 2048
  v_add_u32 v80, s46, v80
  v_xor_b32 v81, 64, v80
  v_bfe_u32 v93, v94, 2, 2
  v_lshl_add_u32 v93, v95, 3, v93
  v_mul_u32_u24 v93, 288, v93
  v_mul_u32_u24 v96, 128, v95
  v_add_u32 v93, v93, v96
  v_and_b32 v96, 3, v94
  v_lshl_add_u32 v84, v96, 3, v93
  s_mov_b32 s46, 8192
  v_add_u32 v84, s46, v84
  v_add_u32 v80, 104448, v80
  v_add_u32 v81, 104448, v81
  v_add_u32 v84, 104448, v84
  v_add_u32 v82, 27648, v80
  v_add_u32 v83, 27648, v81
  v_add_u32 v85, 27648, v84
  v_mov_b32 v4, 0
  v_mov_b32 v5, 0
  v_mov_b32 v6, 0
  v_mov_b32 v7, 0
  v_mov_b32 v8, 0
  v_mov_b32 v9, 0
  v_mov_b32 v10, 0
  v_mov_b32 v11, 0
  v_mov_b32 v12, 0
  v_mov_b32 v13, 0
  v_mov_b32 v14, 0
  v_mov_b32 v15, 0
  v_mov_b32 v16, 0
  v_mov_b32 v17, 0
  v_mov_b32 v18, 0
  v_mov_b32 v19, 0
  v_mov_b32 v20, 0
  v_mov_b32 v21, 0
  v_mov_b32 v22, 0
  v_mov_b32 v23, 0
  v_mov_b32 v24, 0
  v_mov_b32 v25, 0
  v_mov_b32 v26, 0
  v_mov_b32 v27, 0
  v_mov_b32 v28, 0
  v_mov_b32 v29, 0
  v_mov_b32 v30, 0
  v_mov_b32 v31, 0
  v_mov_b32 v32, 0
  v_mov_b32 v33, 0
  v_mov_b32 v34, 0
  v_mov_b32 v35, 0
  v_mov_b32 v36, 0
  v_mov_b32 v37, 0
  v_mov_b32 v38, 0
  v_mov_b32 v39, 0
  s_waitcnt vmcnt(0)
  s_barrier
  ds_read_b64_tr_b16 v[48:49], v84 offset:0
  ds_read_b64_tr_b16 v[50:51], v84 offset:1152
  ds_read_b128 v[40:43], v80 offset:0
  ds_read_b64_tr_b16 v[52:53], v84 offset:32
  ds_read_b64_tr_b16 v[54:55], v84 offset:1184
  ds_read_b64_tr_b16 v[56:57], v84 offset:64
  ds_read_b64_tr_b16 v[58:59], v84 offset:1216
  ds_read_b64_tr_b16 v[60:61], v84 offset:96
  ds_read_b64_tr_b16 v[62:63], v84 offset:1248
  ds_read_b64_tr_b16 v[64:65], v84 offset:128
  ds_read_b64_tr_b16 v[66:67], v84 offset:1280
  ds_read_b64_tr_b16 v[68:69], v84 offset:160
  ds_read_b64_tr_b16 v[70:71], v84 offset:1312
  ds_read_b64_tr_b16 v[72:73], v84 offset:192
  ds_read_b64_tr_b16 v[74:75], v84 offset:1344
  ds_read_b64_tr_b16 v[76:77], v84 offset:224
  ds_read_b64_tr_b16 v[78:79], v84 offset:1376
  s_add_u32 m0, s44, 132096
  s_add_u32 s46, s43, 128
  buffer_load_dwordx4 v86, s[4:7], s46 offen lds
  s_waitcnt lgkmcnt(14)
  v_mfma_f32_16x16x32_bf16 v[4:7], v[48:51], v[40:43], v[4:7]
  ds_read_b64_tr_b16 v[48:49], v84 offset:256
  ds_read_b64_tr_b16 v[50:51], v84 offset:1408
  s_add_u32 m0, s44, 133120
  s_add_u32 s46, s43, 9344
  buffer_load_dwordx4 v87, s[4:7], s46 offen lds
  s_waitcnt lgkmcnt(14)
  v_mfma_f32_16x16x32_bf16 v[8:11], v[52:55], v[40:43], v[8:11]
  ds_read_b64_tr_b16 v[52:53], v84 offset:9728
  ds_read_b64_tr_b16 v[54:55], v84 offset:10880
  ds_read_b128 v[44:47], v81 offset:0
  s_add_u32 m0, s45, 132096
  s_add_u32 s46, s33, 73728
  buffer_load_dwordx4 v88, s[8:11], s46 offen lds
  s_waitcnt lgkmcnt(15)
  v_mfma_f32_16x16x32_bf16 v[12:15], v[56:59], v[40:43], v[12:15]
  ds_read_b64_tr_b16 v[56:57], v84 offset:9760
  ds_read_b64_tr_b16 v[58:59], v84 offset:10912
  s_add_u32 m0, s45, 136192
  s_add_u32 s46, s33, 73728
  buffer_load_dwordx4 v89, s[8:11], s46 offen lds
  s_waitcnt lgkmcnt(15)
  v_mfma_f32_16x16x32_bf16 v[16:19], v[60:63], v[40:43], v[16:19]
  ds_read_b64_tr_b16 v[60:61], v84 offset:9792
  ds_read_b64_tr_b16 v[62:63], v84 offset:10944
  s_add_u32 m0, s45, 140288
  s_add_u32 s46, s33, 73728
  buffer_load_dwordx4 v90, s[8:11], s46 offen lds
  s_waitcnt lgkmcnt(15)
  v_mfma_f32_16x16x32_bf16 v[20:23], v[64:67], v[40:43], v[20:23]
  ds_read_b64_tr_b16 v[64:65], v84 offset:9824
  ds_read_b64_tr_b16 v[66:67], v84 offset:10976
  s_add_u32 m0, s45, 144384
  s_add_u32 s46, s33, 73728
  buffer_load_dwordx4 v91, s[8:11], s46 offen lds
  s_waitcnt lgkmcnt(15)
  v_mfma_f32_16x16x32_bf16 v[24:27], v[68:71], v[40:43], v[24:27]
  ds_read_b64_tr_b16 v[68:69], v84 offset:9856
  ds_read_b64_tr_b16 v[70:71], v84 offset:11008
  s_cmp_ge_u32 s40, 3
  s_cbranch_scc1 gemm1_kernel_wsk15
  s_add_u32 m0, s45, 148480
  s_add_u32 s46, s33, 73728
  buffer_load_dwordx4 v92, s[8:11], s46 offen lds
  gemm1_kernel_wsk15:
  s_waitcnt lgkmcnt(15)
  v_mfma_f32_16x16x32_bf16 v[28:31], v[72:75], v[40:43], v[28:31]
  ds_read_b64_tr_b16 v[72:73], v84 offset:9888
  ds_read_b64_tr_b16 v[74:75], v84 offset:11040
  s_waitcnt lgkmcnt(15)
  v_mfma_f32_16x16x32_bf16 v[32:35], v[76:79], v[40:43], v[32:35]
  ds_read_b64_tr_b16 v[76:77], v84 offset:9920
  ds_read_b64_tr_b16 v[78:79], v84 offset:11072
  s_waitcnt lgkmcnt(15)
  v_mfma_f32_16x16x32_bf16 v[36:39], v[48:51], v[40:43], v[36:39]
  ds_read_b64_tr_b16 v[48:49], v84 offset:9952
  ds_read_b64_tr_b16 v[50:51], v84 offset:11104
  s_waitcnt lgkmcnt(14)
  v_mfma_f32_16x16x32_bf16 v[4:7], v[52:55], v[44:47], v[4:7]
  ds_read_b64_tr_b16 v[52:53], v84 offset:9984
  ds_read_b64_tr_b16 v[54:55], v84 offset:11136
  s_waitcnt lgkmcnt(14)
  v_mfma_f32_16x16x32_bf16 v[8:11], v[56:59], v[44:47], v[8:11]
  s_waitcnt lgkmcnt(12)
  v_mfma_f32_16x16x32_bf16 v[12:15], v[60:63], v[44:47], v[12:15]
  s_waitcnt lgkmcnt(10)
  v_mfma_f32_16x16x32_bf16 v[16:19], v[64:67], v[44:47], v[16:19]
  s_waitcnt lgkmcnt(8)
  v_mfma_f32_16x16x32_bf16 v[20:23], v[68:71], v[44:47], v[20:23]
  s_waitcnt lgkmcnt(6)
  v_mfma_f32_16x16x32_bf16 v[24:27], v[72:75], v[44:47], v[24:27]
  s_waitcnt lgkmcnt(4)
  v_mfma_f32_16x16x32_bf16 v[28:31], v[76:79], v[44:47], v[28:31]
  s_waitcnt lgkmcnt(2)
  v_mfma_f32_16x16x32_bf16 v[32:35], v[48:51], v[44:47], v[32:35]
  s_waitcnt lgkmcnt(0)
  v_mfma_f32_16x16x32_bf16 v[36:39], v[52:55], v[44:47], v[36:39]
  s_waitcnt vmcnt(0)
  s_barrier
  ds_read_b64_tr_b16 v[48:49], v85 offset:0
  ds_read_b64_tr_b16 v[50:51], v85 offset:1152
  ds_read_b128 v[40:43], v82 offset:0
  ds_read_b64_tr_b16 v[52:53], v85 offset:32
  ds_read_b64_tr_b16 v[54:55], v85 offset:1184
  ds_read_b64_tr_b16 v[56:57], v85 offset:64
  ds_read_b64_tr_b16 v[58:59], v85 offset:1216
  ds_read_b64_tr_b16 v[60:61], v85 offset:96
  ds_read_b64_tr_b16 v[62:63], v85 offset:1248
  ds_read_b64_tr_b16 v[64:65], v85 offset:128
  ds_read_b64_tr_b16 v[66:67], v85 offset:1280
  ds_read_b64_tr_b16 v[68:69], v85 offset:160
  ds_read_b64_tr_b16 v[70:71], v85 offset:1312
  ds_read_b64_tr_b16 v[72:73], v85 offset:192
  ds_read_b64_tr_b16 v[74:75], v85 offset:1344
  ds_read_b64_tr_b16 v[76:77], v85 offset:224
  ds_read_b64_tr_b16 v[78:79], v85 offset:1376
  s_add_u32 m0, s44, 104448
  s_add_u32 s46, s43, 256
  buffer_load_dwordx4 v86, s[4:7], s46 offen lds
  s_waitcnt lgkmcnt(14)
  v_mfma_f32_16x16x32_bf16 v[4:7], v[48:51], v[40:43], v[4:7]
  ds_read_b64_tr_b16 v[48:49], v85 offset:256
  ds_read_b64_tr_b16 v[50:51], v85 offset:1408
  s_add_u32 m0, s44, 105472
  s_add_u32 s46, s43, 9472
  buffer_load_dwordx4 v87, s[4:7], s46 offen lds
  s_waitcnt lgkmcnt(14)
  v_mfma_f32_16x16x32_bf16 v[8:11], v[52:55], v[40:43], v[8:11]
  ds_read_b64_tr_b16 v[52:53], v85 offset:9728
  ds_read_b64_tr_b16 v[54:55], v85 offset:10880
  ds_read_b128 v[44:47], v83 offset:0
  s_add_u32 m0, s45, 104448
  s_add_u32 s46, s33, 147456
  buffer_load_dwordx4 v88, s[8:11], s46 offen lds
  s_waitcnt lgkmcnt(15)
  v_mfma_f32_16x16x32_bf16 v[12:15], v[56:59], v[40:43], v[12:15]
  ds_read_b64_tr_b16 v[56:57], v85 offset:9760
  ds_read_b64_tr_b16 v[58:59], v85 offset:10912
  s_add_u32 m0, s45, 108544
  s_add_u32 s46, s33, 147456
  buffer_load_dwordx4 v89, s[8:11], s46 offen lds
  s_waitcnt lgkmcnt(15)
  v_mfma_f32_16x16x32_bf16 v[16:19], v[60:63], v[40:43], v[16:19]
  ds_read_b64_tr_b16 v[60:61], v85 offset:9792
  ds_read_b64_tr_b16 v[62:63], v85 offset:10944
  s_add_u32 m0, s45, 112640
  s_add_u32 s46, s33, 147456
  buffer_load_dwordx4 v90, s[8:11], s46 offen lds
  s_waitcnt lgkmcnt(15)
  v_mfma_f32_16x16x32_bf16 v[20:23], v[64:67], v[40:43], v[20:23]
  ds_read_b64_tr_b16 v[64:65], v85 offset:9824
  ds_read_b64_tr_b16 v[66:67], v85 offset:10976
  s_add_u32 m0, s45, 116736
  s_add_u32 s46, s33, 147456
  buffer_load_dwordx4 v91, s[8:11], s46 offen lds
  s_waitcnt lgkmcnt(15)
  v_mfma_f32_16x16x32_bf16 v[24:27], v[68:71], v[40:43], v[24:27]
  ds_read_b64_tr_b16 v[68:69], v85 offset:9856
  ds_read_b64_tr_b16 v[70:71], v85 offset:11008
  s_cmp_ge_u32 s40, 3
  s_cbranch_scc1 gemm1_kernel_wsk16
  s_add_u32 m0, s45, 120832
  s_add_u32 s46, s33, 147456
  buffer_load_dwordx4 v92, s[8:11], s46 offen lds
  gemm1_kernel_wsk16:
  s_waitcnt lgkmcnt(15)
  v_mfma_f32_16x16x32_bf16 v[28:31], v[72:75], v[40:43], v[28:31]
  ds_read_b64_tr_b16 v[72:73], v85 offset:9888
  ds_read_b64_tr_b16 v[74:75], v85 offset:11040
  s_waitcnt lgkmcnt(15)
  v_mfma_f32_16x16x32_bf16 v[32:35], v[76:79], v[40:43], v[32:35]
  ds_read_b64_tr_b16 v[76:77], v85 offset:9920
  ds_read_b64_tr_b16 v[78:79], v85 offset:11072
  s_waitcnt lgkmcnt(15)
  v_mfma_f32_16x16x32_bf16 v[36:39], v[48:51], v[40:43], v[36:39]
  ds_read_b64_tr_b16 v[48:49], v85 offset:9952
  ds_read_b64_tr_b16 v[50:51], v85 offset:11104
  s_waitcnt lgkmcnt(14)
  v_mfma_f32_16x16x32_bf16 v[4:7], v[52:55], v[44:47], v[4:7]
  ds_read_b64_tr_b16 v[52:53], v85 offset:9984
  ds_read_b64_tr_b16 v[54:55], v85 offset:11136
  s_waitcnt lgkmcnt(14)
  v_mfma_f32_16x16x32_bf16 v[8:11], v[56:59], v[44:47], v[8:11]
  s_waitcnt lgkmcnt(12)
  v_mfma_f32_16x16x32_bf16 v[12:15], v[60:63], v[44:47], v[12:15]
  s_waitcnt lgkmcnt(10)
  v_mfma_f32_16x16x32_bf16 v[16:19], v[64:67], v[44:47], v[16:19]
  s_waitcnt lgkmcnt(8)
  v_mfma_f32_16x16x32_bf16 v[20:23], v[68:71], v[44:47], v[20:23]
  s_waitcnt lgkmcnt(6)
  v_mfma_f32_16x16x32_bf16 v[24:27], v[72:75], v[44:47], v[24:27]
  s_waitcnt lgkmcnt(4)
  v_mfma_f32_16x16x32_bf16 v[28:31], v[76:79], v[44:47], v[28:31]
  s_waitcnt lgkmcnt(2)
  v_mfma_f32_16x16x32_bf16 v[32:35], v[48:51], v[44:47], v[32:35]
  s_waitcnt lgkmcnt(0)
  v_mfma_f32_16x16x32_bf16 v[36:39], v[52:55], v[44:47], v[36:39]
  s_waitcnt vmcnt(0)
  s_barrier
  ds_read_b64_tr_b16 v[48:49], v84 offset:0
  ds_read_b64_tr_b16 v[50:51], v84 offset:1152
  ds_read_b128 v[40:43], v80 offset:0
  ds_read_b64_tr_b16 v[52:53], v84 offset:32
  ds_read_b64_tr_b16 v[54:55], v84 offset:1184
  ds_read_b64_tr_b16 v[56:57], v84 offset:64
  ds_read_b64_tr_b16 v[58:59], v84 offset:1216
  ds_read_b64_tr_b16 v[60:61], v84 offset:96
  ds_read_b64_tr_b16 v[62:63], v84 offset:1248
  ds_read_b64_tr_b16 v[64:65], v84 offset:128
  ds_read_b64_tr_b16 v[66:67], v84 offset:1280
  ds_read_b64_tr_b16 v[68:69], v84 offset:160
  ds_read_b64_tr_b16 v[70:71], v84 offset:1312
  ds_read_b64_tr_b16 v[72:73], v84 offset:192
  ds_read_b64_tr_b16 v[74:75], v84 offset:1344
  ds_read_b64_tr_b16 v[76:77], v84 offset:224
  ds_read_b64_tr_b16 v[78:79], v84 offset:1376
  s_add_u32 m0, s44, 132096
  s_add_u32 s46, s43, 384
  buffer_load_dwordx4 v86, s[4:7], s46 offen lds
  s_waitcnt lgkmcnt(14)
  v_mfma_f32_16x16x32_bf16 v[4:7], v[48:51], v[40:43], v[4:7]
  ds_read_b64_tr_b16 v[48:49], v84 offset:256
  ds_read_b64_tr_b16 v[50:51], v84 offset:1408
  s_add_u32 m0, s44, 133120
  s_add_u32 s46, s43, 9600
  buffer_load_dwordx4 v87, s[4:7], s46 offen lds
  s_waitcnt lgkmcnt(14)
  v_mfma_f32_16x16x32_bf16 v[8:11], v[52:55], v[40:43], v[8:11]
  ds_read_b64_tr_b16 v[52:53], v84 offset:9728
  ds_read_b64_tr_b16 v[54:55], v84 offset:10880
  ds_read_b128 v[44:47], v81 offset:0
  s_add_u32 m0, s45, 132096
  s_add_u32 s46, s33, 221184
  buffer_load_dwordx4 v88, s[8:11], s46 offen lds
  s_waitcnt lgkmcnt(15)
  v_mfma_f32_16x16x32_bf16 v[12:15], v[56:59], v[40:43], v[12:15]
  ds_read_b64_tr_b16 v[56:57], v84 offset:9760
  ds_read_b64_tr_b16 v[58:59], v84 offset:10912
  s_add_u32 m0, s45, 136192
  s_add_u32 s46, s33, 221184
  buffer_load_dwordx4 v89, s[8:11], s46 offen lds
  s_waitcnt lgkmcnt(15)
  v_mfma_f32_16x16x32_bf16 v[16:19], v[60:63], v[40:43], v[16:19]
  ds_read_b64_tr_b16 v[60:61], v84 offset:9792
  ds_read_b64_tr_b16 v[62:63], v84 offset:10944
  s_add_u32 m0, s45, 140288
  s_add_u32 s46, s33, 221184
  buffer_load_dwordx4 v90, s[8:11], s46 offen lds
  s_waitcnt lgkmcnt(15)
  v_mfma_f32_16x16x32_bf16 v[20:23], v[64:67], v[40:43], v[20:23]
  ds_read_b64_tr_b16 v[64:65], v84 offset:9824
  ds_read_b64_tr_b16 v[66:67], v84 offset:10976
  s_add_u32 m0, s45, 144384
  s_add_u32 s46, s33, 221184
  buffer_load_dwordx4 v91, s[8:11], s46 offen lds
  s_waitcnt lgkmcnt(15)
  v_mfma_f32_16x16x32_bf16 v[24:27], v[68:71], v[40:43], v[24:27]
  ds_read_b64_tr_b16 v[68:69], v84 offset:9856
  ds_read_b64_tr_b16 v[70:71], v84 offset:11008
  s_cmp_ge_u32 s40, 3
  s_cbranch_scc1 gemm1_kernel_wsk17
  s_add_u32 m0, s45, 148480
  s_add_u32 s46, s33, 221184
  buffer_load_dwordx4 v92, s[8:11], s46 offen lds
  gemm1_kernel_wsk17:
  s_waitcnt lgkmcnt(15)
  v_mfma_f32_16x16x32_bf16 v[28:31], v[72:75], v[40:43], v[28:31]
  ds_read_b64_tr_b16 v[72:73], v84 offset:9888
  ds_read_b64_tr_b16 v[74:75], v84 offset:11040
  s_waitcnt lgkmcnt(15)
  v_mfma_f32_16x16x32_bf16 v[32:35], v[76:79], v[40:43], v[32:35]
  ds_read_b64_tr_b16 v[76:77], v84 offset:9920
  ds_read_b64_tr_b16 v[78:79], v84 offset:11072
  s_waitcnt lgkmcnt(15)
  v_mfma_f32_16x16x32_bf16 v[36:39], v[48:51], v[40:43], v[36:39]
  ds_read_b64_tr_b16 v[48:49], v84 offset:9952
  ds_read_b64_tr_b16 v[50:51], v84 offset:11104
  s_waitcnt lgkmcnt(14)
  v_mfma_f32_16x16x32_bf16 v[4:7], v[52:55], v[44:47], v[4:7]
  ds_read_b64_tr_b16 v[52:53], v84 offset:9984
  ds_read_b64_tr_b16 v[54:55], v84 offset:11136
  s_waitcnt lgkmcnt(14)
  v_mfma_f32_16x16x32_bf16 v[8:11], v[56:59], v[44:47], v[8:11]
  s_waitcnt lgkmcnt(12)
  v_mfma_f32_16x16x32_bf16 v[12:15], v[60:63], v[44:47], v[12:15]
  s_waitcnt lgkmcnt(10)
  v_mfma_f32_16x16x32_bf16 v[16:19], v[64:67], v[44:47], v[16:19]
  s_waitcnt lgkmcnt(8)
  v_mfma_f32_16x16x32_bf16 v[20:23], v[68:71], v[44:47], v[20:23]
  s_waitcnt lgkmcnt(6)
  v_mfma_f32_16x16x32_bf16 v[24:27], v[72:75], v[44:47], v[24:27]
  s_waitcnt lgkmcnt(4)
  v_mfma_f32_16x16x32_bf16 v[28:31], v[76:79], v[44:47], v[28:31]
  s_waitcnt lgkmcnt(2)
  v_mfma_f32_16x16x32_bf16 v[32:35], v[48:51], v[44:47], v[32:35]
  s_waitcnt lgkmcnt(0)
  v_mfma_f32_16x16x32_bf16 v[36:39], v[52:55], v[44:47], v[36:39]
  s_waitcnt vmcnt(0)
  s_barrier
  ds_read_b64_tr_b16 v[48:49], v85 offset:0
  ds_read_b64_tr_b16 v[50:51], v85 offset:1152
  ds_read_b128 v[40:43], v82 offset:0
  ds_read_b64_tr_b16 v[52:53], v85 offset:32
  ds_read_b64_tr_b16 v[54:55], v85 offset:1184
  ds_read_b64_tr_b16 v[56:57], v85 offset:64
  ds_read_b64_tr_b16 v[58:59], v85 offset:1216
  ds_read_b64_tr_b16 v[60:61], v85 offset:96
  ds_read_b64_tr_b16 v[62:63], v85 offset:1248
  ds_read_b64_tr_b16 v[64:65], v85 offset:128
  ds_read_b64_tr_b16 v[66:67], v85 offset:1280
  ds_read_b64_tr_b16 v[68:69], v85 offset:160
  ds_read_b64_tr_b16 v[70:71], v85 offset:1312
  ds_read_b64_tr_b16 v[72:73], v85 offset:192
  ds_read_b64_tr_b16 v[74:75], v85 offset:1344
  ds_read_b64_tr_b16 v[76:77], v85 offset:224
  ds_read_b64_tr_b16 v[78:79], v85 offset:1376
  s_add_u32 m0, s44, 104448
  s_add_u32 s46, s43, 512
  buffer_load_dwordx4 v86, s[4:7], s46 offen lds
  s_waitcnt lgkmcnt(14)
  v_mfma_f32_16x16x32_bf16 v[4:7], v[48:51], v[40:43], v[4:7]
  ds_read_b64_tr_b16 v[48:49], v85 offset:256
  ds_read_b64_tr_b16 v[50:51], v85 offset:1408
  s_add_u32 m0, s44, 105472
  s_add_u32 s46, s43, 9728
  buffer_load_dwordx4 v87, s[4:7], s46 offen lds
  s_waitcnt lgkmcnt(14)
  v_mfma_f32_16x16x32_bf16 v[8:11], v[52:55], v[40:43], v[8:11]
  ds_read_b64_tr_b16 v[52:53], v85 offset:9728
  ds_read_b64_tr_b16 v[54:55], v85 offset:10880
  ds_read_b128 v[44:47], v83 offset:0
  s_add_u32 m0, s45, 104448
  s_add_u32 s46, s33, 294912
  buffer_load_dwordx4 v88, s[8:11], s46 offen lds
  s_waitcnt lgkmcnt(15)
  v_mfma_f32_16x16x32_bf16 v[12:15], v[56:59], v[40:43], v[12:15]
  ds_read_b64_tr_b16 v[56:57], v85 offset:9760
  ds_read_b64_tr_b16 v[58:59], v85 offset:10912
  s_add_u32 m0, s45, 108544
  s_add_u32 s46, s33, 294912
  buffer_load_dwordx4 v89, s[8:11], s46 offen lds
  s_waitcnt lgkmcnt(15)
  v_mfma_f32_16x16x32_bf16 v[16:19], v[60:63], v[40:43], v[16:19]
  ds_read_b64_tr_b16 v[60:61], v85 offset:9792
  ds_read_b64_tr_b16 v[62:63], v85 offset:10944
  s_add_u32 m0, s45, 112640
  s_add_u32 s46, s33, 294912
  buffer_load_dwordx4 v90, s[8:11], s46 offen lds
  s_waitcnt lgkmcnt(15)
  v_mfma_f32_16x16x32_bf16 v[20:23], v[64:67], v[40:43], v[20:23]
  ds_read_b64_tr_b16 v[64:65], v85 offset:9824
  ds_read_b64_tr_b16 v[66:67], v85 offset:10976
  s_add_u32 m0, s45, 116736
  s_add_u32 s46, s33, 294912
  buffer_load_dwordx4 v91, s[8:11], s46 offen lds
  s_waitcnt lgkmcnt(15)
  v_mfma_f32_16x16x32_bf16 v[24:27], v[68:71], v[40:43], v[24:27]
  ds_read_b64_tr_b16 v[68:69], v85 offset:9856
  ds_read_b64_tr_b16 v[70:71], v85 offset:11008
  s_cmp_ge_u32 s40, 3
  s_cbranch_scc1 gemm1_kernel_wsk18
  s_add_u32 m0, s45, 120832
  s_add_u32 s46, s33, 294912
  buffer_load_dwordx4 v92, s[8:11], s46 offen lds
  gemm1_kernel_wsk18:
  s_waitcnt lgkmcnt(15)
  v_mfma_f32_16x16x32_bf16 v[28:31], v[72:75], v[40:43], v[28:31]
  ds_read_b64_tr_b16 v[72:73], v85 offset:9888
  ds_read_b64_tr_b16 v[74:75], v85 offset:11040
  s_waitcnt lgkmcnt(15)
  v_mfma_f32_16x16x32_bf16 v[32:35], v[76:79], v[40:43], v[32:35]
  ds_read_b64_tr_b16 v[76:77], v85 offset:9920
  ds_read_b64_tr_b16 v[78:79], v85 offset:11072
  s_waitcnt lgkmcnt(15)
  v_mfma_f32_16x16x32_bf16 v[36:39], v[48:51], v[40:43], v[36:39]
  ds_read_b64_tr_b16 v[48:49], v85 offset:9952
  ds_read_b64_tr_b16 v[50:51], v85 offset:11104
  s_waitcnt lgkmcnt(14)
  v_mfma_f32_16x16x32_bf16 v[4:7], v[52:55], v[44:47], v[4:7]
  ds_read_b64_tr_b16 v[52:53], v85 offset:9984
  ds_read_b64_tr_b16 v[54:55], v85 offset:11136
  s_waitcnt lgkmcnt(14)
  v_mfma_f32_16x16x32_bf16 v[8:11], v[56:59], v[44:47], v[8:11]
  s_waitcnt lgkmcnt(12)
  v_mfma_f32_16x16x32_bf16 v[12:15], v[60:63], v[44:47], v[12:15]
  s_waitcnt lgkmcnt(10)
  v_mfma_f32_16x16x32_bf16 v[16:19], v[64:67], v[44:47], v[16:19]
  s_waitcnt lgkmcnt(8)
  v_mfma_f32_16x16x32_bf16 v[20:23], v[68:71], v[44:47], v[20:23]
  s_waitcnt lgkmcnt(6)
  v_mfma_f32_16x16x32_bf16 v[24:27], v[72:75], v[44:47], v[24:27]
  s_waitcnt lgkmcnt(4)
  v_mfma_f32_16x16x32_bf16 v[28:31], v[76:79], v[44:47], v[28:31]
  s_waitcnt lgkmcnt(2)
  v_mfma_f32_16x16x32_bf16 v[32:35], v[48:51], v[44:47], v[32:35]
  s_waitcnt lgkmcnt(0)
  v_mfma_f32_16x16x32_bf16 v[36:39], v[52:55], v[44:47], v[36:39]
  s_waitcnt vmcnt(0)
  s_barrier
  ds_read_b64_tr_b16 v[48:49], v84 offset:0
  ds_read_b64_tr_b16 v[50:51], v84 offset:1152
  ds_read_b128 v[40:43], v80 offset:0
  ds_read_b64_tr_b16 v[52:53], v84 offset:32
  ds_read_b64_tr_b16 v[54:55], v84 offset:1184
  ds_read_b64_tr_b16 v[56:57], v84 offset:64
  ds_read_b64_tr_b16 v[58:59], v84 offset:1216
  ds_read_b64_tr_b16 v[60:61], v84 offset:96
  ds_read_b64_tr_b16 v[62:63], v84 offset:1248
  ds_read_b64_tr_b16 v[64:65], v84 offset:128
  ds_read_b64_tr_b16 v[66:67], v84 offset:1280
  ds_read_b64_tr_b16 v[68:69], v84 offset:160
  ds_read_b64_tr_b16 v[70:71], v84 offset:1312
  ds_read_b64_tr_b16 v[72:73], v84 offset:192
  ds_read_b64_tr_b16 v[74:75], v84 offset:1344
  ds_read_b64_tr_b16 v[76:77], v84 offset:224
  ds_read_b64_tr_b16 v[78:79], v84 offset:1376
  s_add_u32 m0, s44, 132096
  s_add_u32 s46, s43, 640
  buffer_load_dwordx4 v86, s[4:7], s46 offen lds
  s_waitcnt lgkmcnt(14)
  v_mfma_f32_16x16x32_bf16 v[4:7], v[48:51], v[40:43], v[4:7]
  ds_read_b64_tr_b16 v[48:49], v84 offset:256
  ds_read_b64_tr_b16 v[50:51], v84 offset:1408
  s_add_u32 m0, s44, 133120
  s_add_u32 s46, s43, 9856
  buffer_load_dwordx4 v87, s[4:7], s46 offen lds
  s_waitcnt lgkmcnt(14)
  v_mfma_f32_16x16x32_bf16 v[8:11], v[52:55], v[40:43], v[8:11]
  ds_read_b64_tr_b16 v[52:53], v84 offset:9728
  ds_read_b64_tr_b16 v[54:55], v84 offset:10880
  ds_read_b128 v[44:47], v81 offset:0
  s_add_u32 m0, s45, 132096
  s_add_u32 s46, s33, 368640
  buffer_load_dwordx4 v88, s[8:11], s46 offen lds
  s_waitcnt lgkmcnt(15)
  v_mfma_f32_16x16x32_bf16 v[12:15], v[56:59], v[40:43], v[12:15]
  ds_read_b64_tr_b16 v[56:57], v84 offset:9760
  ds_read_b64_tr_b16 v[58:59], v84 offset:10912
  s_add_u32 m0, s45, 136192
  s_add_u32 s46, s33, 368640
  buffer_load_dwordx4 v89, s[8:11], s46 offen lds
  s_waitcnt lgkmcnt(15)
  v_mfma_f32_16x16x32_bf16 v[16:19], v[60:63], v[40:43], v[16:19]
  ds_read_b64_tr_b16 v[60:61], v84 offset:9792
  ds_read_b64_tr_b16 v[62:63], v84 offset:10944
  s_add_u32 m0, s45, 140288
  s_add_u32 s46, s33, 368640
  buffer_load_dwordx4 v90, s[8:11], s46 offen lds
  s_waitcnt lgkmcnt(15)
  v_mfma_f32_16x16x32_bf16 v[20:23], v[64:67], v[40:43], v[20:23]
  ds_read_b64_tr_b16 v[64:65], v84 offset:9824
  ds_read_b64_tr_b16 v[66:67], v84 offset:10976
  s_add_u32 m0, s45, 144384
  s_add_u32 s46, s33, 368640
  buffer_load_dwordx4 v91, s[8:11], s46 offen lds
  s_waitcnt lgkmcnt(15)
  v_mfma_f32_16x16x32_bf16 v[24:27], v[68:71], v[40:43], v[24:27]
  ds_read_b64_tr_b16 v[68:69], v84 offset:9856
  ds_read_b64_tr_b16 v[70:71], v84 offset:11008
  s_cmp_ge_u32 s40, 3
  s_cbranch_scc1 gemm1_kernel_wsk19
  s_add_u32 m0, s45, 148480
  s_add_u32 s46, s33, 368640
  buffer_load_dwordx4 v92, s[8:11], s46 offen lds
  gemm1_kernel_wsk19:
  s_waitcnt lgkmcnt(15)
  v_mfma_f32_16x16x32_bf16 v[28:31], v[72:75], v[40:43], v[28:31]
  ds_read_b64_tr_b16 v[72:73], v84 offset:9888
  ds_read_b64_tr_b16 v[74:75], v84 offset:11040
  s_waitcnt lgkmcnt(15)
  v_mfma_f32_16x16x32_bf16 v[32:35], v[76:79], v[40:43], v[32:35]
  ds_read_b64_tr_b16 v[76:77], v84 offset:9920
  ds_read_b64_tr_b16 v[78:79], v84 offset:11072
  s_waitcnt lgkmcnt(15)
  v_mfma_f32_16x16x32_bf16 v[36:39], v[48:51], v[40:43], v[36:39]
  ds_read_b64_tr_b16 v[48:49], v84 offset:9952
  ds_read_b64_tr_b16 v[50:51], v84 offset:11104
  s_waitcnt lgkmcnt(14)
  v_mfma_f32_16x16x32_bf16 v[4:7], v[52:55], v[44:47], v[4:7]
  ds_read_b64_tr_b16 v[52:53], v84 offset:9984
  ds_read_b64_tr_b16 v[54:55], v84 offset:11136
  s_waitcnt lgkmcnt(14)
  v_mfma_f32_16x16x32_bf16 v[8:11], v[56:59], v[44:47], v[8:11]
  s_waitcnt lgkmcnt(12)
  v_mfma_f32_16x16x32_bf16 v[12:15], v[60:63], v[44:47], v[12:15]
  s_waitcnt lgkmcnt(10)
  v_mfma_f32_16x16x32_bf16 v[16:19], v[64:67], v[44:47], v[16:19]
  s_waitcnt lgkmcnt(8)
  v_mfma_f32_16x16x32_bf16 v[20:23], v[68:71], v[44:47], v[20:23]
  s_waitcnt lgkmcnt(6)
  v_mfma_f32_16x16x32_bf16 v[24:27], v[72:75], v[44:47], v[24:27]
  s_waitcnt lgkmcnt(4)
  v_mfma_f32_16x16x32_bf16 v[28:31], v[76:79], v[44:47], v[28:31]
  s_waitcnt lgkmcnt(2)
  v_mfma_f32_16x16x32_bf16 v[32:35], v[48:51], v[44:47], v[32:35]
  s_waitcnt lgkmcnt(0)
  v_mfma_f32_16x16x32_bf16 v[36:39], v[52:55], v[44:47], v[36:39]
  s_waitcnt vmcnt(0)
  s_barrier
  ds_read_b64_tr_b16 v[48:49], v85 offset:0
  ds_read_b64_tr_b16 v[50:51], v85 offset:1152
  ds_read_b128 v[40:43], v82 offset:0
  ds_read_b64_tr_b16 v[52:53], v85 offset:32
  ds_read_b64_tr_b16 v[54:55], v85 offset:1184
  ds_read_b64_tr_b16 v[56:57], v85 offset:64
  ds_read_b64_tr_b16 v[58:59], v85 offset:1216
  ds_read_b64_tr_b16 v[60:61], v85 offset:96
  ds_read_b64_tr_b16 v[62:63], v85 offset:1248
  ds_read_b64_tr_b16 v[64:65], v85 offset:128
  ds_read_b64_tr_b16 v[66:67], v85 offset:1280
  ds_read_b64_tr_b16 v[68:69], v85 offset:160
  ds_read_b64_tr_b16 v[70:71], v85 offset:1312
  ds_read_b64_tr_b16 v[72:73], v85 offset:192
  ds_read_b64_tr_b16 v[74:75], v85 offset:1344
  ds_read_b64_tr_b16 v[76:77], v85 offset:224
  ds_read_b64_tr_b16 v[78:79], v85 offset:1376
  s_add_u32 m0, s44, 104448
  s_add_u32 s46, s43, 768
  buffer_load_dwordx4 v86, s[4:7], s46 offen lds
  s_waitcnt lgkmcnt(14)
  v_mfma_f32_16x16x32_bf16 v[4:7], v[48:51], v[40:43], v[4:7]
  ds_read_b64_tr_b16 v[48:49], v85 offset:256
  ds_read_b64_tr_b16 v[50:51], v85 offset:1408
  s_add_u32 m0, s44, 105472
  s_add_u32 s46, s43, 9984
  buffer_load_dwordx4 v87, s[4:7], s46 offen lds
  s_waitcnt lgkmcnt(14)
  v_mfma_f32_16x16x32_bf16 v[8:11], v[52:55], v[40:43], v[8:11]
  ds_read_b64_tr_b16 v[52:53], v85 offset:9728
  ds_read_b64_tr_b16 v[54:55], v85 offset:10880
  ds_read_b128 v[44:47], v83 offset:0
  s_add_u32 m0, s45, 104448
  s_add_u32 s46, s33, 442368
  buffer_load_dwordx4 v88, s[8:11], s46 offen lds
  s_waitcnt lgkmcnt(15)
  v_mfma_f32_16x16x32_bf16 v[12:15], v[56:59], v[40:43], v[12:15]
  ds_read_b64_tr_b16 v[56:57], v85 offset:9760
  ds_read_b64_tr_b16 v[58:59], v85 offset:10912
  s_add_u32 m0, s45, 108544
  s_add_u32 s46, s33, 442368
  buffer_load_dwordx4 v89, s[8:11], s46 offen lds
  s_waitcnt lgkmcnt(15)
  v_mfma_f32_16x16x32_bf16 v[16:19], v[60:63], v[40:43], v[16:19]
  ds_read_b64_tr_b16 v[60:61], v85 offset:9792
  ds_read_b64_tr_b16 v[62:63], v85 offset:10944
  s_add_u32 m0, s45, 112640
  s_add_u32 s46, s33, 442368
  buffer_load_dwordx4 v90, s[8:11], s46 offen lds
  s_waitcnt lgkmcnt(15)
  v_mfma_f32_16x16x32_bf16 v[20:23], v[64:67], v[40:43], v[20:23]
  ds_read_b64_tr_b16 v[64:65], v85 offset:9824
  ds_read_b64_tr_b16 v[66:67], v85 offset:10976
  s_add_u32 m0, s45, 116736
  s_add_u32 s46, s33, 442368
  buffer_load_dwordx4 v91, s[8:11], s46 offen lds
  s_waitcnt lgkmcnt(15)
  v_mfma_f32_16x16x32_bf16 v[24:27], v[68:71], v[40:43], v[24:27]
  ds_read_b64_tr_b16 v[68:69], v85 offset:9856
  ds_read_b64_tr_b16 v[70:71], v85 offset:11008
  s_cmp_ge_u32 s40, 3
  s_cbranch_scc1 gemm1_kernel_wsk20
  s_add_u32 m0, s45, 120832
  s_add_u32 s46, s33, 442368
  buffer_load_dwordx4 v92, s[8:11], s46 offen lds
  gemm1_kernel_wsk20:
  s_waitcnt lgkmcnt(15)
  v_mfma_f32_16x16x32_bf16 v[28:31], v[72:75], v[40:43], v[28:31]
  ds_read_b64_tr_b16 v[72:73], v85 offset:9888
  ds_read_b64_tr_b16 v[74:75], v85 offset:11040
  s_waitcnt lgkmcnt(15)
  v_mfma_f32_16x16x32_bf16 v[32:35], v[76:79], v[40:43], v[32:35]
  ds_read_b64_tr_b16 v[76:77], v85 offset:9920
  ds_read_b64_tr_b16 v[78:79], v85 offset:11072
  s_waitcnt lgkmcnt(15)
  v_mfma_f32_16x16x32_bf16 v[36:39], v[48:51], v[40:43], v[36:39]
  ds_read_b64_tr_b16 v[48:49], v85 offset:9952
  ds_read_b64_tr_b16 v[50:51], v85 offset:11104
  s_waitcnt lgkmcnt(14)
  v_mfma_f32_16x16x32_bf16 v[4:7], v[52:55], v[44:47], v[4:7]
  ds_read_b64_tr_b16 v[52:53], v85 offset:9984
  ds_read_b64_tr_b16 v[54:55], v85 offset:11136
  s_waitcnt lgkmcnt(14)
  v_mfma_f32_16x16x32_bf16 v[8:11], v[56:59], v[44:47], v[8:11]
  s_waitcnt lgkmcnt(12)
  v_mfma_f32_16x16x32_bf16 v[12:15], v[60:63], v[44:47], v[12:15]
  s_waitcnt lgkmcnt(10)
  v_mfma_f32_16x16x32_bf16 v[16:19], v[64:67], v[44:47], v[16:19]
  s_waitcnt lgkmcnt(8)
  v_mfma_f32_16x16x32_bf16 v[20:23], v[68:71], v[44:47], v[20:23]
  s_waitcnt lgkmcnt(6)
  v_mfma_f32_16x16x32_bf16 v[24:27], v[72:75], v[44:47], v[24:27]
  s_waitcnt lgkmcnt(4)
  v_mfma_f32_16x16x32_bf16 v[28:31], v[76:79], v[44:47], v[28:31]
  s_waitcnt lgkmcnt(2)
  v_mfma_f32_16x16x32_bf16 v[32:35], v[48:51], v[44:47], v[32:35]
  s_waitcnt lgkmcnt(0)
  v_mfma_f32_16x16x32_bf16 v[36:39], v[52:55], v[44:47], v[36:39]
  s_waitcnt vmcnt(0)
  s_barrier
  ds_read_b64_tr_b16 v[48:49], v84 offset:0
  ds_read_b64_tr_b16 v[50:51], v84 offset:1152
  ds_read_b128 v[40:43], v80 offset:0
  ds_read_b64_tr_b16 v[52:53], v84 offset:32
  ds_read_b64_tr_b16 v[54:55], v84 offset:1184
  ds_read_b64_tr_b16 v[56:57], v84 offset:64
  ds_read_b64_tr_b16 v[58:59], v84 offset:1216
  ds_read_b64_tr_b16 v[60:61], v84 offset:96
  ds_read_b64_tr_b16 v[62:63], v84 offset:1248
  ds_read_b64_tr_b16 v[64:65], v84 offset:128
  ds_read_b64_tr_b16 v[66:67], v84 offset:1280
  ds_read_b64_tr_b16 v[68:69], v84 offset:160
  ds_read_b64_tr_b16 v[70:71], v84 offset:1312
  ds_read_b64_tr_b16 v[72:73], v84 offset:192
  ds_read_b64_tr_b16 v[74:75], v84 offset:1344
  ds_read_b64_tr_b16 v[76:77], v84 offset:224
  ds_read_b64_tr_b16 v[78:79], v84 offset:1376
  s_add_u32 m0, s44, 132096
  s_add_u32 s46, s43, 896
  buffer_load_dwordx4 v86, s[4:7], s46 offen lds
  s_waitcnt lgkmcnt(14)
  v_mfma_f32_16x16x32_bf16 v[4:7], v[48:51], v[40:43], v[4:7]
  ds_read_b64_tr_b16 v[48:49], v84 offset:256
  ds_read_b64_tr_b16 v[50:51], v84 offset:1408
  s_add_u32 m0, s44, 133120
  s_add_u32 s46, s43, 10112
  buffer_load_dwordx4 v87, s[4:7], s46 offen lds
  s_waitcnt lgkmcnt(14)
  v_mfma_f32_16x16x32_bf16 v[8:11], v[52:55], v[40:43], v[8:11]
  ds_read_b64_tr_b16 v[52:53], v84 offset:9728
  ds_read_b64_tr_b16 v[54:55], v84 offset:10880
  ds_read_b128 v[44:47], v81 offset:0
  s_add_u32 m0, s45, 132096
  s_add_u32 s46, s33, 516096
  buffer_load_dwordx4 v88, s[8:11], s46 offen lds
  s_waitcnt lgkmcnt(15)
  v_mfma_f32_16x16x32_bf16 v[12:15], v[56:59], v[40:43], v[12:15]
  ds_read_b64_tr_b16 v[56:57], v84 offset:9760
  ds_read_b64_tr_b16 v[58:59], v84 offset:10912
  s_add_u32 m0, s45, 136192
  s_add_u32 s46, s33, 516096
  buffer_load_dwordx4 v89, s[8:11], s46 offen lds
  s_waitcnt lgkmcnt(15)
  v_mfma_f32_16x16x32_bf16 v[16:19], v[60:63], v[40:43], v[16:19]
  ds_read_b64_tr_b16 v[60:61], v84 offset:9792
  ds_read_b64_tr_b16 v[62:63], v84 offset:10944
  s_add_u32 m0, s45, 140288
  s_add_u32 s46, s33, 516096
  buffer_load_dwordx4 v90, s[8:11], s46 offen lds
  s_waitcnt lgkmcnt(15)
  v_mfma_f32_16x16x32_bf16 v[20:23], v[64:67], v[40:43], v[20:23]
  ds_read_b64_tr_b16 v[64:65], v84 offset:9824
  ds_read_b64_tr_b16 v[66:67], v84 offset:10976
  s_add_u32 m0, s45, 144384
  s_add_u32 s46, s33, 516096
  buffer_load_dwordx4 v91, s[8:11], s46 offen lds
  s_waitcnt lgkmcnt(15)
  v_mfma_f32_16x16x32_bf16 v[24:27], v[68:71], v[40:43], v[24:27]
  ds_read_b64_tr_b16 v[68:69], v84 offset:9856
  ds_read_b64_tr_b16 v[70:71], v84 offset:11008
  s_cmp_ge_u32 s40, 3
  s_cbranch_scc1 gemm1_kernel_wsk21
  s_add_u32 m0, s45, 148480
  s_add_u32 s46, s33, 516096
  buffer_load_dwordx4 v92, s[8:11], s46 offen lds
  gemm1_kernel_wsk21:
  s_waitcnt lgkmcnt(15)
  v_mfma_f32_16x16x32_bf16 v[28:31], v[72:75], v[40:43], v[28:31]
  ds_read_b64_tr_b16 v[72:73], v84 offset:9888
  ds_read_b64_tr_b16 v[74:75], v84 offset:11040
  s_waitcnt lgkmcnt(15)
  v_mfma_f32_16x16x32_bf16 v[32:35], v[76:79], v[40:43], v[32:35]
  ds_read_b64_tr_b16 v[76:77], v84 offset:9920
  ds_read_b64_tr_b16 v[78:79], v84 offset:11072
  s_waitcnt lgkmcnt(15)
  v_mfma_f32_16x16x32_bf16 v[36:39], v[48:51], v[40:43], v[36:39]
  ds_read_b64_tr_b16 v[48:49], v84 offset:9952
  ds_read_b64_tr_b16 v[50:51], v84 offset:11104
  s_waitcnt lgkmcnt(14)
  v_mfma_f32_16x16x32_bf16 v[4:7], v[52:55], v[44:47], v[4:7]
  ds_read_b64_tr_b16 v[52:53], v84 offset:9984
  ds_read_b64_tr_b16 v[54:55], v84 offset:11136
  s_waitcnt lgkmcnt(14)
  v_mfma_f32_16x16x32_bf16 v[8:11], v[56:59], v[44:47], v[8:11]
  s_waitcnt lgkmcnt(12)
  v_mfma_f32_16x16x32_bf16 v[12:15], v[60:63], v[44:47], v[12:15]
  s_waitcnt lgkmcnt(10)
  v_mfma_f32_16x16x32_bf16 v[16:19], v[64:67], v[44:47], v[16:19]
  s_waitcnt lgkmcnt(8)
  v_mfma_f32_16x16x32_bf16 v[20:23], v[68:71], v[44:47], v[20:23]
  s_waitcnt lgkmcnt(6)
  v_mfma_f32_16x16x32_bf16 v[24:27], v[72:75], v[44:47], v[24:27]
  s_waitcnt lgkmcnt(4)
  v_mfma_f32_16x16x32_bf16 v[28:31], v[76:79], v[44:47], v[28:31]
  s_waitcnt lgkmcnt(2)
  v_mfma_f32_16x16x32_bf16 v[32:35], v[48:51], v[44:47], v[32:35]
  s_waitcnt lgkmcnt(0)
  v_mfma_f32_16x16x32_bf16 v[36:39], v[52:55], v[44:47], v[36:39]
  s_waitcnt vmcnt(0)
  s_barrier
  ds_read_b64_tr_b16 v[48:49], v85 offset:0
  ds_read_b64_tr_b16 v[50:51], v85 offset:1152
  ds_read_b128 v[40:43], v82 offset:0
  ds_read_b64_tr_b16 v[52:53], v85 offset:32
  ds_read_b64_tr_b16 v[54:55], v85 offset:1184
  ds_read_b64_tr_b16 v[56:57], v85 offset:64
  ds_read_b64_tr_b16 v[58:59], v85 offset:1216
  ds_read_b64_tr_b16 v[60:61], v85 offset:96
  ds_read_b64_tr_b16 v[62:63], v85 offset:1248
  ds_read_b64_tr_b16 v[64:65], v85 offset:128
  ds_read_b64_tr_b16 v[66:67], v85 offset:1280
  ds_read_b64_tr_b16 v[68:69], v85 offset:160
  ds_read_b64_tr_b16 v[70:71], v85 offset:1312
  ds_read_b64_tr_b16 v[72:73], v85 offset:192
  ds_read_b64_tr_b16 v[74:75], v85 offset:1344
  ds_read_b64_tr_b16 v[76:77], v85 offset:224
  ds_read_b64_tr_b16 v[78:79], v85 offset:1376
  s_add_u32 m0, s44, 104448
  s_add_u32 s46, s43, 1024
  buffer_load_dwordx4 v86, s[4:7], s46 offen lds
  s_waitcnt lgkmcnt(14)
  v_mfma_f32_16x16x32_bf16 v[4:7], v[48:51], v[40:43], v[4:7]
  ds_read_b64_tr_b16 v[48:49], v85 offset:256
  ds_read_b64_tr_b16 v[50:51], v85 offset:1408
  s_add_u32 m0, s44, 105472
  s_add_u32 s46, s43, 10240
  buffer_load_dwordx4 v87, s[4:7], s46 offen lds
  s_waitcnt lgkmcnt(14)
  v_mfma_f32_16x16x32_bf16 v[8:11], v[52:55], v[40:43], v[8:11]
  ds_read_b64_tr_b16 v[52:53], v85 offset:9728
  ds_read_b64_tr_b16 v[54:55], v85 offset:10880
  ds_read_b128 v[44:47], v83 offset:0
  s_add_u32 m0, s45, 104448
  s_add_u32 s46, s33, 589824
  buffer_load_dwordx4 v88, s[8:11], s46 offen lds
  s_waitcnt lgkmcnt(15)
  v_mfma_f32_16x16x32_bf16 v[12:15], v[56:59], v[40:43], v[12:15]
  ds_read_b64_tr_b16 v[56:57], v85 offset:9760
  ds_read_b64_tr_b16 v[58:59], v85 offset:10912
  s_add_u32 m0, s45, 108544
  s_add_u32 s46, s33, 589824
  buffer_load_dwordx4 v89, s[8:11], s46 offen lds
  s_waitcnt lgkmcnt(15)
  v_mfma_f32_16x16x32_bf16 v[16:19], v[60:63], v[40:43], v[16:19]
  ds_read_b64_tr_b16 v[60:61], v85 offset:9792
  ds_read_b64_tr_b16 v[62:63], v85 offset:10944
  s_add_u32 m0, s45, 112640
  s_add_u32 s46, s33, 589824
  buffer_load_dwordx4 v90, s[8:11], s46 offen lds
  s_waitcnt lgkmcnt(15)
  v_mfma_f32_16x16x32_bf16 v[20:23], v[64:67], v[40:43], v[20:23]
  ds_read_b64_tr_b16 v[64:65], v85 offset:9824
  ds_read_b64_tr_b16 v[66:67], v85 offset:10976
  s_add_u32 m0, s45, 116736
  s_add_u32 s46, s33, 589824
  buffer_load_dwordx4 v91, s[8:11], s46 offen lds
  s_waitcnt lgkmcnt(15)
  v_mfma_f32_16x16x32_bf16 v[24:27], v[68:71], v[40:43], v[24:27]
  ds_read_b64_tr_b16 v[68:69], v85 offset:9856
  ds_read_b64_tr_b16 v[70:71], v85 offset:11008
  s_cmp_ge_u32 s40, 3
  s_cbranch_scc1 gemm1_kernel_wsk22
  s_add_u32 m0, s45, 120832
  s_add_u32 s46, s33, 589824
  buffer_load_dwordx4 v92, s[8:11], s46 offen lds
  gemm1_kernel_wsk22:
  s_waitcnt lgkmcnt(15)
  v_mfma_f32_16x16x32_bf16 v[28:31], v[72:75], v[40:43], v[28:31]
  ds_read_b64_tr_b16 v[72:73], v85 offset:9888
  ds_read_b64_tr_b16 v[74:75], v85 offset:11040
  s_waitcnt lgkmcnt(15)
  v_mfma_f32_16x16x32_bf16 v[32:35], v[76:79], v[40:43], v[32:35]
  ds_read_b64_tr_b16 v[76:77], v85 offset:9920
  ds_read_b64_tr_b16 v[78:79], v85 offset:11072
  s_waitcnt lgkmcnt(15)
  v_mfma_f32_16x16x32_bf16 v[36:39], v[48:51], v[40:43], v[36:39]
  ds_read_b64_tr_b16 v[48:49], v85 offset:9952
  ds_read_b64_tr_b16 v[50:51], v85 offset:11104
  s_waitcnt lgkmcnt(14)
  v_mfma_f32_16x16x32_bf16 v[4:7], v[52:55], v[44:47], v[4:7]
  ds_read_b64_tr_b16 v[52:53], v85 offset:9984
  ds_read_b64_tr_b16 v[54:55], v85 offset:11136
  s_waitcnt lgkmcnt(14)
  v_mfma_f32_16x16x32_bf16 v[8:11], v[56:59], v[44:47], v[8:11]
  s_waitcnt lgkmcnt(12)
  v_mfma_f32_16x16x32_bf16 v[12:15], v[60:63], v[44:47], v[12:15]
  s_waitcnt lgkmcnt(10)
  v_mfma_f32_16x16x32_bf16 v[16:19], v[64:67], v[44:47], v[16:19]
  s_waitcnt lgkmcnt(8)
  v_mfma_f32_16x16x32_bf16 v[20:23], v[68:71], v[44:47], v[20:23]
  s_waitcnt lgkmcnt(6)
  v_mfma_f32_16x16x32_bf16 v[24:27], v[72:75], v[44:47], v[24:27]
  s_waitcnt lgkmcnt(4)
  v_mfma_f32_16x16x32_bf16 v[28:31], v[76:79], v[44:47], v[28:31]
  s_waitcnt lgkmcnt(2)
  v_mfma_f32_16x16x32_bf16 v[32:35], v[48:51], v[44:47], v[32:35]
  s_waitcnt lgkmcnt(0)
  v_mfma_f32_16x16x32_bf16 v[36:39], v[52:55], v[44:47], v[36:39]
  s_waitcnt vmcnt(0)
  s_barrier
  ds_read_b64_tr_b16 v[48:49], v84 offset:0
  ds_read_b64_tr_b16 v[50:51], v84 offset:1152
  ds_read_b128 v[40:43], v80 offset:0
  ds_read_b64_tr_b16 v[52:53], v84 offset:32
  ds_read_b64_tr_b16 v[54:55], v84 offset:1184
  ds_read_b64_tr_b16 v[56:57], v84 offset:64
  ds_read_b64_tr_b16 v[58:59], v84 offset:1216
  ds_read_b64_tr_b16 v[60:61], v84 offset:96
  ds_read_b64_tr_b16 v[62:63], v84 offset:1248
  ds_read_b64_tr_b16 v[64:65], v84 offset:128
  ds_read_b64_tr_b16 v[66:67], v84 offset:1280
  ds_read_b64_tr_b16 v[68:69], v84 offset:160
  ds_read_b64_tr_b16 v[70:71], v84 offset:1312
  ds_read_b64_tr_b16 v[72:73], v84 offset:192
  ds_read_b64_tr_b16 v[74:75], v84 offset:1344
  ds_read_b64_tr_b16 v[76:77], v84 offset:224
  ds_read_b64_tr_b16 v[78:79], v84 offset:1376
  s_waitcnt lgkmcnt(14)
  v_mfma_f32_16x16x32_bf16 v[4:7], v[48:51], v[40:43], v[4:7]
  ds_read_b64_tr_b16 v[48:49], v84 offset:256
  ds_read_b64_tr_b16 v[50:51], v84 offset:1408
  s_waitcnt lgkmcnt(14)
  v_mfma_f32_16x16x32_bf16 v[8:11], v[52:55], v[40:43], v[8:11]
  ds_read_b64_tr_b16 v[52:53], v84 offset:9728
  ds_read_b64_tr_b16 v[54:55], v84 offset:10880
  ds_read_b128 v[44:47], v81 offset:0
  s_waitcnt lgkmcnt(15)
  v_mfma_f32_16x16x32_bf16 v[12:15], v[56:59], v[40:43], v[12:15]
  ds_read_b64_tr_b16 v[56:57], v84 offset:9760
  ds_read_b64_tr_b16 v[58:59], v84 offset:10912
  s_waitcnt lgkmcnt(15)
  v_mfma_f32_16x16x32_bf16 v[16:19], v[60:63], v[40:43], v[16:19]
  ds_read_b64_tr_b16 v[60:61], v84 offset:9792
  ds_read_b64_tr_b16 v[62:63], v84 offset:10944
  s_waitcnt lgkmcnt(15)
  v_mfma_f32_16x16x32_bf16 v[20:23], v[64:67], v[40:43], v[20:23]
  ds_read_b64_tr_b16 v[64:65], v84 offset:9824
  ds_read_b64_tr_b16 v[66:67], v84 offset:10976
  s_waitcnt lgkmcnt(15)
  v_mfma_f32_16x16x32_bf16 v[24:27], v[68:71], v[40:43], v[24:27]
  ds_read_b64_tr_b16 v[68:69], v84 offset:9856
  ds_read_b64_tr_b16 v[70:71], v84 offset:11008
  s_waitcnt lgkmcnt(15)
  v_mfma_f32_16x16x32_bf16 v[28:31], v[72:75], v[40:43], v[28:31]
  ds_read_b64_tr_b16 v[72:73], v84 offset:9888
  ds_read_b64_tr_b16 v[74:75], v84 offset:11040
  s_waitcnt lgkmcnt(15)
  v_mfma_f32_16x16x32_bf16 v[32:35], v[76:79], v[40:43], v[32:35]
  ds_read_b64_tr_b16 v[76:77], v84 offset:9920
  ds_read_b64_tr_b16 v[78:79], v84 offset:11072
  s_waitcnt lgkmcnt(15)
  v_mfma_f32_16x16x32_bf16 v[36:39], v[48:51], v[40:43], v[36:39]
  ds_read_b64_tr_b16 v[48:49], v84 offset:9952
  ds_read_b64_tr_b16 v[50:51], v84 offset:11104
  s_waitcnt lgkmcnt(14)
  v_mfma_f32_16x16x32_bf16 v[4:7], v[52:55], v[44:47], v[4:7]
  ds_read_b64_tr_b16 v[52:53], v84 offset:9984
  ds_read_b64_tr_b16 v[54:55], v84 offset:11136
  s_waitcnt lgkmcnt(14)
  v_mfma_f32_16x16x32_bf16 v[8:11], v[56:59], v[44:47], v[8:11]
  s_waitcnt lgkmcnt(12)
  v_mfma_f32_16x16x32_bf16 v[12:15], v[60:63], v[44:47], v[12:15]
  s_waitcnt lgkmcnt(10)
  v_mfma_f32_16x16x32_bf16 v[16:19], v[64:67], v[44:47], v[16:19]
  s_waitcnt lgkmcnt(8)
  v_mfma_f32_16x16x32_bf16 v[20:23], v[68:71], v[44:47], v[20:23]
  s_waitcnt lgkmcnt(6)
  v_mfma_f32_16x16x32_bf16 v[24:27], v[72:75], v[44:47], v[24:27]
  s_waitcnt lgkmcnt(4)
  v_mfma_f32_16x16x32_bf16 v[28:31], v[76:79], v[44:47], v[28:31]
  s_waitcnt lgkmcnt(2)
  v_mfma_f32_16x16x32_bf16 v[32:35], v[48:51], v[44:47], v[32:35]
  s_waitcnt lgkmcnt(0)
  v_mfma_f32_16x16x32_bf16 v[36:39], v[52:55], v[44:47], v[36:39]
  s_nop 7
  s_nop 7
  v_and_b32 v93, 15, v0
  v_bfe_u32 v94, v0, 4, 2
  s_lshl_b32 s34, s41, 4
  v_add_u32 v93, s34, v93
  s_movk_i32 s34, 1152
  v_mul_lo_u32 v93, v93, s34
  v_lshl_add_u32 v93, v94, 3, v93
  s_add_u32 s34, s32, s33
  s_mov_b32 s35, 0x3eae1a93
  v_mul_f32 v4, s35, v4
  v_mul_f32 v5, s35, v5
  v_mul_f32 v6, s35, v6
  v_mul_f32 v7, s35, v7
  v_cvt_pk_bf16_f32 v4, v4, v5
  v_cvt_pk_bf16_f32 v5, v6, v7
  buffer_store_dwordx2 v[4:5], v93, s[12:15], s34 offen offset:0
  v_mul_f32 v8, s35, v8
  v_mul_f32 v9, s35, v9
  v_mul_f32 v10, s35, v10
  v_mul_f32 v11, s35, v11
  v_cvt_pk_bf16_f32 v8, v8, v9
  v_cvt_pk_bf16_f32 v9, v10, v11
  buffer_store_dwordx2 v[8:9], v93, s[12:15], s34 offen offset:32
  v_mul_f32 v12, s35, v12
  v_mul_f32 v13, s35, v13
  v_mul_f32 v14, s35, v14
  v_mul_f32 v15, s35, v15
  v_cvt_pk_bf16_f32 v12, v12, v13
  v_cvt_pk_bf16_f32 v13, v14, v15
  buffer_store_dwordx2 v[12:13], v93, s[12:15], s34 offen offset:64
  v_mul_f32 v16, s35, v16
  v_mul_f32 v17, s35, v17
  v_mul_f32 v18, s35, v18
  v_mul_f32 v19, s35, v19
  v_cvt_pk_bf16_f32 v16, v16, v17
  v_cvt_pk_bf16_f32 v17, v18, v19
  buffer_store_dwordx2 v[16:17], v93, s[12:15], s34 offen offset:96
  v_mul_f32 v20, s35, v20
  v_mul_f32 v21, s35, v21
  v_mul_f32 v22, s35, v22
  v_mul_f32 v23, s35, v23
  v_cvt_pk_bf16_f32 v20, v20, v21
  v_cvt_pk_bf16_f32 v21, v22, v23
  buffer_store_dwordx2 v[20:21], v93, s[12:15], s34 offen offset:128
  v_mul_f32 v24, s35, v24
  v_mul_f32 v25, s35, v25
  v_mul_f32 v26, s35, v26
  v_mul_f32 v27, s35, v27
  v_cvt_pk_bf16_f32 v24, v24, v25
  v_cvt_pk_bf16_f32 v25, v26, v27
  buffer_store_dwordx2 v[24:25], v93, s[12:15], s34 offen offset:160
  v_mul_f32 v28, s35, v28
  v_mul_f32 v29, s35, v29
  v_mul_f32 v30, s35, v30
  v_mul_f32 v31, s35, v31
  v_cvt_pk_bf16_f32 v28, v28, v29
  v_cvt_pk_bf16_f32 v29, v30, v31
  buffer_store_dwordx2 v[28:29], v93, s[12:15], s34 offen offset:192
  v_mul_f32 v32, s35, v32
  v_mul_f32 v33, s35, v33
  v_mul_f32 v34, s35, v34
  v_mul_f32 v35, s35, v35
  v_cvt_pk_bf16_f32 v32, v32, v33
  v_cvt_pk_bf16_f32 v33, v34, v35
  buffer_store_dwordx2 v[32:33], v93, s[12:15], s34 offen offset:224
  v_mul_f32 v36, s35, v36
  v_mul_f32 v37, s35, v37
  v_mul_f32 v38, s35, v38
  v_mul_f32 v39, s35, v39
  v_cvt_pk_bf16_f32 v36, v36, v37
  v_cvt_pk_bf16_f32 v37, v38, v39
  buffer_store_dwordx2 v[36:37], v93, s[12:15], s34 offen offset:256
  s_branch gemm1_kernel_done1
gemm1_kernel_kv12:
  s_sub_u32 s30, s2, 128
  s_mul_i32 s32, s30, 73728
  s_mov_b32 s33, 0
  v_lshrrev_b32 v55, 6, v0
  s_nop 0
  v_readfirstlane_b32 s40, v55
  v_and_b32 v56, 63, v0
  s_nop 2
  s_mov_b32 s41, s40
  s_mov_b32 s42, 0
  v_lshrrev_b32 v55, 3, v56
  s_mov_b32 s46, 1152
  v_mul_lo_u32 v55, v55, s46
  v_lshrrev_b32 v57, 4, v56
  v_and_b32 v58, 7, v56
  v_xor_b32 v57, v57, v58
  v_lshl_add_u32 v50, v57, 4, v55
  v_xor_b32 v57, 4, v57
  v_lshl_add_u32 v51, v57, 4, v55
  s_mul_i32 s43, s40, 18432
  s_add_u32 s43, s43, s32
  s_mul_i32 s44, s40, 2048
  s_lshl_b32 s45, s40, 10
  s_add_u32 s45, s45, 8192
  s_lshl_b32 s46, s40, 6
  s_add_u32 s46, s46, 0
  v_add_u32 v55, s46, v56
  s_mov_b32 s46, 497
  v_mul_lo_u32 v57, v55, s46
  v_lshrrev_b32 v57, 15, v57
  v_mul_u32_u24 v58, 66, v57
  v_sub_u32 v55, v55, v58
  v_mul_u32_u24 v58, 32, v55
  v_lshrrev_b32 v58, 8, v58
  v_mul_u32_u24 v52, 8, v58
  v_sub_u32 v52, v55, v52
  v_lshlrev_b32 v52, 4, v52
  v_lshl_add_u32 v58, v57, 3, v58
  s_mov_b32 s46, 128
  v_mul_lo_u32 v58, v58, s46
  v_add_u32 v52, v52, v58
  v_cmp_gt_u32 vcc, 64, v55
  v_cmp_gt_u32 s[48:49], 8, v57
  s_nop 1
  s_and_b64 vcc, vcc, s[48:49]
  v_mov_b32 v58, 0x80000000
  s_nop 1
  v_cndmask_b32 v52, v58, v52, vcc
  s_lshl_b32 s46, s40, 6
  s_add_u32 s46, s46, 256
  v_add_u32 v55, s46, v56
  s_mov_b32 s46, 497
  v_mul_lo_u32 v57, v55, s46
  v_lshrrev_b32 v57, 15, v57
  v_mul_u32_u24 v58, 66, v57
  v_sub_u32 v55, v55, v58
  v_mul_u32_u24 v58, 32, v55
  v_lshrrev_b32 v58, 8, v58
  v_mul_u32_u24 v53, 8, v58
  v_sub_u32 v53, v55, v53
  v_lshlrev_b32 v53, 4, v53
  v_lshl_add_u32 v58, v57, 3, v58
  s_mov_b32 s46, 128
  v_mul_lo_u32 v58, v58, s46
  v_add_u32 v53, v53, v58
  v_cmp_gt_u32 vcc, 64, v55
  v_cmp_gt_u32 s[48:49], 8, v57
  s_nop 1
  s_and_b64 vcc, vcc, s[48:49]
  v_mov_b32 v58, 0x80000000
  s_nop 1
  v_cndmask_b32 v53, v58, v53, vcc
  s_lshl_b32 s46, s40, 6
  s_add_u32 s46, s46, 512
  v_add_u32 v55, s46, v56
  s_mov_b32 s46, 497
  v_mul_lo_u32 v57, v55, s46
  v_lshrrev_b32 v57, 15, v57
  v_mul_u32_u24 v58, 66, v57
  v_sub_u32 v55, v55, v58
  v_mul_u32_u24 v58, 32, v55
  v_lshrrev_b32 v58, 8, v58
  v_mul_u32_u24 v54, 8, v58
  v_sub_u32 v54, v55, v54
  v_lshlrev_b32 v54, 4, v54
  v_lshl_add_u32 v58, v57, 3, v58
  s_mov_b32 s46, 128
  v_mul_lo_u32 v58, v58, s46
  v_add_u32 v54, v54, v58
  v_cmp_gt_u32 vcc, 64, v55
  v_cmp_gt_u32 s[48:49], 8, v57
  s_nop 1
  s_and_b64 vcc, vcc, s[48:49]
  v_mov_b32 v58, 0x80000000
  s_nop 1
  v_cndmask_b32 v54, v58, v54, vcc
  s_add_u32 m0, s44, 104448
  s_add_u32 s46, s43, 0
  buffer_load_dwordx4 v50, s[4:7], s46 offen lds
  s_add_u32 m0, s44, 105472
  s_add_u32 s46, s43, 9216
  buffer_load_dwordx4 v51, s[4:7], s46 offen lds
  s_add_u32 m0, s45, 104448
  s_add_u32 s46, s33, 0
  buffer_load_dwordx4 v52, s[16:19], s46 offen lds
  s_add_u32 m0, s45, 108544
  s_add_u32 s46, s33, 0
  buffer_load_dwordx4 v53, s[16:19], s46 offen lds
  s_cmp_ge_u32 s40, 1
  s_cbranch_scc1 gemm1_kernel_wsk23
  s_add_u32 m0, s45, 112640
  s_add_u32 s46, s33, 0
  buffer_load_dwordx4 v54, s[16:19], s46 offen lds
  gemm1_kernel_wsk23:
  v_and_b32 v55, 15, v56
  v_lshrrev_b32 v57, 4, v56
  v_lshrrev_b32 v58, 1, v55
  v_xor_b32 v58, v58, v57
  v_lshlrev_b32 v55, 7, v55
  v_lshl_add_u32 v44, v58, 4, v55
  s_mul_i32 s46, s41, 2048
  v_add_u32 v44, s46, v44
  v_xor_b32 v45, 64, v44
  v_bfe_u32 v55, v56, 2, 2
  v_lshl_add_u32 v55, v57, 3, v55
  v_mul_u32_u24 v55, 128, v55
  v_mul_u32_u24 v58, 32, v57
  v_add_u32 v55, v55, v58
  v_and_b32 v58, 3, v56
  v_lshl_add_u32 v48, v58, 3, v55
  s_mov_b32 s46, 8192
  v_add_u32 v48, s46, v48
  v_add_u32 v44, 104448, v44
  v_add_u32 v45, 104448, v45
  v_add_u32 v48, 104448, v48
  v_add_u32 v46, 17408, v44
  v_add_u32 v47, 17408, v45
  v_add_u32 v49, 17408, v48
  v_mov_b32 v4, 0
  v_mov_b32 v5, 0
  v_mov_b32 v6, 0
  v_mov_b32 v7, 0
  v_mov_b32 v8, 0
  v_mov_b32 v9, 0
  v_mov_b32 v10, 0
  v_mov_b32 v11, 0
  v_mov_b32 v12, 0
  v_mov_b32 v13, 0
  v_mov_b32 v14, 0
  v_mov_b32 v15, 0
  v_mov_b32 v16, 0
  v_mov_b32 v17, 0
  v_mov_b32 v18, 0
  v_mov_b32 v19, 0
  s_waitcnt vmcnt(0)
  s_barrier
  ds_read_b64_tr_b16 v[28:29], v48 offset:0
  ds_read_b64_tr_b16 v[30:31], v48 offset:512
  ds_read_b128 v[20:23], v44 offset:0
  ds_read_b64_tr_b16 v[32:33], v48 offset:32
  ds_read_b64_tr_b16 v[34:35], v48 offset:544
  ds_read_b64_tr_b16 v[36:37], v48 offset:64
  ds_read_b64_tr_b16 v[38:39], v48 offset:576
  ds_read_b64_tr_b16 v[40:41], v48 offset:96
  ds_read_b64_tr_b16 v[42:43], v48 offset:608
  s_add_u32 m0, s44, 121856
  s_add_u32 s46, s43, 128
  buffer_load_dwordx4 v50, s[4:7], s46 offen lds
  s_waitcnt lgkmcnt(6)
  v_mfma_f32_16x16x32_bf16 v[4:7], v[28:31], v[20:23], v[4:7]
  ds_read_b64_tr_b16 v[28:29], v48 offset:4224
  ds_read_b64_tr_b16 v[30:31], v48 offset:4736
  s_add_u32 m0, s44, 122880
  s_add_u32 s46, s43, 9344
  buffer_load_dwordx4 v51, s[4:7], s46 offen lds
  s_waitcnt lgkmcnt(6)
  v_mfma_f32_16x16x32_bf16 v[8:11], v[32:35], v[20:23], v[8:11]
  ds_read_b64_tr_b16 v[32:33], v48 offset:4256
  ds_read_b64_tr_b16 v[34:35], v48 offset:4768
  ds_read_b128 v[24:27], v45 offset:0
  s_add_u32 m0, s45, 121856
  s_add_u32 s46, s33, 8192
  buffer_load_dwordx4 v52, s[16:19], s46 offen lds
  s_waitcnt lgkmcnt(7)
  v_mfma_f32_16x16x32_bf16 v[12:15], v[36:39], v[20:23], v[12:15]
  ds_read_b64_tr_b16 v[36:37], v48 offset:4288
  ds_read_b64_tr_b16 v[38:39], v48 offset:4800
  s_add_u32 m0, s45, 125952
  s_add_u32 s46, s33, 8192
  buffer_load_dwordx4 v53, s[16:19], s46 offen lds
  s_waitcnt lgkmcnt(7)
  v_mfma_f32_16x16x32_bf16 v[16:19], v[40:43], v[20:23], v[16:19]
  ds_read_b64_tr_b16 v[40:41], v48 offset:4320
  ds_read_b64_tr_b16 v[42:43], v48 offset:4832
  s_cmp_ge_u32 s40, 1
  s_cbranch_scc1 gemm1_kernel_wsk24
  s_add_u32 m0, s45, 130048
  s_add_u32 s46, s33, 8192
  buffer_load_dwordx4 v54, s[16:19], s46 offen lds
  gemm1_kernel_wsk24:
  s_waitcnt lgkmcnt(4)
  v_mfma_f32_16x16x32_bf16 v[4:7], v[28:31], v[24:27], v[4:7]
  v_mfma_f32_16x16x32_bf16 v[8:11], v[32:35], v[24:27], v[8:11]
  s_waitcnt lgkmcnt(2)
  v_mfma_f32_16x16x32_bf16 v[12:15], v[36:39], v[24:27], v[12:15]
  s_waitcnt lgkmcnt(0)
  v_mfma_f32_16x16x32_bf16 v[16:19], v[40:43], v[24:27], v[16:19]
  s_waitcnt vmcnt(0)
  s_barrier
  ds_read_b64_tr_b16 v[28:29], v49 offset:0
  ds_read_b64_tr_b16 v[30:31], v49 offset:512
  ds_read_b128 v[20:23], v46 offset:0
  ds_read_b64_tr_b16 v[32:33], v49 offset:32
  ds_read_b64_tr_b16 v[34:35], v49 offset:544
  ds_read_b64_tr_b16 v[36:37], v49 offset:64
  ds_read_b64_tr_b16 v[38:39], v49 offset:576
  ds_read_b64_tr_b16 v[40:41], v49 offset:96
  ds_read_b64_tr_b16 v[42:43], v49 offset:608
  s_add_u32 m0, s44, 104448
  s_add_u32 s46, s43, 256
  buffer_load_dwordx4 v50, s[4:7], s46 offen lds
  s_waitcnt lgkmcnt(6)
  v_mfma_f32_16x16x32_bf16 v[4:7], v[28:31], v[20:23], v[4:7]
  ds_read_b64_tr_b16 v[28:29], v49 offset:4224
  ds_read_b64_tr_b16 v[30:31], v49 offset:4736
  s_add_u32 m0, s44, 105472
  s_add_u32 s46, s43, 9472
  buffer_load_dwordx4 v51, s[4:7], s46 offen lds
  s_waitcnt lgkmcnt(6)
  v_mfma_f32_16x16x32_bf16 v[8:11], v[32:35], v[20:23], v[8:11]
  ds_read_b64_tr_b16 v[32:33], v49 offset:4256
  ds_read_b64_tr_b16 v[34:35], v49 offset:4768
  ds_read_b128 v[24:27], v47 offset:0
  s_add_u32 m0, s45, 104448
  s_add_u32 s46, s33, 16384
  buffer_load_dwordx4 v52, s[16:19], s46 offen lds
  s_waitcnt lgkmcnt(7)
  v_mfma_f32_16x16x32_bf16 v[12:15], v[36:39], v[20:23], v[12:15]
  ds_read_b64_tr_b16 v[36:37], v49 offset:4288
  ds_read_b64_tr_b16 v[38:39], v49 offset:4800
  s_add_u32 m0, s45, 108544
  s_add_u32 s46, s33, 16384
  buffer_load_dwordx4 v53, s[16:19], s46 offen lds
  s_waitcnt lgkmcnt(7)
  v_mfma_f32_16x16x32_bf16 v[16:19], v[40:43], v[20:23], v[16:19]
  ds_read_b64_tr_b16 v[40:41], v49 offset:4320
  ds_read_b64_tr_b16 v[42:43], v49 offset:4832
  s_cmp_ge_u32 s40, 1
  s_cbranch_scc1 gemm1_kernel_wsk25
  s_add_u32 m0, s45, 112640
  s_add_u32 s46, s33, 16384
  buffer_load_dwordx4 v54, s[16:19], s46 offen lds
  gemm1_kernel_wsk25:
  s_waitcnt lgkmcnt(4)
  v_mfma_f32_16x16x32_bf16 v[4:7], v[28:31], v[24:27], v[4:7]
  v_mfma_f32_16x16x32_bf16 v[8:11], v[32:35], v[24:27], v[8:11]
  s_waitcnt lgkmcnt(2)
  v_mfma_f32_16x16x32_bf16 v[12:15], v[36:39], v[24:27], v[12:15]
  s_waitcnt lgkmcnt(0)
  v_mfma_f32_16x16x32_bf16 v[16:19], v[40:43], v[24:27], v[16:19]
  s_waitcnt vmcnt(0)
  s_barrier
  ds_read_b64_tr_b16 v[28:29], v48 offset:0
  ds_read_b64_tr_b16 v[30:31], v48 offset:512
  ds_read_b128 v[20:23], v44 offset:0
  ds_read_b64_tr_b16 v[32:33], v48 offset:32
  ds_read_b64_tr_b16 v[34:35], v48 offset:544
  ds_read_b64_tr_b16 v[36:37], v48 offset:64
  ds_read_b64_tr_b16 v[38:39], v48 offset:576
  ds_read_b64_tr_b16 v[40:41], v48 offset:96
  ds_read_b64_tr_b16 v[42:43], v48 offset:608
  s_add_u32 m0, s44, 121856
  s_add_u32 s46, s43, 384
  buffer_load_dwordx4 v50, s[4:7], s46 offen lds
  s_waitcnt lgkmcnt(6)
  v_mfma_f32_16x16x32_bf16 v[4:7], v[28:31], v[20:23], v[4:7]
  ds_read_b64_tr_b16 v[28:29], v48 offset:4224
  ds_read_b64_tr_b16 v[30:31], v48 offset:4736
  s_add_u32 m0, s44, 122880
  s_add_u32 s46, s43, 9600
  buffer_load_dwordx4 v51, s[4:7], s46 offen lds
  s_waitcnt lgkmcnt(6)
  v_mfma_f32_16x16x32_bf16 v[8:11], v[32:35], v[20:23], v[8:11]
  ds_read_b64_tr_b16 v[32:33], v48 offset:4256
  ds_read_b64_tr_b16 v[34:35], v48 offset:4768
  ds_read_b128 v[24:27], v45 offset:0
  s_add_u32 m0, s45, 121856
  s_add_u32 s46, s33, 24576
  buffer_load_dwordx4 v52, s[16:19], s46 offen lds
  s_waitcnt lgkmcnt(7)
  v_mfma_f32_16x16x32_bf16 v[12:15], v[36:39], v[20:23], v[12:15]
  ds_read_b64_tr_b16 v[36:37], v48 offset:4288
  ds_read_b64_tr_b16 v[38:39], v48 offset:4800
  s_add_u32 m0, s45, 125952
  s_add_u32 s46, s33, 24576
  buffer_load_dwordx4 v53, s[16:19], s46 offen lds
  s_waitcnt lgkmcnt(7)
  v_mfma_f32_16x16x32_bf16 v[16:19], v[40:43], v[20:23], v[16:19]
  ds_read_b64_tr_b16 v[40:41], v48 offset:4320
  ds_read_b64_tr_b16 v[42:43], v48 offset:4832
  s_cmp_ge_u32 s40, 1
  s_cbranch_scc1 gemm1_kernel_wsk26
  s_add_u32 m0, s45, 130048
  s_add_u32 s46, s33, 24576
  buffer_load_dwordx4 v54, s[16:19], s46 offen lds
  gemm1_kernel_wsk26:
  s_waitcnt lgkmcnt(4)
  v_mfma_f32_16x16x32_bf16 v[4:7], v[28:31], v[24:27], v[4:7]
  v_mfma_f32_16x16x32_bf16 v[8:11], v[32:35], v[24:27], v[8:11]
  s_waitcnt lgkmcnt(2)
  v_mfma_f32_16x16x32_bf16 v[12:15], v[36:39], v[24:27], v[12:15]
  s_waitcnt lgkmcnt(0)
  v_mfma_f32_16x16x32_bf16 v[16:19], v[40:43], v[24:27], v[16:19]
  s_waitcnt vmcnt(0)
  s_barrier
  ds_read_b64_tr_b16 v[28:29], v49 offset:0
  ds_read_b64_tr_b16 v[30:31], v49 offset:512
  ds_read_b128 v[20:23], v46 offset:0
  ds_read_b64_tr_b16 v[32:33], v49 offset:32
  ds_read_b64_tr_b16 v[34:35], v49 offset:544
  ds_read_b64_tr_b16 v[36:37], v49 offset:64
  ds_read_b64_tr_b16 v[38:39], v49 offset:576
  ds_read_b64_tr_b16 v[40:41], v49 offset:96
  ds_read_b64_tr_b16 v[42:43], v49 offset:608
  s_add_u32 m0, s44, 104448
  s_add_u32 s46, s43, 512
  buffer_load_dwordx4 v50, s[4:7], s46 offen lds
  s_waitcnt lgkmcnt(6)
  v_mfma_f32_16x16x32_bf16 v[4:7], v[28:31], v[20:23], v[4:7]
  ds_read_b64_tr_b16 v[28:29], v49 offset:4224
  ds_read_b64_tr_b16 v[30:31], v49 offset:4736
  s_add_u32 m0, s44, 105472
  s_add_u32 s46, s43, 9728
  buffer_load_dwordx4 v51, s[4:7], s46 offen lds
  s_waitcnt lgkmcnt(6)
  v_mfma_f32_16x16x32_bf16 v[8:11], v[32:35], v[20:23], v[8:11]
  ds_read_b64_tr_b16 v[32:33], v49 offset:4256
  ds_read_b64_tr_b16 v[34:35], v49 offset:4768
  ds_read_b128 v[24:27], v47 offset:0
  s_add_u32 m0, s45, 104448
  s_add_u32 s46, s33, 32768
  buffer_load_dwordx4 v52, s[16:19], s46 offen lds
  s_waitcnt lgkmcnt(7)
  v_mfma_f32_16x16x32_bf16 v[12:15], v[36:39], v[20:23], v[12:15]
  ds_read_b64_tr_b16 v[36:37], v49 offset:4288
  ds_read_b64_tr_b16 v[38:39], v49 offset:4800
  s_add_u32 m0, s45, 108544
  s_add_u32 s46, s33, 32768
  buffer_load_dwordx4 v53, s[16:19], s46 offen lds
  s_waitcnt lgkmcnt(7)
  v_mfma_f32_16x16x32_bf16 v[16:19], v[40:43], v[20:23], v[16:19]
  ds_read_b64_tr_b16 v[40:41], v49 offset:4320
  ds_read_b64_tr_b16 v[42:43], v49 offset:4832
  s_cmp_ge_u32 s40, 1
  s_cbranch_scc1 gemm1_kernel_wsk27
  s_add_u32 m0, s45, 112640
  s_add_u32 s46, s33, 32768
  buffer_load_dwordx4 v54, s[16:19], s46 offen lds
  gemm1_kernel_wsk27:
  s_waitcnt lgkmcnt(4)
  v_mfma_f32_16x16x32_bf16 v[4:7], v[28:31], v[24:27], v[4:7]
  v_mfma_f32_16x16x32_bf16 v[8:11], v[32:35], v[24:27], v[8:11]
  s_waitcnt lgkmcnt(2)
  v_mfma_f32_16x16x32_bf16 v[12:15], v[36:39], v[24:27], v[12:15]
  s_waitcnt lgkmcnt(0)
  v_mfma_f32_16x16x32_bf16 v[16:19], v[40:43], v[24:27], v[16:19]
  s_waitcnt vmcnt(0)
  s_barrier
  ds_read_b64_tr_b16 v[28:29], v48 offset:0
  ds_read_b64_tr_b16 v[30:31], v48 offset:512
  ds_read_b128 v[20:23], v44 offset:0
  ds_read_b64_tr_b16 v[32:33], v48 offset:32
  ds_read_b64_tr_b16 v[34:35], v48 offset:544
  ds_read_b64_tr_b16 v[36:37], v48 offset:64
  ds_read_b64_tr_b16 v[38:39], v48 offset:576
  ds_read_b64_tr_b16 v[40:41], v48 offset:96
  ds_read_b64_tr_b16 v[42:43], v48 offset:608
  s_add_u32 m0, s44, 121856
  s_add_u32 s46, s43, 640
  buffer_load_dwordx4 v50, s[4:7], s46 offen lds
  s_waitcnt lgkmcnt(6)
  v_mfma_f32_16x16x32_bf16 v[4:7], v[28:31], v[20:23], v[4:7]
  ds_read_b64_tr_b16 v[28:29], v48 offset:4224
  ds_read_b64_tr_b16 v[30:31], v48 offset:4736
  s_add_u32 m0, s44, 122880
  s_add_u32 s46, s43, 9856
  buffer_load_dwordx4 v51, s[4:7], s46 offen lds
  s_waitcnt lgkmcnt(6)
  v_mfma_f32_16x16x32_bf16 v[8:11], v[32:35], v[20:23], v[8:11]
  ds_read_b64_tr_b16 v[32:33], v48 offset:4256
  ds_read_b64_tr_b16 v[34:35], v48 offset:4768
  ds_read_b128 v[24:27], v45 offset:0
  s_add_u32 m0, s45, 121856
  s_add_u32 s46, s33, 40960
  buffer_load_dwordx4 v52, s[16:19], s46 offen lds
  s_waitcnt lgkmcnt(7)
  v_mfma_f32_16x16x32_bf16 v[12:15], v[36:39], v[20:23], v[12:15]
  ds_read_b64_tr_b16 v[36:37], v48 offset:4288
  ds_read_b64_tr_b16 v[38:39], v48 offset:4800
  s_add_u32 m0, s45, 125952
  s_add_u32 s46, s33, 40960
  buffer_load_dwordx4 v53, s[16:19], s46 offen lds
  s_waitcnt lgkmcnt(7)
  v_mfma_f32_16x16x32_bf16 v[16:19], v[40:43], v[20:23], v[16:19]
  ds_read_b64_tr_b16 v[40:41], v48 offset:4320
  ds_read_b64_tr_b16 v[42:43], v48 offset:4832
  s_cmp_ge_u32 s40, 1
  s_cbranch_scc1 gemm1_kernel_wsk28
  s_add_u32 m0, s45, 130048
  s_add_u32 s46, s33, 40960
  buffer_load_dwordx4 v54, s[16:19], s46 offen lds
  gemm1_kernel_wsk28:
  s_waitcnt lgkmcnt(4)
  v_mfma_f32_16x16x32_bf16 v[4:7], v[28:31], v[24:27], v[4:7]
  v_mfma_f32_16x16x32_bf16 v[8:11], v[32:35], v[24:27], v[8:11]
  s_waitcnt lgkmcnt(2)
  v_mfma_f32_16x16x32_bf16 v[12:15], v[36:39], v[24:27], v[12:15]
  s_waitcnt lgkmcnt(0)
  v_mfma_f32_16x16x32_bf16 v[16:19], v[40:43], v[24:27], v[16:19]
  s_waitcnt vmcnt(0)
  s_barrier
  ds_read_b64_tr_b16 v[28:29], v49 offset:0
  ds_read_b64_tr_b16 v[30:31], v49 offset:512
  ds_read_b128 v[20:23], v46 offset:0
  ds_read_b64_tr_b16 v[32:33], v49 offset:32
  ds_read_b64_tr_b16 v[34:35], v49 offset:544
  ds_read_b64_tr_b16 v[36:37], v49 offset:64
  ds_read_b64_tr_b16 v[38:39], v49 offset:576
  ds_read_b64_tr_b16 v[40:41], v49 offset:96
  ds_read_b64_tr_b16 v[42:43], v49 offset:608
  s_add_u32 m0, s44, 104448
  s_add_u32 s46, s43, 768
  buffer_load_dwordx4 v50, s[4:7], s46 offen lds
  s_waitcnt lgkmcnt(6)
  v_mfma_f32_16x16x32_bf16 v[4:7], v[28:31], v[20:23], v[4:7]
  ds_read_b64_tr_b16 v[28:29], v49 offset:4224
  ds_read_b64_tr_b16 v[30:31], v49 offset:4736
  s_add_u32 m0, s44, 105472
  s_add_u32 s46, s43, 9984
  buffer_load_dwordx4 v51, s[4:7], s46 offen lds
  s_waitcnt lgkmcnt(6)
  v_mfma_f32_16x16x32_bf16 v[8:11], v[32:35], v[20:23], v[8:11]
  ds_read_b64_tr_b16 v[32:33], v49 offset:4256
  ds_read_b64_tr_b16 v[34:35], v49 offset:4768
  ds_read_b128 v[24:27], v47 offset:0
  s_add_u32 m0, s45, 104448
  s_add_u32 s46, s33, 49152
  buffer_load_dwordx4 v52, s[16:19], s46 offen lds
  s_waitcnt lgkmcnt(7)
  v_mfma_f32_16x16x32_bf16 v[12:15], v[36:39], v[20:23], v[12:15]
  ds_read_b64_tr_b16 v[36:37], v49 offset:4288
  ds_read_b64_tr_b16 v[38:39], v49 offset:4800
  s_add_u32 m0, s45, 108544
  s_add_u32 s46, s33, 49152
  buffer_load_dwordx4 v53, s[16:19], s46 offen lds
  s_waitcnt lgkmcnt(7)
  v_mfma_f32_16x16x32_bf16 v[16:19], v[40:43], v[20:23], v[16:19]
  ds_read_b64_tr_b16 v[40:41], v49 offset:4320
  ds_read_b64_tr_b16 v[42:43], v49 offset:4832
  s_cmp_ge_u32 s40, 1
  s_cbranch_scc1 gemm1_kernel_wsk29
  s_add_u32 m0, s45, 112640
  s_add_u32 s46, s33, 49152
  buffer_load_dwordx4 v54, s[16:19], s46 offen lds
  gemm1_kernel_wsk29:
  s_waitcnt lgkmcnt(4)
  v_mfma_f32_16x16x32_bf16 v[4:7], v[28:31], v[24:27], v[4:7]
  v_mfma_f32_16x16x32_bf16 v[8:11], v[32:35], v[24:27], v[8:11]
  s_waitcnt lgkmcnt(2)
  v_mfma_f32_16x16x32_bf16 v[12:15], v[36:39], v[24:27], v[12:15]
  s_waitcnt lgkmcnt(0)
  v_mfma_f32_16x16x32_bf16 v[16:19], v[40:43], v[24:27], v[16:19]
  s_waitcnt vmcnt(0)
  s_barrier
  ds_read_b64_tr_b16 v[28:29], v48 offset:0
  ds_read_b64_tr_b16 v[30:31], v48 offset:512
  ds_read_b128 v[20:23], v44 offset:0
  ds_read_b64_tr_b16 v[32:33], v48 offset:32
  ds_read_b64_tr_b16 v[34:35], v48 offset:544
  ds_read_b64_tr_b16 v[36:37], v48 offset:64
  ds_read_b64_tr_b16 v[38:39], v48 offset:576
  ds_read_b64_tr_b16 v[40:41], v48 offset:96
  ds_read_b64_tr_b16 v[42:43], v48 offset:608
  s_add_u32 m0, s44, 121856
  s_add_u32 s46, s43, 896
  buffer_load_dwordx4 v50, s[4:7], s46 offen lds
  s_waitcnt lgkmcnt(6)
  v_mfma_f32_16x16x32_bf16 v[4:7], v[28:31], v[20:23], v[4:7]
  ds_read_b64_tr_b16 v[28:29], v48 offset:4224
  ds_read_b64_tr_b16 v[30:31], v48 offset:4736
  s_add_u32 m0, s44, 122880
  s_add_u32 s46, s43, 10112
  buffer_load_dwordx4 v51, s[4:7], s46 offen lds
  s_waitcnt lgkmcnt(6)
  v_mfma_f32_16x16x32_bf16 v[8:11], v[32:35], v[20:23], v[8:11]
  ds_read_b64_tr_b16 v[32:33], v48 offset:4256
  ds_read_b64_tr_b16 v[34:35], v48 offset:4768
  ds_read_b128 v[24:27], v45 offset:0
  s_add_u32 m0, s45, 121856
  s_add_u32 s46, s33, 57344
  buffer_load_dwordx4 v52, s[16:19], s46 offen lds
  s_waitcnt lgkmcnt(7)
  v_mfma_f32_16x16x32_bf16 v[12:15], v[36:39], v[20:23], v[12:15]
  ds_read_b64_tr_b16 v[36:37], v48 offset:4288
  ds_read_b64_tr_b16 v[38:39], v48 offset:4800
  s_add_u32 m0, s45, 125952
  s_add_u32 s46, s33, 57344
  buffer_load_dwordx4 v53, s[16:19], s46 offen lds
  s_waitcnt lgkmcnt(7)
  v_mfma_f32_16x16x32_bf16 v[16:19], v[40:43], v[20:23], v[16:19]
  ds_read_b64_tr_b16 v[40:41], v48 offset:4320
  ds_read_b64_tr_b16 v[42:43], v48 offset:4832
  s_cmp_ge_u32 s40, 1
  s_cbranch_scc1 gemm1_kernel_wsk30
  s_add_u32 m0, s45, 130048
  s_add_u32 s46, s33, 57344
  buffer_load_dwordx4 v54, s[16:19], s46 offen lds
  gemm1_kernel_wsk30:
  s_waitcnt lgkmcnt(4)
  v_mfma_f32_16x16x32_bf16 v[4:7], v[28:31], v[24:27], v[4:7]
  v_mfma_f32_16x16x32_bf16 v[8:11], v[32:35], v[24:27], v[8:11]
  s_waitcnt lgkmcnt(2)
  v_mfma_f32_16x16x32_bf16 v[12:15], v[36:39], v[24:27], v[12:15]
  s_waitcnt lgkmcnt(0)
  v_mfma_f32_16x16x32_bf16 v[16:19], v[40:43], v[24:27], v[16:19]
  s_waitcnt vmcnt(0)
  s_barrier
  ds_read_b64_tr_b16 v[28:29], v49 offset:0
  ds_read_b64_tr_b16 v[30:31], v49 offset:512
  ds_read_b128 v[20:23], v46 offset:0
  ds_read_b64_tr_b16 v[32:33], v49 offset:32
  ds_read_b64_tr_b16 v[34:35], v49 offset:544
  ds_read_b64_tr_b16 v[36:37], v49 offset:64
  ds_read_b64_tr_b16 v[38:39], v49 offset:576
  ds_read_b64_tr_b16 v[40:41], v49 offset:96
  ds_read_b64_tr_b16 v[42:43], v49 offset:608
  s_add_u32 m0, s44, 104448
  s_add_u32 s46, s43, 1024
  buffer_load_dwordx4 v50, s[4:7], s46 offen lds
  s_waitcnt lgkmcnt(6)
  v_mfma_f32_16x16x32_bf16 v[4:7], v[28:31], v[20:23], v[4:7]
  ds_read_b64_tr_b16 v[28:29], v49 offset:4224
  ds_read_b64_tr_b16 v[30:31], v49 offset:4736
  s_add_u32 m0, s44, 105472
  s_add_u32 s46, s43, 10240
  buffer_load_dwordx4 v51, s[4:7], s46 offen lds
  s_waitcnt lgkmcnt(6)
  v_mfma_f32_16x16x32_bf16 v[8:11], v[32:35], v[20:23], v[8:11]
  ds_read_b64_tr_b16 v[32:33], v49 offset:4256
  ds_read_b64_tr_b16 v[34:35], v49 offset:4768
  ds_read_b128 v[24:27], v47 offset:0
  s_add_u32 m0, s45, 104448
  s_add_u32 s46, s33, 65536
  buffer_load_dwordx4 v52, s[16:19], s46 offen lds
  s_waitcnt lgkmcnt(7)
  v_mfma_f32_16x16x32_bf16 v[12:15], v[36:39], v[20:23], v[12:15]
  ds_read_b64_tr_b16 v[36:37], v49 offset:4288
  ds_read_b64_tr_b16 v[38:39], v49 offset:4800
  s_add_u32 m0, s45, 108544
  s_add_u32 s46, s33, 65536
  buffer_load_dwordx4 v53, s[16:19], s46 offen lds
  s_waitcnt lgkmcnt(7)
  v_mfma_f32_16x16x32_bf16 v[16:19], v[40:43], v[20:23], v[16:19]
  ds_read_b64_tr_b16 v[40:41], v49 offset:4320
  ds_read_b64_tr_b16 v[42:43], v49 offset:4832
  s_cmp_ge_u32 s40, 1
  s_cbranch_scc1 gemm1_kernel_wsk31
  s_add_u32 m0, s45, 112640
  s_add_u32 s46, s33, 65536
  buffer_load_dwordx4 v54, s[16:19], s46 offen lds
  gemm1_kernel_wsk31:
  s_waitcnt lgkmcnt(4)
  v_mfma_f32_16x16x32_bf16 v[4:7], v[28:31], v[24:27], v[4:7]
  v_mfma_f32_16x16x32_bf16 v[8:11], v[32:35], v[24:27], v[8:11]
  s_waitcnt lgkmcnt(2)
  v_mfma_f32_16x16x32_bf16 v[12:15], v[36:39], v[24:27], v[12:15]
  s_waitcnt lgkmcnt(0)
  v_mfma_f32_16x16x32_bf16 v[16:19], v[40:43], v[24:27], v[16:19]
  s_waitcnt vmcnt(0)
  s_barrier
  ds_read_b64_tr_b16 v[28:29], v48 offset:0
  ds_read_b64_tr_b16 v[30:31], v48 offset:512
  ds_read_b128 v[20:23], v44 offset:0
  ds_read_b64_tr_b16 v[32:33], v48 offset:32
  ds_read_b64_tr_b16 v[34:35], v48 offset:544
  ds_read_b64_tr_b16 v[36:37], v48 offset:64
  ds_read_b64_tr_b16 v[38:39], v48 offset:576
  ds_read_b64_tr_b16 v[40:41], v48 offset:96
  ds_read_b64_tr_b16 v[42:43], v48 offset:608
  s_waitcnt lgkmcnt(6)
  v_mfma_f32_16x16x32_bf16 v[4:7], v[28:31], v[20:23], v[4:7]
  ds_read_b64_tr_b16 v[28:29], v48 offset:4224
  ds_read_b64_tr_b16 v[30:31], v48 offset:4736
  s_waitcnt lgkmcnt(6)
  v_mfma_f32_16x16x32_bf16 v[8:11], v[32:35], v[20:23], v[8:11]
  ds_read_b64_tr_b16 v[32:33], v48 offset:4256
  ds_read_b64_tr_b16 v[34:35], v48 offset:4768
  ds_read_b128 v[24:27], v45 offset:0
  s_waitcnt lgkmcnt(7)
  v_mfma_f32_16x16x32_bf16 v[12:15], v[36:39], v[20:23], v[12:15]
  ds_read_b64_tr_b16 v[36:37], v48 offset:4288
  ds_read_b64_tr_b16 v[38:39], v48 offset:4800
  s_waitcnt lgkmcnt(7)
  v_mfma_f32_16x16x32_bf16 v[16:19], v[40:43], v[20:23], v[16:19]
  ds_read_b64_tr_b16 v[40:41], v48 offset:4320
  ds_read_b64_tr_b16 v[42:43], v48 offset:4832
  s_waitcnt lgkmcnt(4)
  v_mfma_f32_16x16x32_bf16 v[4:7], v[28:31], v[24:27], v[4:7]
  v_mfma_f32_16x16x32_bf16 v[8:11], v[32:35], v[24:27], v[8:11]
  s_waitcnt lgkmcnt(2)
  v_mfma_f32_16x16x32_bf16 v[12:15], v[36:39], v[24:27], v[12:15]
  s_waitcnt lgkmcnt(0)
  v_mfma_f32_16x16x32_bf16 v[16:19], v[40:43], v[24:27], v[16:19]
  s_nop 7
  s_nop 7
  v_and_b32 v55, 15, v0
  v_bfe_u32 v56, v0, 4, 2
  s_lshl_b32 s34, s41, 4
  s_lshl_b32 s35, s30, 6
  s_add_u32 s34, s34, s35
  v_add_u32 v55, s34, v55
  v_mov_b32 v20, 0x80000000
  v_lshrrev_b32 v57, 5, v55
  v_lshlrev_b32 v57, 10, v57
  v_and_b32 v58, 31, v55
  v_lshl_add_u32 v57, v58, 4, v57
  v_lshrrev_b32 v58, 1, v56
  v_lshl_add_u32 v57, v58, 9, v57
  v_and_b32 v58, 1, v56
  v_lshl_add_u32 v57, v58, 3, v57
  v_cvt_pk_bf16_f32 v4, v4, v5
  v_cvt_pk_bf16_f32 v5, v6, v7
  buffer_store_dwordx2 v[4:5], v57, s[20:23], 0 offen
  v_cmp_eq_u32 vcc, 0, v56
  v_lshlrev_b32 v57, 2, v55
  v_add_u32 v57, 65536, v57
  v_cndmask_b32 v57, v20, v57, vcc
  v_cvt_pk_bf16_f32 v8, v8, v9
  buffer_store_dword v8, v57, s[20:23], 0 offen
  v_lshrrev_b32 v57, 4, v55
  v_lshlrev_b32 v57, 10, v57
  v_bfe_u32 v58, v55, 2, 1
  v_lshl_add_u32 v57, v58, 9, v57
  v_and_b32 v58, 3, v55
  v_lshl_add_u32 v57, v58, 1, v57
  v_bfe_u32 v58, v55, 3, 1
  v_lshl_add_u32 v57, v58, 3, v57
  v_add_u32 v57, 73728, v57
  v_lshl_add_u32 v58, v56, 6, v57
  v_cvt_pk_bf16_f32 v12, v12, v13
  v_cvt_pk_bf16_f32 v13, v14, v15
  buffer_store_short v12, v58, s[20:23], 0 offen
  buffer_store_short_d16_hi v12, v58, s[20:23], 0 offen offset:16
  buffer_store_short v13, v58, s[20:23], 0 offen offset:32
  buffer_store_short_d16_hi v13, v58, s[20:23], 0 offen offset:48
  v_cndmask_b32 v58, v20, v57, vcc
  v_cvt_pk_bf16_f32 v16, v16, v17
  v_mov_b32 v17, 0x3f80
  buffer_store_short v16, v58, s[20:23], 0 offen offset:256
  buffer_store_short_d16_hi v16, v58, s[20:23], 0 offen offset:272
  buffer_store_short v17, v58, s[20:23], 0 offen offset:288
  s_branch gemm1_kernel_done1
gemm1_kernel_pf13:
  s_load_dwordx2 s[4:5], s[0:1], 64
  s_load_dwordx2 s[8:9], s[0:1], 32
  s_waitcnt lgkmcnt(0)
  s_mov_b32 s6, 5308416
  s_mov_b32 s7, 0x00020000
  s_mov_b32 s10, 663552
  s_mov_b32 s11, 0x00020000
  v_lshlrev_b32 v4, 4, v0
  s_sub_u32 s3, s2, 160
  s_lshl_b32 s3, s3, 12
  s_add_u32 s29, s3, 0
  buffer_load_dwordx4 v[8:11], v4, s[4:7], s29 offen
  s_add_u32 s29, s3, 393216
  buffer_load_dwordx4 v[8:11], v4, s[4:7], s29 offen
  s_add_u32 s29, s3, 786432
  buffer_load_dwordx4 v[8:11], v4, s[4:7], s29 offen
  s_add_u32 s29, s3, 1179648
  buffer_load_dwordx4 v[8:11], v4, s[4:7], s29 offen
  s_add_u32 s29, s3, 1572864
  buffer_load_dwordx4 v[8:11], v4, s[4:7], s29 offen
  s_add_u32 s29, s3, 1966080
  buffer_load_dwordx4 v[8:11], v4, s[4:7], s29 offen
  s_add_u32 s29, s3, 2359296
  buffer_load_dwordx4 v[8:11], v4, s[4:7], s29 offen
  s_add_u32 s29, s3, 2752512
  buffer_load_dwordx4 v[8:11], v4, s[4:7], s29 offen
  s_add_u32 s29, s3, 3145728
  buffer_load_dwordx4 v[8:11], v4, s[4:7], s29 offen
  s_add_u32 s29, s3, 3538944
  buffer_load_dwordx4 v[8:11], v4, s[4:7], s29 offen
  s_add_u32 s29, s3, 3932160
  buffer_load_dwordx4 v[8:11], v4, s[4:7], s29 offen
  s_add_u32 s29, s3, 4325376
  buffer_load_dwordx4 v[8:11], v4, s[4:7], s29 offen
  s_add_u32 s29, s3, 4718592
  buffer_load_dwordx4 v[8:11], v4, s[4:7], s29 offen
  s_add_u32 s29, s3, 5111808
  buffer_load_dwordx4 v[8:11], v4, s[4:7], s29 offen
  s_add_u32 s29, s3, 0
  buffer_load_dwordx4 v[8:11], v4, s[8:11], s29 offen
  s_add_u32 s29, s3, 393216
  buffer_load_dwordx4 v[8:11], v4, s[8:11], s29 offen
gemm1_kernel_done1:
  s_endpgm
.globl gemm2_kernel
.p2align 8
.type gemm2_kernel,@function
gemm2_kernel:
  s_cmp_ge_u32 s2, 256
  s_cbranch_scc1 gemm2_kernel_done1
  v_lshrrev_b32 v1, 9, v0
  s_nop 0
  v_readfirstlane_b32 s3, v1
  s_nop 3
  s_cmp_lg_u32 s3, 0
  s_cbranch_scc1 gemm2_kernel_att2
  s_load_dwordx2 s[4:5], s[0:1], 96
  s_load_dwordx2 s[8:9], s[0:1], 64
  s_load_dwordx2 s[12:13], s[0:1], 96
  s_waitcnt lgkmcnt(0)
  s_add_u32 s4, s4, 9723904
  s_addc_u32 s5, s5, 0
  s_mov_b32 s6, 18874368
  s_mov_b32 s7, 0x00020000
  s_mov_b32 s10, 5308416
  s_mov_b32 s11, 0x00020000
  s_add_u32 s12, s12, 28598272
  s_addc_u32 s13, s13, 0
  s_mov_b32 s14, 18874368
  s_mov_b32 s15, 0x00020000
  s_and_b32 s34, s2, 1
  s_lshl_b32 s34, s34, 3
  s_bfe_u32 s35, s2, 0x30003
  s_add_u32 s30, s34, s35
  s_lshr_b32 s36, s2, 6
  s_bfe_u32 s37, s2, 0x20001
  s_mul_i32 s32, s30, 1179648
  s_mul_i32 s34, s37, 36864
  s_add_u32 s32, s32, s34
  s_mul_i32 s33, s37, 1327104
  s_mul_i32 s34, s36, 288
  s_add_u32 s33, s33, s34
  v_lshrrev_b32 v114, 6, v0
  s_nop 0
  v_readfirstlane_b32 s40, v114
  v_and_b32 v115, 63, v0
  s_nop 2
  s_and_b32 s41, s40, 3
  s_lshr_b32 s42, s40, 2
  v_lshrrev_b32 v114, 3, v115
  v_lshlrev_b32 v114, 4, v114
  v_lshrrev_b32 v116, 4, v115
  v_and_b32 v117, 7, v115
  v_xor_b32 v116, v116, v117
  v_lshl_add_u32 v109, v116, 8, v114
  v_xor_b32 v116, 4, v116
  v_lshl_add_u32 v110, v116, 8, v114
  v_lshlrev_b32 v109, 4, v115
  v_add_u32 v110, 1024, v109
  s_mul_i32 s43, s40, 147456
  s_add_u32 s43, s43, s32
  s_mul_i32 s44, s40, 2048
  s_lshl_b32 s45, s40, 10
  s_add_u32 s45, s45, 16384
  s_lshl_b32 s46, s40, 6
  s_add_u32 s46, s46, 0
  v_add_u32 v114, s46, v115
  s_mov_b32 s46, 1725
  v_mul_lo_u32 v116, v114, s46
  v_lshrrev_b32 v116, 18, v116
  v_mul_u32_u24 v117, 152, v116
  v_sub_u32 v114, v114, v117
  v_mul_u32_u24 v117, 57, v114
  v_lshrrev_b32 v117, 10, v117
  v_mul_u32_u24 v111, 18, v117
  v_sub_u32 v111, v114, v111
  v_lshlrev_b32 v111, 4, v111
  v_lshl_add_u32 v117, v116, 3, v117
  s_mov_b32 s46, 1152
  v_mul_lo_u32 v117, v117, s46
  v_add_u32 v111, v111, v117
  v_cmp_gt_u32 vcc, 144, v114
  v_cmp_gt_u32 s[48:49], 8, v116
  s_nop 1
  s_and_b64 vcc, vcc, s[48:49]
  v_mov_b32 v117, 0x80000000
  s_nop 1
  v_cndmask_b32 v111, v117, v111, vcc
  s_lshl_b32 s46, s40, 6
  s_add_u32 s46, s46, 512
  v_add_u32 v114, s46, v115
  s_mov_b32 s46, 1725
  v_mul_lo_u32 v116, v114, s46
  v_lshrrev_b32 v116, 18, v116
  v_mul_u32_u24 v117, 152, v116
  v_sub_u32 v114, v114, v117
  v_mul_u32_u24 v117, 57, v114
  v_lshrrev_b32 v117, 10, v117
  v_mul_u32_u24 v112, 18, v117
  v_sub_u32 v112, v114, v112
  v_lshlrev_b32 v112, 4, v112
  v_lshl_add_u32 v117, v116, 3, v117
  s_mov_b32 s46, 1152
  v_mul_lo_u32 v117, v117, s46
  v_add_u32 v112, v112, v117
  v_cmp_gt_u32 vcc, 144, v114
  v_cmp_gt_u32 s[48:49], 8, v116
  s_nop 1
  s_and_b64 vcc, vcc, s[48:49]
  v_mov_b32 v117, 0x80000000
  s_nop 1
  v_cndmask_b32 v112, v117, v112, vcc
  s_lshl_b32 s46, s40, 6
  s_add_u32 s46, s46, 1024
  v_add_u32 v114, s46, v115
  s_mov_b32 s46, 1725
  v_mul_lo_u32 v116, v114, s46
  v_lshrrev_b32 v116, 18, v116
  v_mul_u32_u24 v117, 152, v116
  v_sub_u32 v114, v114, v117
  v_mul_u32_u24 v117, 57, v114
  v_lshrrev_b32 v117, 10, v117
  v_mul_u32_u24 v113, 18, v117
  v_sub_u32 v113, v114, v113
  v_lshlrev_b32 v113, 4, v113
  v_lshl_add_u32 v117, v116, 3, v117
  s_mov_b32 s46, 1152
  v_mul_lo_u32 v117, v117, s46
  v_add_u32 v113, v113, v117
  v_cmp_gt_u32 vcc, 144, v114
  v_cmp_gt_u32 s[48:49], 8, v116
  s_nop 1
  s_and_b64 vcc, vcc, s[48:49]
  v_mov_b32 v117, 0x80000000
  s_nop 1
  v_cndmask_b32 v113, v117, v113, vcc
  s_add_u32 m0, s44, 0
  s_add_u32 s46, s43, 0
  buffer_load_dwordx4 v109, s[4:7], s46 offen lds
  s_add_u32 m0, s44, 1024
  s_add_u32 s46, s43, 0
  buffer_load_dwordx4 v110, s[4:7], s46 offen lds
  s_add_u32 m0, s45, 0
  s_add_u32 s46, s33, 0
  buffer_load_dwordx4 v111, s[8:11], s46 offen lds
  s_add_u32 m0, s45, 8192
  s_add_u32 s46, s33, 0
  buffer_load_dwordx4 v112, s[8:11], s46 offen lds
  s_cmp_ge_u32 s40, 3
  s_cbranch_scc1 gemm2_kernel_wsk3
  s_add_u32 m0, s45, 16384
  s_add_u32 s46, s33, 0
  buffer_load_dwordx4 v113, s[8:11], s46 offen lds
  gemm2_kernel_wsk3:
  s_add_u32 m0, s44, 35840
  s_add_u32 s46, s43, 2048
  buffer_load_dwordx4 v109, s[4:7], s46 offen lds
  s_add_u32 m0, s44, 36864
  s_add_u32 s46, s43, 2048
  buffer_load_dwordx4 v110, s[4:7], s46 offen lds
  s_add_u32 m0, s45, 35840
  s_add_u32 s46, s33, 73728
  buffer_load_dwordx4 v111, s[8:11], s46 offen lds
  s_add_u32 m0, s45, 44032
  s_add_u32 s46, s33, 73728
  buffer_load_dwordx4 v112, s[8:11], s46 offen lds
  s_cmp_ge_u32 s40, 3
  s_cbranch_scc1 gemm2_kernel_wsk4
  s_add_u32 m0, s45, 52224
  s_add_u32 s46, s33, 73728
  buffer_load_dwordx4 v113, s[8:11], s46 offen lds
  gemm2_kernel_wsk4:
  v_and_b32 v114, 15, v115
  v_lshrrev_b32 v116, 4, v115
  v_lshrrev_b32 v117, 1, v114
  v_xor_b32 v117, v117, v116
  v_lshlrev_b32 v114, 4, v114
  v_lshl_add_u32 v100, v116, 8, v114
  s_mul_i32 s46, s41, 4096
  v_add_u32 v100, s46, v100
  s_lshl_b32 s46, s42, 10
  v_xor_b32 v100, s46, v100
  v_xor_b32 v101, 1024, v100
  v_bfe_u32 v114, v115, 2, 2
  v_lshl_add_u32 v114, v116, 3, v114
  v_mul_u32_u24 v114, 288, v114
  v_mul_u32_u24 v117, 128, v116
  v_add_u32 v114, v114, v117
  v_and_b32 v117, 3, v115
  v_lshl_add_u32 v106, v117, 3, v114
  s_mul_i32 s46, s42, 9728
  s_add_u32 s46, s46, 16384
  v_add_u32 v106, s46, v106
  v_add_u32 v102, 35840, v100
  v_add_u32 v103, 35840, v101
  v_add_u32 v107, 35840, v106
  v_add_u32 v104, 71680, v100
  v_add_u32 v105, 71680, v101
  v_add_u32 v108, 71680, v106
  v_mov_b32 v4, 0
  v_mov_b32 v5, 0
  v_mov_b32 v6, 0
  v_mov_b32 v7, 0
  v_mov_b32 v8, 0
  v_mov_b32 v9, 0
  v_mov_b32 v10, 0
  v_mov_b32 v11, 0
  v_mov_b32 v12, 0
  v_mov_b32 v13, 0
  v_mov_b32 v14, 0
  v_mov_b32 v15, 0
  v_mov_b32 v16, 0
  v_mov_b32 v17, 0
  v_mov_b32 v18, 0
  v_mov_b32 v19, 0
  v_mov_b32 v20, 0
  v_mov_b32 v21, 0
  v_mov_b32 v22, 0
  v_mov_b32 v23, 0
  v_mov_b32 v24, 0
  v_mov_b32 v25, 0
  v_mov_b32 v26, 0
  v_mov_b32 v27, 0
  v_mov_b32 v28, 0
  v_mov_b32 v29, 0
  v_mov_b32 v30, 0
  v_mov_b32 v31, 0
  v_mov_b32 v32, 0
  v_mov_b32 v33, 0
  v_mov_b32 v34, 0
  v_mov_b32 v35, 0
  v_mov_b32 v36, 0
  v_mov_b32 v37, 0
  v_mov_b32 v38, 0
  v_mov_b32 v39, 0
  v_mov_b32 v40, 0
  v_mov_b32 v41, 0
  v_mov_b32 v42, 0
  v_mov_b32 v43, 0
  v_mov_b32 v44, 0
  v_mov_b32 v45, 0
  v_mov_b32 v46, 0
  v_mov_b32 v47, 0
  v_mov_b32 v48, 0
  v_mov_b32 v49, 0
  v_mov_b32 v50, 0
  v_mov_b32 v51, 0
  v_mov_b32 v52, 0
  v_mov_b32 v53, 0
  v_mov_b32 v54, 0
  v_mov_b32 v55, 0
  v_mov_b32 v56, 0
  v_mov_b32 v57, 0
  v_mov_b32 v58, 0
  v_mov_b32 v59, 0
  v_mov_b32 v60, 0
  v_mov_b32 v61, 0
  v_mov_b32 v62, 0
  v_mov_b32 v63, 0
  v_mov_b32 v64, 0
  v_mov_b32 v65, 0
  v_mov_b32 v66, 0
  v_mov_b32 v67, 0
  v_mov_b32 v68, 0
  v_mov_b32 v69, 0
  v_mov_b32 v70, 0
  v_mov_b32 v71, 0
  v_mov_b32 v72, 0
  v_mov_b32 v73, 0
  v_mov_b32 v74, 0
  v_mov_b32 v75, 0
  s_waitcnt vmcnt(4)
  s_barrier
  ds_read_b64_tr_b16 v[84:85], v106 offset:0
  ds_read_b64_tr_b16 v[86:87], v106 offset:1152
  ds_read_b128 v[76:79], v100 offset:0
  ds_read_b128 v[80:83], v100 offset:2048
  ds_read_b64_tr_b16 v[88:89], v106 offset:32
  ds_read_b64_tr_b16 v[90:91], v106 offset:1184
  ds_read_b64_tr_b16 v[92:93], v106 offset:64
  ds_read_b64_tr_b16 v[94:95], v106 offset:1216
  ds_read_b64_tr_b16 v[96:97], v106 offset:96
  ds_read_b64_tr_b16 v[98:99], v106 offset:1248
  s_add_u32 m0, s44, 71680
  s_add_u32 s46, s43, 4096
  buffer_load_dwordx4 v109, s[4:7], s46 offen lds
  s_waitcnt lgkmcnt(6)
  v_mfma_f32_16x16x32_bf16 v[4:7], v[84:87], v[76:79], v[4:7]
  v_mfma_f32_16x16x32_bf16 v[40:43], v[84:87], v[80:83], v[40:43]
  ds_read_b64_tr_b16 v[84:85], v106 offset:128
  ds_read_b64_tr_b16 v[86:87], v106 offset:1280
  s_add_u32 m0, s44, 72704
  s_add_u32 s46, s43, 4096
  buffer_load_dwordx4 v110, s[4:7], s46 offen lds
  s_waitcnt lgkmcnt(6)
  v_mfma_f32_16x16x32_bf16 v[8:11], v[88:91], v[76:79], v[8:11]
  v_mfma_f32_16x16x32_bf16 v[44:47], v[88:91], v[80:83], v[44:47]
  ds_read_b64_tr_b16 v[88:89], v106 offset:160
  ds_read_b64_tr_b16 v[90:91], v106 offset:1312
  s_add_u32 m0, s45, 71680
  s_add_u32 s46, s33, 147456
  buffer_load_dwordx4 v111, s[8:11], s46 offen lds
  s_waitcnt lgkmcnt(6)
  v_mfma_f32_16x16x32_bf16 v[12:15], v[92:95], v[76:79], v[12:15]
  v_mfma_f32_16x16x32_bf16 v[48:51], v[92:95], v[80:83], v[48:51]
  ds_read_b64_tr_b16 v[92:93], v106 offset:192
  ds_read_b64_tr_b16 v[94:95], v106 offset:1344
  s_add_u32 m0, s45, 79872
  s_add_u32 s46, s33, 147456
  buffer_load_dwordx4 v112, s[8:11], s46 offen lds
  s_waitcnt lgkmcnt(6)
  v_mfma_f32_16x16x32_bf16 v[16:19], v[96:99], v[76:79], v[16:19]
  v_mfma_f32_16x16x32_bf16 v[52:55], v[96:99], v[80:83], v[52:55]
  ds_read_b64_tr_b16 v[96:97], v106 offset:224
  ds_read_b64_tr_b16 v[98:99], v106 offset:1376
  s_cmp_ge_u32 s40, 3
  s_cbranch_scc1 gemm2_kernel_wsk5
  s_add_u32 m0, s45, 88064
  s_add_u32 s46, s33, 147456
  buffer_load_dwordx4 v113, s[8:11], s46 offen lds
  gemm2_kernel_wsk5:
  s_waitcnt lgkmcnt(6)
  v_mfma_f32_16x16x32_bf16 v[20:23], v[84:87], v[76:79], v[20:23]
  v_mfma_f32_16x16x32_bf16 v[56:59], v[84:87], v[80:83], v[56:59]
  ds_read_b64_tr_b16 v[84:85], v106 offset:256
  ds_read_b64_tr_b16 v[86:87], v106 offset:1408
  s_waitcnt lgkmcnt(6)
  v_mfma_f32_16x16x32_bf16 v[24:27], v[88:91], v[76:79], v[24:27]
  v_mfma_f32_16x16x32_bf16 v[60:63], v[88:91], v[80:83], v[60:63]
  s_waitcnt lgkmcnt(4)
  v_mfma_f32_16x16x32_bf16 v[28:31], v[92:95], v[76:79], v[28:31]
  v_mfma_f32_16x16x32_bf16 v[64:67], v[92:95], v[80:83], v[64:67]
  s_waitcnt lgkmcnt(2)
  v_mfma_f32_16x16x32_bf16 v[32:35], v[96:99], v[76:79], v[32:35]
  v_mfma_f32_16x16x32_bf16 v[68:71], v[96:99], v[80:83], v[68:71]
  s_waitcnt lgkmcnt(0)
  v_mfma_f32_16x16x32_bf16 v[36:39], v[84:87], v[76:79], v[36:39]
  v_mfma_f32_16x16x32_bf16 v[72:75], v[84:87], v[80:83], v[72:75]
  s_waitcnt vmcnt(4)
  s_barrier
  ds_read_b64_tr_b16 v[84:85], v107 offset:0
  ds_read_b64_tr_b16 v[86:87], v107 offset:1152
  ds_read_b128 v[76:79], v102 offset:0
  ds_read_b128 v[80:83], v102 offset:2048
  ds_read_b64_tr_b16 v[88:89], v107 offset:32
  ds_read_b64_tr_b16 v[90:91], v107 offset:1184
  ds_read_b64_tr_b16 v[92:93], v107 offset:64
  ds_read_b64_tr_b16 v[94:95], v107 offset:1216
  ds_read_b64_tr_b16 v[96:97], v107 offset:96
  ds_read_b64_tr_b16 v[98:99], v107 offset:1248
  s_add_u32 m0, s44, 0
  s_add_u32 s46, s43, 6144
  buffer_load_dwordx4 v109, s[4:7], s46 offen lds
  s_waitcnt lgkmcnt(6)
  v_mfma_f32_16x16x32_bf16 v[4:7], v[84:87], v[76:79], v[4:7]
  v_mfma_f32_16x16x32_bf16 v[40:43], v[84:87], v[80:83], v[40:43]
  ds_read_b64_tr_b16 v[84:85], v107 offset:128
  ds_read_b64_tr_b16 v[86:87], v107 offset:1280
  s_add_u32 m0, s44, 1024
  s_add_u32 s46, s43, 6144
  buffer_load_dwordx4 v110, s[4:7], s46 offen lds
  s_waitcnt lgkmcnt(6)
  v_mfma_f32_16x16x32_bf16 v[8:11], v[88:91], v[76:79], v[8:11]
  v_mfma_f32_16x16x32_bf16 v[44:47], v[88:91], v[80:83], v[44:47]
  ds_read_b64_tr_b16 v[88:89], v107 offset:160
  ds_read_b64_tr_b16 v[90:91], v107 offset:1312
  s_add_u32 m0, s45, 0
  s_add_u32 s46, s33, 221184
  buffer_load_dwordx4 v111, s[8:11], s46 offen lds
  s_waitcnt lgkmcnt(6)
  v_mfma_f32_16x16x32_bf16 v[12:15], v[92:95], v[76:79], v[12:15]
  v_mfma_f32_16x16x32_bf16 v[48:51], v[92:95], v[80:83], v[48:51]
  ds_read_b64_tr_b16 v[92:93], v107 offset:192
  ds_read_b64_tr_b16 v[94:95], v107 offset:1344
  s_add_u32 m0, s45, 8192
  s_add_u32 s46, s33, 221184
  buffer_load_dwordx4 v112, s[8:11], s46 offen lds
  s_waitcnt lgkmcnt(6)
  v_mfma_f32_16x16x32_bf16 v[16:19], v[96:99], v[76:79], v[16:19]
  v_mfma_f32_16x16x32_bf16 v[52:55], v[96:99], v[80:83], v[52:55]
  ds_read_b64_tr_b16 v[96:97], v107 offset:224
  ds_read_b64_tr_b16 v[98:99], v107 offset:1376
  s_cmp_ge_u32 s40, 3
  s_cbranch_scc1 gemm2_kernel_wsk6
  s_add_u32 m0, s45, 16384
  s_add_u32 s46, s33, 221184
  buffer_load_dwordx4 v113, s[8:11], s46 offen lds
  gemm2_kernel_wsk6:
  s_waitcnt lgkmcnt(6)
  v_mfma_f32_16x16x32_bf16 v[20:23], v[84:87], v[76:79], v[20:23]
  v_mfma_f32_16x16x32_bf16 v[56:59], v[84:87], v[80:83], v[56:59]
  ds_read_b64_tr_b16 v[84:85], v107 offset:256
  ds_read_b64_tr_b16 v[86:87], v107 offset:1408
  s_waitcnt lgkmcnt(6)
  v_mfma_f32_16x16x32_bf16 v[24:27], v[88:91], v[76:79], v[24:27]
  v_mfma_f32_16x16x32_bf16 v[60:63], v[88:91], v[80:83], v[60:63]
  s_waitcnt lgkmcnt(4)
  v_mfma_f32_16x16x32_bf16 v[28:31], v[92:95], v[76:79], v[28:31]
  v_mfma_f32_16x16x32_bf16 v[64:67], v[92:95], v[80:83], v[64:67]
  s_waitcnt lgkmcnt(2)
  v_mfma_f32_16x16x32_bf16 v[32:35], v[96:99], v[76:79], v[32:35]
  v_mfma_f32_16x16x32_bf16 v[68:71], v[96:99], v[80:83], v[68:71]
  s_waitcnt lgkmcnt(0)
  v_mfma_f32_16x16x32_bf16 v[36:39], v[84:87], v[76:79], v[36:39]
  v_mfma_f32_16x16x32_bf16 v[72:75], v[84:87], v[80:83], v[72:75]
  s_waitcnt vmcnt(4)
  s_barrier
  ds_read_b64_tr_b16 v[84:85], v108 offset:0
  ds_read_b64_tr_b16 v[86:87], v108 offset:1152
  ds_read_b128 v[76:79], v104 offset:0
  ds_read_b128 v[80:83], v104 offset:2048
  ds_read_b64_tr_b16 v[88:89], v108 offset:32
  ds_read_b64_tr_b16 v[90:91], v108 offset:1184
  ds_read_b64_tr_b16 v[92:93], v108 offset:64
  ds_read_b64_tr_b16 v[94:95], v108 offset:1216
  ds_read_b64_tr_b16 v[96:97], v108 offset:96
  ds_read_b64_tr_b16 v[98:99], v108 offset:1248
  s_add_u32 m0, s44, 35840
  s_add_u32 s46, s43, 8192
  buffer_load_dwordx4 v109, s[4:7], s46 offen lds
  s_waitcnt lgkmcnt(6)
  v_mfma_f32_16x16x32_bf16 v[4:7], v[84:87], v[76:79], v[4:7]
  v_mfma_f32_16x16x32_bf16 v[40:43], v[84:87], v[80:83], v[40:43]
  ds_read_b64_tr_b16 v[84:85], v108 offset:128
  ds_read_b64_tr_b16 v[86:87], v108 offset:1280
  s_add_u32 m0, s44, 36864
  s_add_u32 s46, s43, 8192
  buffer_load_dwordx4 v110, s[4:7], s46 offen lds
  s_waitcnt lgkmcnt(6)
  v_mfma_f32_16x16x32_bf16 v[8:11], v[88:91], v[76:79], v[8:11]
  v_mfma_f32_16x16x32_bf16 v[44:47], v[88:91], v[80:83], v[44:47]
  ds_read_b64_tr_b16 v[88:89], v108 offset:160
  ds_read_b64_tr_b16 v[90:91], v108 offset:1312
  s_add_u32 m0, s45, 35840
  s_add_u32 s46, s33, 294912
  buffer_load_dwordx4 v111, s[8:11], s46 offen lds
  s_waitcnt lgkmcnt(6)
  v_mfma_f32_16x16x32_bf16 v[12:15], v[92:95], v[76:79], v[12:15]
  v_mfma_f32_16x16x32_bf16 v[48:51], v[92:95], v[80:83], v[48:51]
  ds_read_b64_tr_b16 v[92:93], v108 offset:192
  ds_read_b64_tr_b16 v[94:95], v108 offset:1344
  s_add_u32 m0, s45, 44032
  s_add_u32 s46, s33, 294912
  buffer_load_dwordx4 v112, s[8:11], s46 offen lds
  s_waitcnt lgkmcnt(6)
  v_mfma_f32_16x16x32_bf16 v[16:19], v[96:99], v[76:79], v[16:19]
  v_mfma_f32_16x16x32_bf16 v[52:55], v[96:99], v[80:83], v[52:55]
  ds_read_b64_tr_b16 v[96:97], v108 offset:224
  ds_read_b64_tr_b16 v[98:99], v108 offset:1376
  s_cmp_ge_u32 s40, 3
  s_cbranch_scc1 gemm2_kernel_wsk7
  s_add_u32 m0, s45, 52224
  s_add_u32 s46, s33, 294912
  buffer_load_dwordx4 v113, s[8:11], s46 offen lds
  gemm2_kernel_wsk7:
  s_waitcnt lgkmcnt(6)
  v_mfma_f32_16x16x32_bf16 v[20:23], v[84:87], v[76:79], v[20:23]
  v_mfma_f32_16x16x32_bf16 v[56:59], v[84:87], v[80:83], v[56:59]
  ds_read_b64_tr_b16 v[84:85], v108 offset:256
  ds_read_b64_tr_b16 v[86:87], v108 offset:1408
  s_waitcnt lgkmcnt(6)
  v_mfma_f32_16x16x32_bf16 v[24:27], v[88:91], v[76:79], v[24:27]
  v_mfma_f32_16x16x32_bf16 v[60:63], v[88:91], v[80:83], v[60:63]
  s_waitcnt lgkmcnt(4)
  v_mfma_f32_16x16x32_bf16 v[28:31], v[92:95], v[76:79], v[28:31]
  v_mfma_f32_16x16x32_bf16 v[64:67], v[92:95], v[80:83], v[64:67]
  s_waitcnt lgkmcnt(2)
  v_mfma_f32_16x16x32_bf16 v[32:35], v[96:99], v[76:79], v[32:35]
  v_mfma_f32_16x16x32_bf16 v[68:71], v[96:99], v[80:83], v[68:71]
  s_waitcnt lgkmcnt(0)
  v_mfma_f32_16x16x32_bf16 v[36:39], v[84:87], v[76:79], v[36:39]
  v_mfma_f32_16x16x32_bf16 v[72:75], v[84:87], v[80:83], v[72:75]
  s_waitcnt vmcnt(4)
  s_barrier
  ds_read_b64_tr_b16 v[84:85], v106 offset:0
  ds_read_b64_tr_b16 v[86:87], v106 offset:1152
  ds_read_b128 v[76:79], v100 offset:0
  ds_read_b128 v[80:83], v100 offset:2048
  ds_read_b64_tr_b16 v[88:89], v106 offset:32
  ds_read_b64_tr_b16 v[90:91], v106 offset:1184
  ds_read_b64_tr_b16 v[92:93], v106 offset:64
  ds_read_b64_tr_b16 v[94:95], v106 offset:1216
  ds_read_b64_tr_b16 v[96:97], v106 offset:96
  ds_read_b64_tr_b16 v[98:99], v106 offset:1248
  s_add_u32 m0, s44, 71680
  s_add_u32 s46, s43, 10240
  buffer_load_dwordx4 v109, s[4:7], s46 offen lds
  s_waitcnt lgkmcnt(6)
  v_mfma_f32_16x16x32_bf16 v[4:7], v[84:87], v[76:79], v[4:7]
  v_mfma_f32_16x16x32_bf16 v[40:43], v[84:87], v[80:83], v[40:43]
  ds_read_b64_tr_b16 v[84:85], v106 offset:128
  ds_read_b64_tr_b16 v[86:87], v106 offset:1280
  s_add_u32 m0, s44, 72704
  s_add_u32 s46, s43, 10240
  buffer_load_dwordx4 v110, s[4:7], s46 offen lds
  s_waitcnt lgkmcnt(6)
  v_mfma_f32_16x16x32_bf16 v[8:11], v[88:91], v[76:79], v[8:11]
  v_mfma_f32_16x16x32_bf16 v[44:47], v[88:91], v[80:83], v[44:47]
  ds_read_b64_tr_b16 v[88:89], v106 offset:160
  ds_read_b64_tr_b16 v[90:91], v106 offset:1312
  s_add_u32 m0, s45, 71680
  s_add_u32 s46, s33, 368640
  buffer_load_dwordx4 v111, s[8:11], s46 offen lds
  s_waitcnt lgkmcnt(6)
  v_mfma_f32_16x16x32_bf16 v[12:15], v[92:95], v[76:79], v[12:15]
  v_mfma_f32_16x16x32_bf16 v[48:51], v[92:95], v[80:83], v[48:51]
  ds_read_b64_tr_b16 v[92:93], v106 offset:192
  ds_read_b64_tr_b16 v[94:95], v106 offset:1344
  s_add_u32 m0, s45, 79872
  s_add_u32 s46, s33, 368640
  buffer_load_dwordx4 v112, s[8:11], s46 offen lds
  s_waitcnt lgkmcnt(6)
  v_mfma_f32_16x16x32_bf16 v[16:19], v[96:99], v[76:79], v[16:19]
  v_mfma_f32_16x16x32_bf16 v[52:55], v[96:99], v[80:83], v[52:55]
  ds_read_b64_tr_b16 v[96:97], v106 offset:224
  ds_read_b64_tr_b16 v[98:99], v106 offset:1376
  s_cmp_ge_u32 s40, 3
  s_cbranch_scc1 gemm2_kernel_wsk8
  s_add_u32 m0, s45, 88064
  s_add_u32 s46, s33, 368640
  buffer_load_dwordx4 v113, s[8:11], s46 offen lds
  gemm2_kernel_wsk8:
  s_waitcnt lgkmcnt(6)
  v_mfma_f32_16x16x32_bf16 v[20:23], v[84:87], v[76:79], v[20:23]
  v_mfma_f32_16x16x32_bf16 v[56:59], v[84:87], v[80:83], v[56:59]
  ds_read_b64_tr_b16 v[84:85], v106 offset:256
  ds_read_b64_tr_b16 v[86:87], v106 offset:1408
  s_waitcnt lgkmcnt(6)
  v_mfma_f32_16x16x32_bf16 v[24:27], v[88:91], v[76:79], v[24:27]
  v_mfma_f32_16x16x32_bf16 v[60:63], v[88:91], v[80:83], v[60:63]
  s_waitcnt lgkmcnt(4)
  v_mfma_f32_16x16x32_bf16 v[28:31], v[92:95], v[76:79], v[28:31]
  v_mfma_f32_16x16x32_bf16 v[64:67], v[92:95], v[80:83], v[64:67]
  s_waitcnt lgkmcnt(2)
  v_mfma_f32_16x16x32_bf16 v[32:35], v[96:99], v[76:79], v[32:35]
  v_mfma_f32_16x16x32_bf16 v[68:71], v[96:99], v[80:83], v[68:71]
  s_waitcnt lgkmcnt(0)
  v_mfma_f32_16x16x32_bf16 v[36:39], v[84:87], v[76:79], v[36:39]
  v_mfma_f32_16x16x32_bf16 v[72:75], v[84:87], v[80:83], v[72:75]
  s_waitcnt vmcnt(4)
  s_barrier
  ds_read_b64_tr_b16 v[84:85], v107 offset:0
  ds_read_b64_tr_b16 v[86:87], v107 offset:1152
  ds_read_b128 v[76:79], v102 offset:0
  ds_read_b128 v[80:83], v102 offset:2048
  ds_read_b64_tr_b16 v[88:89], v107 offset:32
  ds_read_b64_tr_b16 v[90:91], v107 offset:1184
  ds_read_b64_tr_b16 v[92:93], v107 offset:64
  ds_read_b64_tr_b16 v[94:95], v107 offset:1216
  ds_read_b64_tr_b16 v[96:97], v107 offset:96
  ds_read_b64_tr_b16 v[98:99], v107 offset:1248
  s_add_u32 m0, s44, 0
  s_add_u32 s46, s43, 12288
  buffer_load_dwordx4 v109, s[4:7], s46 offen lds
  s_waitcnt lgkmcnt(6)
  v_mfma_f32_16x16x32_bf16 v[4:7], v[84:87], v[76:79], v[4:7]
  v_mfma_f32_16x16x32_bf16 v[40:43], v[84:87], v[80:83], v[40:43]
  ds_read_b64_tr_b16 v[84:85], v107 offset:128
  ds_read_b64_tr_b16 v[86:87], v107 offset:1280
  s_add_u32 m0, s44, 1024
  s_add_u32 s46, s43, 12288
  buffer_load_dwordx4 v110, s[4:7], s46 offen lds
  s_waitcnt lgkmcnt(6)
  v_mfma_f32_16x16x32_bf16 v[8:11], v[88:91], v[76:79], v[8:11]
  v_mfma_f32_16x16x32_bf16 v[44:47], v[88:91], v[80:83], v[44:47]
  ds_read_b64_tr_b16 v[88:89], v107 offset:160
  ds_read_b64_tr_b16 v[90:91], v107 offset:1312
  s_add_u32 m0, s45, 0
  s_add_u32 s46, s33, 442368
  buffer_load_dwordx4 v111, s[8:11], s46 offen lds
  s_waitcnt lgkmcnt(6)
  v_mfma_f32_16x16x32_bf16 v[12:15], v[92:95], v[76:79], v[12:15]
  v_mfma_f32_16x16x32_bf16 v[48:51], v[92:95], v[80:83], v[48:51]
  ds_read_b64_tr_b16 v[92:93], v107 offset:192
  ds_read_b64_tr_b16 v[94:95], v107 offset:1344
  s_add_u32 m0, s45, 8192
  s_add_u32 s46, s33, 442368
  buffer_load_dwordx4 v112, s[8:11], s46 offen lds
  s_waitcnt lgkmcnt(6)
  v_mfma_f32_16x16x32_bf16 v[16:19], v[96:99], v[76:79], v[16:19]
  v_mfma_f32_16x16x32_bf16 v[52:55], v[96:99], v[80:83], v[52:55]
  ds_read_b64_tr_b16 v[96:97], v107 offset:224
  ds_read_b64_tr_b16 v[98:99], v107 offset:1376
  s_cmp_ge_u32 s40, 3
  s_cbranch_scc1 gemm2_kernel_wsk9
  s_add_u32 m0, s45, 16384
  s_add_u32 s46, s33, 442368
  buffer_load_dwordx4 v113, s[8:11], s46 offen lds
  gemm2_kernel_wsk9:
  s_waitcnt lgkmcnt(6)
  v_mfma_f32_16x16x32_bf16 v[20:23], v[84:87], v[76:79], v[20:23]
  v_mfma_f32_16x16x32_bf16 v[56:59], v[84:87], v[80:83], v[56:59]
  ds_read_b64_tr_b16 v[84:85], v107 offset:256
  ds_read_b64_tr_b16 v[86:87], v107 offset:1408
  s_waitcnt lgkmcnt(6)
  v_mfma_f32_16x16x32_bf16 v[24:27], v[88:91], v[76:79], v[24:27]
  v_mfma_f32_16x16x32_bf16 v[60:63], v[88:91], v[80:83], v[60:63]
  s_waitcnt lgkmcnt(4)
  v_mfma_f32_16x16x32_bf16 v[28:31], v[92:95], v[76:79], v[28:31]
  v_mfma_f32_16x16x32_bf16 v[64:67], v[92:95], v[80:83], v[64:67]
  s_waitcnt lgkmcnt(2)
  v_mfma_f32_16x16x32_bf16 v[32:35], v[96:99], v[76:79], v[32:35]
  v_mfma_f32_16x16x32_bf16 v[68:71], v[96:99], v[80:83], v[68:71]
  s_waitcnt lgkmcnt(0)
  v_mfma_f32_16x16x32_bf16 v[36:39], v[84:87], v[76:79], v[36:39]
  v_mfma_f32_16x16x32_bf16 v[72:75], v[84:87], v[80:83], v[72:75]
  s_waitcnt vmcnt(4)
  s_barrier
  ds_read_b64_tr_b16 v[84:85], v108 offset:0
  ds_read_b64_tr_b16 v[86:87], v108 offset:1152
  ds_read_b128 v[76:79], v104 offset:0
  ds_read_b128 v[80:83], v104 offset:2048
  ds_read_b64_tr_b16 v[88:89], v108 offset:32
  ds_read_b64_tr_b16 v[90:91], v108 offset:1184
  ds_read_b64_tr_b16 v[92:93], v108 offset:64
  ds_read_b64_tr_b16 v[94:95], v108 offset:1216
  ds_read_b64_tr_b16 v[96:97], v108 offset:96
  ds_read_b64_tr_b16 v[98:99], v108 offset:1248
  s_add_u32 m0, s44, 35840
  s_add_u32 s46, s43, 14336
  buffer_load_dwordx4 v109, s[4:7], s46 offen lds
  s_waitcnt lgkmcnt(6)
  v_mfma_f32_16x16x32_bf16 v[4:7], v[84:87], v[76:79], v[4:7]
  v_mfma_f32_16x16x32_bf16 v[40:43], v[84:87], v[80:83], v[40:43]
  ds_read_b64_tr_b16 v[84:85], v108 offset:128
  ds_read_b64_tr_b16 v[86:87], v108 offset:1280
  s_add_u32 m0, s44, 36864
  s_add_u32 s46, s43, 14336
  buffer_load_dwordx4 v110, s[4:7], s46 offen lds
  s_waitcnt lgkmcnt(6)
  v_mfma_f32_16x16x32_bf16 v[8:11], v[88:91], v[76:79], v[8:11]
  v_mfma_f32_16x16x32_bf16 v[44:47], v[88:91], v[80:83], v[44:47]
  ds_read_b64_tr_b16 v[88:89], v108 offset:160
  ds_read_b64_tr_b16 v[90:91], v108 offset:1312
  s_add_u32 m0, s45, 35840
  s_add_u32 s46, s33, 516096
  buffer_load_dwordx4 v111, s[8:11], s46 offen lds
  s_waitcnt lgkmcnt(6)
  v_mfma_f32_16x16x32_bf16 v[12:15], v[92:95], v[76:79], v[12:15]
  v_mfma_f32_16x16x32_bf16 v[48:51], v[92:95], v[80:83], v[48:51]
  ds_read_b64_tr_b16 v[92:93], v108 offset:192
  ds_read_b64_tr_b16 v[94:95], v108 offset:1344
  s_add_u32 m0, s45, 44032
  s_add_u32 s46, s33, 516096
  buffer_load_dwordx4 v112, s[8:11], s46 offen lds
  s_waitcnt lgkmcnt(6)
  v_mfma_f32_16x16x32_bf16 v[16:19], v[96:99], v[76:79], v[16:19]
  v_mfma_f32_16x16x32_bf16 v[52:55], v[96:99], v[80:83], v[52:55]
  ds_read_b64_tr_b16 v[96:97], v108 offset:224
  ds_read_b64_tr_b16 v[98:99], v108 offset:1376
  s_cmp_ge_u32 s40, 3
  s_cbranch_scc1 gemm2_kernel_wsk10
  s_add_u32 m0, s45, 52224
  s_add_u32 s46, s33, 516096
  buffer_load_dwordx4 v113, s[8:11], s46 offen lds
  gemm2_kernel_wsk10:
  s_waitcnt lgkmcnt(6)
  v_mfma_f32_16x16x32_bf16 v[20:23], v[84:87], v[76:79], v[20:23]
  v_mfma_f32_16x16x32_bf16 v[56:59], v[84:87], v[80:83], v[56:59]
  ds_read_b64_tr_b16 v[84:85], v108 offset:256
  ds_read_b64_tr_b16 v[86:87], v108 offset:1408
  s_waitcnt lgkmcnt(6)
  v_mfma_f32_16x16x32_bf16 v[24:27], v[88:91], v[76:79], v[24:27]
  v_mfma_f32_16x16x32_bf16 v[60:63], v[88:91], v[80:83], v[60:63]
  s_waitcnt lgkmcnt(4)
  v_mfma_f32_16x16x32_bf16 v[28:31], v[92:95], v[76:79], v[28:31]
  v_mfma_f32_16x16x32_bf16 v[64:67], v[92:95], v[80:83], v[64:67]
  s_waitcnt lgkmcnt(2)
  v_mfma_f32_16x16x32_bf16 v[32:35], v[96:99], v[76:79], v[32:35]
  v_mfma_f32_16x16x32_bf16 v[68:71], v[96:99], v[80:83], v[68:71]
  s_waitcnt lgkmcnt(0)
  v_mfma_f32_16x16x32_bf16 v[36:39], v[84:87], v[76:79], v[36:39]
  v_mfma_f32_16x16x32_bf16 v[72:75], v[84:87], v[80:83], v[72:75]
  s_waitcnt vmcnt(4)
  s_barrier
  ds_read_b64_tr_b16 v[84:85], v106 offset:0
  ds_read_b64_tr_b16 v[86:87], v106 offset:1152
  ds_read_b128 v[76:79], v100 offset:0
  ds_read_b128 v[80:83], v100 offset:2048
  ds_read_b64_tr_b16 v[88:89], v106 offset:32
  ds_read_b64_tr_b16 v[90:91], v106 offset:1184
  ds_read_b64_tr_b16 v[92:93], v106 offset:64
  ds_read_b64_tr_b16 v[94:95], v106 offset:1216
  ds_read_b64_tr_b16 v[96:97], v106 offset:96
  ds_read_b64_tr_b16 v[98:99], v106 offset:1248
  s_add_u32 m0, s44, 71680
  s_add_u32 s46, s43, 16384
  buffer_load_dwordx4 v109, s[4:7], s46 offen lds
  s_waitcnt lgkmcnt(6)
  v_mfma_f32_16x16x32_bf16 v[4:7], v[84:87], v[76:79], v[4:7]
  v_mfma_f32_16x16x32_bf16 v[40:43], v[84:87], v[80:83], v[40:43]
  ds_read_b64_tr_b16 v[84:85], v106 offset:128
  ds_read_b64_tr_b16 v[86:87], v106 offset:1280
  s_add_u32 m0, s44, 72704
  s_add_u32 s46, s43, 16384
  buffer_load_dwordx4 v110, s[4:7], s46 offen lds
  s_waitcnt lgkmcnt(6)
  v_mfma_f32_16x16x32_bf16 v[8:11], v[88:91], v[76:79], v[8:11]
  v_mfma_f32_16x16x32_bf16 v[44:47], v[88:91], v[80:83], v[44:47]
  ds_read_b64_tr_b16 v[88:89], v106 offset:160
  ds_read_b64_tr_b16 v[90:91], v106 offset:1312
  s_add_u32 m0, s45, 71680
  s_add_u32 s46, s33, 589824
  buffer_load_dwordx4 v111, s[8:11], s46 offen lds
  s_waitcnt lgkmcnt(6)
  v_mfma_f32_16x16x32_bf16 v[12:15], v[92:95], v[76:79], v[12:15]
  v_mfma_f32_16x16x32_bf16 v[48:51], v[92:95], v[80:83], v[48:51]
  ds_read_b64_tr_b16 v[92:93], v106 offset:192
  ds_read_b64_tr_b16 v[94:95], v106 offset:1344
  s_add_u32 m0, s45, 79872
  s_add_u32 s46, s33, 589824
  buffer_load_dwordx4 v112, s[8:11], s46 offen lds
  s_waitcnt lgkmcnt(6)
  v_mfma_f32_16x16x32_bf16 v[16:19], v[96:99], v[76:79], v[16:19]
  v_mfma_f32_16x16x32_bf16 v[52:55], v[96:99], v[80:83], v[52:55]
  ds_read_b64_tr_b16 v[96:97], v106 offset:224
  ds_read_b64_tr_b16 v[98:99], v106 offset:1376
  s_cmp_ge_u32 s40, 3
  s_cbranch_scc1 gemm2_kernel_wsk11
  s_add_u32 m0, s45, 88064
  s_add_u32 s46, s33, 589824
  buffer_load_dwordx4 v113, s[8:11], s46 offen lds
  gemm2_kernel_wsk11:
  s_waitcnt lgkmcnt(6)
  v_mfma_f32_16x16x32_bf16 v[20:23], v[84:87], v[76:79], v[20:23]
  v_mfma_f32_16x16x32_bf16 v[56:59], v[84:87], v[80:83], v[56:59]
  ds_read_b64_tr_b16 v[84:85], v106 offset:256
  ds_read_b64_tr_b16 v[86:87], v106 offset:1408
  s_waitcnt lgkmcnt(6)
  v_mfma_f32_16x16x32_bf16 v[24:27], v[88:91], v[76:79], v[24:27]
  v_mfma_f32_16x16x32_bf16 v[60:63], v[88:91], v[80:83], v[60:63]
  s_waitcnt lgkmcnt(4)
  v_mfma_f32_16x16x32_bf16 v[28:31], v[92:95], v[76:79], v[28:31]
  v_mfma_f32_16x16x32_bf16 v[64:67], v[92:95], v[80:83], v[64:67]
  s_waitcnt lgkmcnt(2)
  v_mfma_f32_16x16x32_bf16 v[32:35], v[96:99], v[76:79], v[32:35]
  v_mfma_f32_16x16x32_bf16 v[68:71], v[96:99], v[80:83], v[68:71]
  s_waitcnt lgkmcnt(0)
  v_mfma_f32_16x16x32_bf16 v[36:39], v[84:87], v[76:79], v[36:39]
  v_mfma_f32_16x16x32_bf16 v[72:75], v[84:87], v[80:83], v[72:75]
  s_waitcnt vmcnt(4)
  s_barrier
  ds_read_b64_tr_b16 v[84:85], v107 offset:0
  ds_read_b64_tr_b16 v[86:87], v107 offset:1152
  ds_read_b128 v[76:79], v102 offset:0
  ds_read_b128 v[80:83], v102 offset:2048
  ds_read_b64_tr_b16 v[88:89], v107 offset:32
  ds_read_b64_tr_b16 v[90:91], v107 offset:1184
  ds_read_b64_tr_b16 v[92:93], v107 offset:64
  ds_read_b64_tr_b16 v[94:95], v107 offset:1216
  ds_read_b64_tr_b16 v[96:97], v107 offset:96
  ds_read_b64_tr_b16 v[98:99], v107 offset:1248
  s_add_u32 m0, s44, 0
  s_add_u32 s46, s43, 18432
  buffer_load_dwordx4 v109, s[4:7], s46 offen lds
  s_waitcnt lgkmcnt(6)
  v_mfma_f32_16x16x32_bf16 v[4:7], v[84:87], v[76:79], v[4:7]
  v_mfma_f32_16x16x32_bf16 v[40:43], v[84:87], v[80:83], v[40:43]
  ds_read_b64_tr_b16 v[84:85], v107 offset:128
  ds_read_b64_tr_b16 v[86:87], v107 offset:1280
  s_add_u32 m0, s44, 1024
  s_add_u32 s46, s43, 18432
  buffer_load_dwordx4 v110, s[4:7], s46 offen lds
  s_waitcnt lgkmcnt(6)
  v_mfma_f32_16x16x32_bf16 v[8:11], v[88:91], v[76:79], v[8:11]
  v_mfma_f32_16x16x32_bf16 v[44:47], v[88:91], v[80:83], v[44:47]
  ds_read_b64_tr_b16 v[88:89], v107 offset:160
  ds_read_b64_tr_b16 v[90:91], v107 offset:1312
  s_add_u32 m0, s45, 0
  s_add_u32 s46, s33, 663552
  buffer_load_dwordx4 v111, s[8:11], s46 offen lds
  s_waitcnt lgkmcnt(6)
  v_mfma_f32_16x16x32_bf16 v[12:15], v[92:95], v[76:79], v[12:15]
  v_mfma_f32_16x16x32_bf16 v[48:51], v[92:95], v[80:83], v[48:51]
  ds_read_b64_tr_b16 v[92:93], v107 offset:192
  ds_read_b64_tr_b16 v[94:95], v107 offset:1344
  s_add_u32 m0, s45, 8192
  s_add_u32 s46, s33, 663552
  buffer_load_dwordx4 v112, s[8:11], s46 offen lds
  s_waitcnt lgkmcnt(6)
  v_mfma_f32_16x16x32_bf16 v[16:19], v[96:99], v[76:79], v[16:19]
  v_mfma_f32_16x16x32_bf16 v[52:55], v[96:99], v[80:83], v[52:55]
  ds_read_b64_tr_b16 v[96:97], v107 offset:224
  ds_read_b64_tr_b16 v[98:99], v107 offset:1376
  s_cmp_ge_u32 s40, 3
  s_cbranch_scc1 gemm2_kernel_wsk12
  s_add_u32 m0, s45, 16384
  s_add_u32 s46, s33, 663552
  buffer_load_dwordx4 v113, s[8:11], s46 offen lds
  gemm2_kernel_wsk12:
  s_waitcnt lgkmcnt(6)
  v_mfma_f32_16x16x32_bf16 v[20:23], v[84:87], v[76:79], v[20:23]
  v_mfma_f32_16x16x32_bf16 v[56:59], v[84:87], v[80:83], v[56:59]
  ds_read_b64_tr_b16 v[84:85], v107 offset:256
  ds_read_b64_tr_b16 v[86:87], v107 offset:1408
  s_waitcnt lgkmcnt(6)
  v_mfma_f32_16x16x32_bf16 v[24:27], v[88:91], v[76:79], v[24:27]
  v_mfma_f32_16x16x32_bf16 v[60:63], v[88:91], v[80:83], v[60:63]
  s_waitcnt lgkmcnt(4)
  v_mfma_f32_16x16x32_bf16 v[28:31], v[92:95], v[76:79], v[28:31]
  v_mfma_f32_16x16x32_bf16 v[64:67], v[92:95], v[80:83], v[64:67]
  s_waitcnt lgkmcnt(2)
  v_mfma_f32_16x16x32_bf16 v[32:35], v[96:99], v[76:79], v[32:35]
  v_mfma_f32_16x16x32_bf16 v[68:71], v[96:99], v[80:83], v[68:71]
  s_waitcnt lgkmcnt(0)
  v_mfma_f32_16x16x32_bf16 v[36:39], v[84:87], v[76:79], v[36:39]
  v_mfma_f32_16x16x32_bf16 v[72:75], v[84:87], v[80:83], v[72:75]
  s_waitcnt vmcnt(4)
  s_barrier
  ds_read_b64_tr_b16 v[84:85], v108 offset:0
  ds_read_b64_tr_b16 v[86:87], v108 offset:1152
  ds_read_b128 v[76:79], v104 offset:0
  ds_read_b128 v[80:83], v104 offset:2048
  ds_read_b64_tr_b16 v[88:89], v108 offset:32
  ds_read_b64_tr_b16 v[90:91], v108 offset:1184
  ds_read_b64_tr_b16 v[92:93], v108 offset:64
  ds_read_b64_tr_b16 v[94:95], v108 offset:1216
  ds_read_b64_tr_b16 v[96:97], v108 offset:96
  ds_read_b64_tr_b16 v[98:99], v108 offset:1248
  s_add_u32 m0, s44, 35840
  s_add_u32 s46, s43, 20480
  buffer_load_dwordx4 v109, s[4:7], s46 offen lds
  s_waitcnt lgkmcnt(6)
  v_mfma_f32_16x16x32_bf16 v[4:7], v[84:87], v[76:79], v[4:7]
  v_mfma_f32_16x16x32_bf16 v[40:43], v[84:87], v[80:83], v[40:43]
  ds_read_b64_tr_b16 v[84:85], v108 offset:128
  ds_read_b64_tr_b16 v[86:87], v108 offset:1280
  s_add_u32 m0, s44, 36864
  s_add_u32 s46, s43, 20480
  buffer_load_dwordx4 v110, s[4:7], s46 offen lds
  s_waitcnt lgkmcnt(6)
  v_mfma_f32_16x16x32_bf16 v[8:11], v[88:91], v[76:79], v[8:11]
  v_mfma_f32_16x16x32_bf16 v[44:47], v[88:91], v[80:83], v[44:47]
  ds_read_b64_tr_b16 v[88:89], v108 offset:160
  ds_read_b64_tr_b16 v[90:91], v108 offset:1312
  s_add_u32 m0, s45, 35840
  s_add_u32 s46, s33, 737280
  buffer_load_dwordx4 v111, s[8:11], s46 offen lds
  s_waitcnt lgkmcnt(6)
  v_mfma_f32_16x16x32_bf16 v[12:15], v[92:95], v[76:79], v[12:15]
  v_mfma_f32_16x16x32_bf16 v[48:51], v[92:95], v[80:83], v[48:51]
  ds_read_b64_tr_b16 v[92:93], v108 offset:192
  ds_read_b64_tr_b16 v[94:95], v108 offset:1344
  s_add_u32 m0, s45, 44032
  s_add_u32 s46, s33, 737280
  buffer_load_dwordx4 v112, s[8:11], s46 offen lds
  s_waitcnt lgkmcnt(6)
  v_mfma_f32_16x16x32_bf16 v[16:19], v[96:99], v[76:79], v[16:19]
  v_mfma_f32_16x16x32_bf16 v[52:55], v[96:99], v[80:83], v[52:55]
  ds_read_b64_tr_b16 v[96:97], v108 offset:224
  ds_read_b64_tr_b16 v[98:99], v108 offset:1376
  s_cmp_ge_u32 s40, 3
  s_cbranch_scc1 gemm2_kernel_wsk13
  s_add_u32 m0, s45, 52224
  s_add_u32 s46, s33, 737280
  buffer_load_dwordx4 v113, s[8:11], s46 offen lds
  gemm2_kernel_wsk13:
  s_waitcnt lgkmcnt(6)
  v_mfma_f32_16x16x32_bf16 v[20:23], v[84:87], v[76:79], v[20:23]
  v_mfma_f32_16x16x32_bf16 v[56:59], v[84:87], v[80:83], v[56:59]
  ds_read_b64_tr_b16 v[84:85], v108 offset:256
  ds_read_b64_tr_b16 v[86:87], v108 offset:1408
  s_waitcnt lgkmcnt(6)
  v_mfma_f32_16x16x32_bf16 v[24:27], v[88:91], v[76:79], v[24:27]
  v_mfma_f32_16x16x32_bf16 v[60:63], v[88:91], v[80:83], v[60:63]
  s_waitcnt lgkmcnt(4)
  v_mfma_f32_16x16x32_bf16 v[28:31], v[92:95], v[76:79], v[28:31]
  v_mfma_f32_16x16x32_bf16 v[64:67], v[92:95], v[80:83], v[64:67]
  s_waitcnt lgkmcnt(2)
  v_mfma_f32_16x16x32_bf16 v[32:35], v[96:99], v[76:79], v[32:35]
  v_mfma_f32_16x16x32_bf16 v[68:71], v[96:99], v[80:83], v[68:71]
  s_waitcnt lgkmcnt(0)
  v_mfma_f32_16x16x32_bf16 v[36:39], v[84:87], v[76:79], v[36:39]
  v_mfma_f32_16x16x32_bf16 v[72:75], v[84:87], v[80:83], v[72:75]
  s_waitcnt vmcnt(4)
  s_barrier
  ds_read_b64_tr_b16 v[84:85], v106 offset:0
  ds_read_b64_tr_b16 v[86:87], v106 offset:1152
  ds_read_b128 v[76:79], v100 offset:0
  ds_read_b128 v[80:83], v100 offset:2048
  ds_read_b64_tr_b16 v[88:89], v106 offset:32
  ds_read_b64_tr_b16 v[90:91], v106 offset:1184
  ds_read_b64_tr_b16 v[92:93], v106 offset:64
  ds_read_b64_tr_b16 v[94:95], v106 offset:1216
  ds_read_b64_tr_b16 v[96:97], v106 offset:96
  ds_read_b64_tr_b16 v[98:99], v106 offset:1248
  s_add_u32 m0, s44, 71680
  s_add_u32 s46, s43, 22528
  buffer_load_dwordx4 v109, s[4:7], s46 offen lds
  s_waitcnt lgkmcnt(6)
  v_mfma_f32_16x16x32_bf16 v[4:7], v[84:87], v[76:79], v[4:7]
  v_mfma_f32_16x16x32_bf16 v[40:43], v[84:87], v[80:83], v[40:43]
  ds_read_b64_tr_b16 v[84:85], v106 offset:128
  ds_read_b64_tr_b16 v[86:87], v106 offset:1280
  s_add_u32 m0, s44, 72704
  s_add_u32 s46, s43, 22528
  buffer_load_dwordx4 v110, s[4:7], s46 offen lds
  s_waitcnt lgkmcnt(6)
  v_mfma_f32_16x16x32_bf16 v[8:11], v[88:91], v[76:79], v[8:11]
  v_mfma_f32_16x16x32_bf16 v[44:47], v[88:91], v[80:83], v[44:47]
  ds_read_b64_tr_b16 v[88:89], v106 offset:160
  ds_read_b64_tr_b16 v[90:91], v106 offset:1312
  s_add_u32 m0, s45, 71680
  s_add_u32 s46, s33, 811008
  buffer_load_dwordx4 v111, s[8:11], s46 offen lds
  s_waitcnt lgkmcnt(6)
  v_mfma_f32_16x16x32_bf16 v[12:15], v[92:95], v[76:79], v[12:15]
  v_mfma_f32_16x16x32_bf16 v[48:51], v[92:95], v[80:83], v[48:51]
  ds_read_b64_tr_b16 v[92:93], v106 offset:192
  ds_read_b64_tr_b16 v[94:95], v106 offset:1344
  s_add_u32 m0, s45, 79872
  s_add_u32 s46, s33, 811008
  buffer_load_dwordx4 v112, s[8:11], s46 offen lds
  s_waitcnt lgkmcnt(6)
  v_mfma_f32_16x16x32_bf16 v[16:19], v[96:99], v[76:79], v[16:19]
  v_mfma_f32_16x16x32_bf16 v[52:55], v[96:99], v[80:83], v[52:55]
  ds_read_b64_tr_b16 v[96:97], v106 offset:224
  ds_read_b64_tr_b16 v[98:99], v106 offset:1376
  s_cmp_ge_u32 s40, 3
  s_cbranch_scc1 gemm2_kernel_wsk14
  s_add_u32 m0, s45, 88064
  s_add_u32 s46, s33, 811008
  buffer_load_dwordx4 v113, s[8:11], s46 offen lds
  gemm2_kernel_wsk14:
  s_waitcnt lgkmcnt(6)
  v_mfma_f32_16x16x32_bf16 v[20:23], v[84:87], v[76:79], v[20:23]
  v_mfma_f32_16x16x32_bf16 v[56:59], v[84:87], v[80:83], v[56:59]
  ds_read_b64_tr_b16 v[84:85], v106 offset:256
  ds_read_b64_tr_b16 v[86:87], v106 offset:1408
  s_waitcnt lgkmcnt(6)
  v_mfma_f32_16x16x32_bf16 v[24:27], v[88:91], v[76:79], v[24:27]
  v_mfma_f32_16x16x32_bf16 v[60:63], v[88:91], v[80:83], v[60:63]
  s_waitcnt lgkmcnt(4)
  v_mfma_f32_16x16x32_bf16 v[28:31], v[92:95], v[76:79], v[28:31]
  v_mfma_f32_16x16x32_bf16 v[64:67], v[92:95], v[80:83], v[64:67]
  s_waitcnt lgkmcnt(2)
  v_mfma_f32_16x16x32_bf16 v[32:35], v[96:99], v[76:79], v[32:35]
  v_mfma_f32_16x16x32_bf16 v[68:71], v[96:99], v[80:83], v[68:71]
  s_waitcnt lgkmcnt(0)
  v_mfma_f32_16x16x32_bf16 v[36:39], v[84:87], v[76:79], v[36:39]
  v_mfma_f32_16x16x32_bf16 v[72:75], v[84:87], v[80:83], v[72:75]
  s_waitcnt vmcnt(4)
  s_barrier
  ds_read_b64_tr_b16 v[84:85], v107 offset:0
  ds_read_b64_tr_b16 v[86:87], v107 offset:1152
  ds_read_b128 v[76:79], v102 offset:0
  ds_read_b128 v[80:83], v102 offset:2048
  ds_read_b64_tr_b16 v[88:89], v107 offset:32
  ds_read_b64_tr_b16 v[90:91], v107 offset:1184
  ds_read_b64_tr_b16 v[92:93], v107 offset:64
  ds_read_b64_tr_b16 v[94:95], v107 offset:1216
  ds_read_b64_tr_b16 v[96:97], v107 offset:96
  ds_read_b64_tr_b16 v[98:99], v107 offset:1248
  s_add_u32 m0, s44, 0
  s_add_u32 s46, s43, 24576
  buffer_load_dwordx4 v109, s[4:7], s46 offen lds
  s_waitcnt lgkmcnt(6)
  v_mfma_f32_16x16x32_bf16 v[4:7], v[84:87], v[76:79], v[4:7]
  v_mfma_f32_16x16x32_bf16 v[40:43], v[84:87], v[80:83], v[40:43]
  ds_read_b64_tr_b16 v[84:85], v107 offset:128
  ds_read_b64_tr_b16 v[86:87], v107 offset:1280
  s_add_u32 m0, s44, 1024
  s_add_u32 s46, s43, 24576
  buffer_load_dwordx4 v110, s[4:7], s46 offen lds
  s_waitcnt lgkmcnt(6)
  v_mfma_f32_16x16x32_bf16 v[8:11], v[88:91], v[76:79], v[8:11]
  v_mfma_f32_16x16x32_bf16 v[44:47], v[88:91], v[80:83], v[44:47]
  ds_read_b64_tr_b16 v[88:89], v107 offset:160
  ds_read_b64_tr_b16 v[90:91], v107 offset:1312
  s_add_u32 m0, s45, 0
  s_add_u32 s46, s33, 884736
  buffer_load_dwordx4 v111, s[8:11], s46 offen lds
  s_waitcnt lgkmcnt(6)
  v_mfma_f32_16x16x32_bf16 v[12:15], v[92:95], v[76:79], v[12:15]
  v_mfma_f32_16x16x32_bf16 v[48:51], v[92:95], v[80:83], v[48:51]
  ds_read_b64_tr_b16 v[92:93], v107 offset:192
  ds_read_b64_tr_b16 v[94:95], v107 offset:1344
  s_add_u32 m0, s45, 8192
  s_add_u32 s46, s33, 884736
  buffer_load_dwordx4 v112, s[8:11], s46 offen lds
  s_waitcnt lgkmcnt(6)
  v_mfma_f32_16x16x32_bf16 v[16:19], v[96:99], v[76:79], v[16:19]
  v_mfma_f32_16x16x32_bf16 v[52:55], v[96:99], v[80:83], v[52:55]
  ds_read_b64_tr_b16 v[96:97], v107 offset:224
  ds_read_b64_tr_b16 v[98:99], v107 offset:1376
  s_cmp_ge_u32 s40, 3
  s_cbranch_scc1 gemm2_kernel_wsk15
  s_add_u32 m0, s45, 16384
  s_add_u32 s46, s33, 884736
  buffer_load_dwordx4 v113, s[8:11], s46 offen lds
  gemm2_kernel_wsk15:
  s_waitcnt lgkmcnt(6)
  v_mfma_f32_16x16x32_bf16 v[20:23], v[84:87], v[76:79], v[20:23]
  v_mfma_f32_16x16x32_bf16 v[56:59], v[84:87], v[80:83], v[56:59]
  ds_read_b64_tr_b16 v[84:85], v107 offset:256
  ds_read_b64_tr_b16 v[86:87], v107 offset:1408
  s_waitcnt lgkmcnt(6)
  v_mfma_f32_16x16x32_bf16 v[24:27], v[88:91], v[76:79], v[24:27]
  v_mfma_f32_16x16x32_bf16 v[60:63], v[88:91], v[80:83], v[60:63]
  s_waitcnt lgkmcnt(4)
  v_mfma_f32_16x16x32_bf16 v[28:31], v[92:95], v[76:79], v[28:31]
  v_mfma_f32_16x16x32_bf16 v[64:67], v[92:95], v[80:83], v[64:67]
  s_waitcnt lgkmcnt(2)
  v_mfma_f32_16x16x32_bf16 v[32:35], v[96:99], v[76:79], v[32:35]
  v_mfma_f32_16x16x32_bf16 v[68:71], v[96:99], v[80:83], v[68:71]
  s_waitcnt lgkmcnt(0)
  v_mfma_f32_16x16x32_bf16 v[36:39], v[84:87], v[76:79], v[36:39]
  v_mfma_f32_16x16x32_bf16 v[72:75], v[84:87], v[80:83], v[72:75]
  s_waitcnt vmcnt(4)
  s_barrier
  ds_read_b64_tr_b16 v[84:85], v108 offset:0
  ds_read_b64_tr_b16 v[86:87], v108 offset:1152
  ds_read_b128 v[76:79], v104 offset:0
  ds_read_b128 v[80:83], v104 offset:2048
  ds_read_b64_tr_b16 v[88:89], v108 offset:32
  ds_read_b64_tr_b16 v[90:91], v108 offset:1184
  ds_read_b64_tr_b16 v[92:93], v108 offset:64
  ds_read_b64_tr_b16 v[94:95], v108 offset:1216
  ds_read_b64_tr_b16 v[96:97], v108 offset:96
  ds_read_b64_tr_b16 v[98:99], v108 offset:1248
  s_add_u32 m0, s44, 35840
  s_add_u32 s46, s43, 26624
  buffer_load_dwordx4 v109, s[4:7], s46 offen lds
  s_waitcnt lgkmcnt(6)
  v_mfma_f32_16x16x32_bf16 v[4:7], v[84:87], v[76:79], v[4:7]
  v_mfma_f32_16x16x32_bf16 v[40:43], v[84:87], v[80:83], v[40:43]
  ds_read_b64_tr_b16 v[84:85], v108 offset:128
  ds_read_b64_tr_b16 v[86:87], v108 offset:1280
  s_add_u32 m0, s44, 36864
  s_add_u32 s46, s43, 26624
  buffer_load_dwordx4 v110, s[4:7], s46 offen lds
  s_waitcnt lgkmcnt(6)
  v_mfma_f32_16x16x32_bf16 v[8:11], v[88:91], v[76:79], v[8:11]
  v_mfma_f32_16x16x32_bf16 v[44:47], v[88:91], v[80:83], v[44:47]
  ds_read_b64_tr_b16 v[88:89], v108 offset:160
  ds_read_b64_tr_b16 v[90:91], v108 offset:1312
  s_add_u32 m0, s45, 35840
  s_add_u32 s46, s33, 958464
  buffer_load_dwordx4 v111, s[8:11], s46 offen lds
  s_waitcnt lgkmcnt(6)
  v_mfma_f32_16x16x32_bf16 v[12:15], v[92:95], v[76:79], v[12:15]
  v_mfma_f32_16x16x32_bf16 v[48:51], v[92:95], v[80:83], v[48:51]
  ds_read_b64_tr_b16 v[92:93], v108 offset:192
  ds_read_b64_tr_b16 v[94:95], v108 offset:1344
  s_add_u32 m0, s45, 44032
  s_add_u32 s46, s33, 958464
  buffer_load_dwordx4 v112, s[8:11], s46 offen lds
  s_waitcnt lgkmcnt(6)
  v_mfma_f32_16x16x32_bf16 v[16:19], v[96:99], v[76:79], v[16:19]
  v_mfma_f32_16x16x32_bf16 v[52:55], v[96:99], v[80:83], v[52:55]
  ds_read_b64_tr_b16 v[96:97], v108 offset:224
  ds_read_b64_tr_b16 v[98:99], v108 offset:1376
  s_cmp_ge_u32 s40, 3
  s_cbranch_scc1 gemm2_kernel_wsk16
  s_add_u32 m0, s45, 52224
  s_add_u32 s46, s33, 958464
  buffer_load_dwordx4 v113, s[8:11], s46 offen lds
  gemm2_kernel_wsk16:
  s_waitcnt lgkmcnt(6)
  v_mfma_f32_16x16x32_bf16 v[20:23], v[84:87], v[76:79], v[20:23]
  v_mfma_f32_16x16x32_bf16 v[56:59], v[84:87], v[80:83], v[56:59]
  ds_read_b64_tr_b16 v[84:85], v108 offset:256
  ds_read_b64_tr_b16 v[86:87], v108 offset:1408
  s_waitcnt lgkmcnt(6)
  v_mfma_f32_16x16x32_bf16 v[24:27], v[88:91], v[76:79], v[24:27]
  v_mfma_f32_16x16x32_bf16 v[60:63], v[88:91], v[80:83], v[60:63]
  s_waitcnt lgkmcnt(4)
  v_mfma_f32_16x16x32_bf16 v[28:31], v[92:95], v[76:79], v[28:31]
  v_mfma_f32_16x16x32_bf16 v[64:67], v[92:95], v[80:83], v[64:67]
  s_waitcnt lgkmcnt(2)
  v_mfma_f32_16x16x32_bf16 v[32:35], v[96:99], v[76:79], v[32:35]
  v_mfma_f32_16x16x32_bf16 v[68:71], v[96:99], v[80:83], v[68:71]
  s_waitcnt lgkmcnt(0)
  v_mfma_f32_16x16x32_bf16 v[36:39], v[84:87], v[76:79], v[36:39]
  v_mfma_f32_16x16x32_bf16 v[72:75], v[84:87], v[80:83], v[72:75]
  s_waitcnt vmcnt(4)
  s_barrier
  ds_read_b64_tr_b16 v[84:85], v106 offset:0
  ds_read_b64_tr_b16 v[86:87], v106 offset:1152
  ds_read_b128 v[76:79], v100 offset:0
  ds_read_b128 v[80:83], v100 offset:2048
  ds_read_b64_tr_b16 v[88:89], v106 offset:32
  ds_read_b64_tr_b16 v[90:91], v106 offset:1184
  ds_read_b64_tr_b16 v[92:93], v106 offset:64
  ds_read_b64_tr_b16 v[94:95], v106 offset:1216
  ds_read_b64_tr_b16 v[96:97], v106 offset:96
  ds_read_b64_tr_b16 v[98:99], v106 offset:1248
  s_add_u32 m0, s44, 71680
  s_add_u32 s46, s43, 28672
  buffer_load_dwordx4 v109, s[4:7], s46 offen lds
  s_waitcnt lgkmcnt(6)
  v_mfma_f32_16x16x32_bf16 v[4:7], v[84:87], v[76:79], v[4:7]
  v_mfma_f32_16x16x32_bf16 v[40:43], v[84:87], v[80:83], v[40:43]
  ds_read_b64_tr_b16 v[84:85], v106 offset:128
  ds_read_b64_tr_b16 v[86:87], v106 offset:1280
  s_add_u32 m0, s44, 72704
  s_add_u32 s46, s43, 28672
  buffer_load_dwordx4 v110, s[4:7], s46 offen lds
  s_waitcnt lgkmcnt(6)
  v_mfma_f32_16x16x32_bf16 v[8:11], v[88:91], v[76:79], v[8:11]
  v_mfma_f32_16x16x32_bf16 v[44:47], v[88:91], v[80:83], v[44:47]
  ds_read_b64_tr_b16 v[88:89], v106 offset:160
  ds_read_b64_tr_b16 v[90:91], v106 offset:1312
  s_add_u32 m0, s45, 71680
  s_add_u32 s46, s33, 1032192
  buffer_load_dwordx4 v111, s[8:11], s46 offen lds
  s_waitcnt lgkmcnt(6)
  v_mfma_f32_16x16x32_bf16 v[12:15], v[92:95], v[76:79], v[12:15]
  v_mfma_f32_16x16x32_bf16 v[48:51], v[92:95], v[80:83], v[48:51]
  ds_read_b64_tr_b16 v[92:93], v106 offset:192
  ds_read_b64_tr_b16 v[94:95], v106 offset:1344
  s_add_u32 m0, s45, 79872
  s_add_u32 s46, s33, 1032192
  buffer_load_dwordx4 v112, s[8:11], s46 offen lds
  s_waitcnt lgkmcnt(6)
  v_mfma_f32_16x16x32_bf16 v[16:19], v[96:99], v[76:79], v[16:19]
  v_mfma_f32_16x16x32_bf16 v[52:55], v[96:99], v[80:83], v[52:55]
  ds_read_b64_tr_b16 v[96:97], v106 offset:224
  ds_read_b64_tr_b16 v[98:99], v106 offset:1376
  s_cmp_ge_u32 s40, 3
  s_cbranch_scc1 gemm2_kernel_wsk17
  s_add_u32 m0, s45, 88064
  s_add_u32 s46, s33, 1032192
  buffer_load_dwordx4 v113, s[8:11], s46 offen lds
  gemm2_kernel_wsk17:
  s_waitcnt lgkmcnt(6)
  v_mfma_f32_16x16x32_bf16 v[20:23], v[84:87], v[76:79], v[20:23]
  v_mfma_f32_16x16x32_bf16 v[56:59], v[84:87], v[80:83], v[56:59]
  ds_read_b64_tr_b16 v[84:85], v106 offset:256
  ds_read_b64_tr_b16 v[86:87], v106 offset:1408
  s_waitcnt lgkmcnt(6)
  v_mfma_f32_16x16x32_bf16 v[24:27], v[88:91], v[76:79], v[24:27]
  v_mfma_f32_16x16x32_bf16 v[60:63], v[88:91], v[80:83], v[60:63]
  s_waitcnt lgkmcnt(4)
  v_mfma_f32_16x16x32_bf16 v[28:31], v[92:95], v[76:79], v[28:31]
  v_mfma_f32_16x16x32_bf16 v[64:67], v[92:95], v[80:83], v[64:67]
  s_waitcnt lgkmcnt(2)
  v_mfma_f32_16x16x32_bf16 v[32:35], v[96:99], v[76:79], v[32:35]
  v_mfma_f32_16x16x32_bf16 v[68:71], v[96:99], v[80:83], v[68:71]
  s_waitcnt lgkmcnt(0)
  v_mfma_f32_16x16x32_bf16 v[36:39], v[84:87], v[76:79], v[36:39]
  v_mfma_f32_16x16x32_bf16 v[72:75], v[84:87], v[80:83], v[72:75]
  s_waitcnt vmcnt(4)
  s_barrier
  ds_read_b64_tr_b16 v[84:85], v107 offset:0
  ds_read_b64_tr_b16 v[86:87], v107 offset:1152
  ds_read_b128 v[76:79], v102 offset:0
  ds_read_b128 v[80:83], v102 offset:2048
  ds_read_b64_tr_b16 v[88:89], v107 offset:32
  ds_read_b64_tr_b16 v[90:91], v107 offset:1184
  ds_read_b64_tr_b16 v[92:93], v107 offset:64
  ds_read_b64_tr_b16 v[94:95], v107 offset:1216
  ds_read_b64_tr_b16 v[96:97], v107 offset:96
  ds_read_b64_tr_b16 v[98:99], v107 offset:1248
  s_add_u32 m0, s44, 0
  s_add_u32 s46, s43, 30720
  buffer_load_dwordx4 v109, s[4:7], s46 offen lds
  s_waitcnt lgkmcnt(6)
  v_mfma_f32_16x16x32_bf16 v[4:7], v[84:87], v[76:79], v[4:7]
  v_mfma_f32_16x16x32_bf16 v[40:43], v[84:87], v[80:83], v[40:43]
  ds_read_b64_tr_b16 v[84:85], v107 offset:128
  ds_read_b64_tr_b16 v[86:87], v107 offset:1280
  s_add_u32 m0, s44, 1024
  s_add_u32 s46, s43, 30720
  buffer_load_dwordx4 v110, s[4:7], s46 offen lds
  s_waitcnt lgkmcnt(6)
  v_mfma_f32_16x16x32_bf16 v[8:11], v[88:91], v[76:79], v[8:11]
  v_mfma_f32_16x16x32_bf16 v[44:47], v[88:91], v[80:83], v[44:47]
  ds_read_b64_tr_b16 v[88:89], v107 offset:160
  ds_read_b64_tr_b16 v[90:91], v107 offset:1312
  s_add_u32 m0, s45, 0
  s_add_u32 s46, s33, 1105920
  buffer_load_dwordx4 v111, s[8:11], s46 offen lds
  s_waitcnt lgkmcnt(6)
  v_mfma_f32_16x16x32_bf16 v[12:15], v[92:95], v[76:79], v[12:15]
  v_mfma_f32_16x16x32_bf16 v[48:51], v[92:95], v[80:83], v[48:51]
  ds_read_b64_tr_b16 v[92:93], v107 offset:192
  ds_read_b64_tr_b16 v[94:95], v107 offset:1344
  s_add_u32 m0, s45, 8192
  s_add_u32 s46, s33, 1105920
  buffer_load_dwordx4 v112, s[8:11], s46 offen lds
  s_waitcnt lgkmcnt(6)
  v_mfma_f32_16x16x32_bf16 v[16:19], v[96:99], v[76:79], v[16:19]
  v_mfma_f32_16x16x32_bf16 v[52:55], v[96:99], v[80:83], v[52:55]
  ds_read_b64_tr_b16 v[96:97], v107 offset:224
  ds_read_b64_tr_b16 v[98:99], v107 offset:1376
  s_cmp_ge_u32 s40, 3
  s_cbranch_scc1 gemm2_kernel_wsk18
  s_add_u32 m0, s45, 16384
  s_add_u32 s46, s33, 1105920
  buffer_load_dwordx4 v113, s[8:11], s46 offen lds
  gemm2_kernel_wsk18:
  s_waitcnt lgkmcnt(6)
  v_mfma_f32_16x16x32_bf16 v[20:23], v[84:87], v[76:79], v[20:23]
  v_mfma_f32_16x16x32_bf16 v[56:59], v[84:87], v[80:83], v[56:59]
  ds_read_b64_tr_b16 v[84:85], v107 offset:256
  ds_read_b64_tr_b16 v[86:87], v107 offset:1408
  s_waitcnt lgkmcnt(6)
  v_mfma_f32_16x16x32_bf16 v[24:27], v[88:91], v[76:79], v[24:27]
  v_mfma_f32_16x16x32_bf16 v[60:63], v[88:91], v[80:83], v[60:63]
  s_waitcnt lgkmcnt(4)
  v_mfma_f32_16x16x32_bf16 v[28:31], v[92:95], v[76:79], v[28:31]
  v_mfma_f32_16x16x32_bf16 v[64:67], v[92:95], v[80:83], v[64:67]
  s_waitcnt lgkmcnt(2)
  v_mfma_f32_16x16x32_bf16 v[32:35], v[96:99], v[76:79], v[32:35]
  v_mfma_f32_16x16x32_bf16 v[68:71], v[96:99], v[80:83], v[68:71]
  s_waitcnt lgkmcnt(0)
  v_mfma_f32_16x16x32_bf16 v[36:39], v[84:87], v[76:79], v[36:39]
  v_mfma_f32_16x16x32_bf16 v[72:75], v[84:87], v[80:83], v[72:75]
  s_waitcnt vmcnt(4)
  s_barrier
  ds_read_b64_tr_b16 v[84:85], v108 offset:0
  ds_read_b64_tr_b16 v[86:87], v108 offset:1152
  ds_read_b128 v[76:79], v104 offset:0
  ds_read_b128 v[80:83], v104 offset:2048
  ds_read_b64_tr_b16 v[88:89], v108 offset:32
  ds_read_b64_tr_b16 v[90:91], v108 offset:1184
  ds_read_b64_tr_b16 v[92:93], v108 offset:64
  ds_read_b64_tr_b16 v[94:95], v108 offset:1216
  ds_read_b64_tr_b16 v[96:97], v108 offset:96
  ds_read_b64_tr_b16 v[98:99], v108 offset:1248
  s_add_u32 m0, s44, 35840
  s_add_u32 s46, s43, 32768
  buffer_load_dwordx4 v109, s[4:7], s46 offen lds
  s_waitcnt lgkmcnt(6)
  v_mfma_f32_16x16x32_bf16 v[4:7], v[84:87], v[76:79], v[4:7]
  v_mfma_f32_16x16x32_bf16 v[40:43], v[84:87], v[80:83], v[40:43]
  ds_read_b64_tr_b16 v[84:85], v108 offset:128
  ds_read_b64_tr_b16 v[86:87], v108 offset:1280
  s_add_u32 m0, s44, 36864
  s_add_u32 s46, s43, 32768
  buffer_load_dwordx4 v110, s[4:7], s46 offen lds
  s_waitcnt lgkmcnt(6)
  v_mfma_f32_16x16x32_bf16 v[8:11], v[88:91], v[76:79], v[8:11]
  v_mfma_f32_16x16x32_bf16 v[44:47], v[88:91], v[80:83], v[44:47]
  ds_read_b64_tr_b16 v[88:89], v108 offset:160
  ds_read_b64_tr_b16 v[90:91], v108 offset:1312
  s_add_u32 m0, s45, 35840
  s_add_u32 s46, s33, 1179648
  buffer_load_dwordx4 v111, s[8:11], s46 offen lds
  s_waitcnt lgkmcnt(6)
  v_mfma_f32_16x16x32_bf16 v[12:15], v[92:95], v[76:79], v[12:15]
  v_mfma_f32_16x16x32_bf16 v[48:51], v[92:95], v[80:83], v[48:51]
  ds_read_b64_tr_b16 v[92:93], v108 offset:192
  ds_read_b64_tr_b16 v[94:95], v108 offset:1344
  s_add_u32 m0, s45, 44032
  s_add_u32 s46, s33, 1179648
  buffer_load_dwordx4 v112, s[8:11], s46 offen lds
  s_waitcnt lgkmcnt(6)
  v_mfma_f32_16x16x32_bf16 v[16:19], v[96:99], v[76:79], v[16:19]
  v_mfma_f32_16x16x32_bf16 v[52:55], v[96:99], v[80:83], v[52:55]
  ds_read_b64_tr_b16 v[96:97], v108 offset:224
  ds_read_b64_tr_b16 v[98:99], v108 offset:1376
  s_cmp_ge_u32 s40, 3
  s_cbranch_scc1 gemm2_kernel_wsk19
  s_add_u32 m0, s45, 52224
  s_add_u32 s46, s33, 1179648
  buffer_load_dwordx4 v113, s[8:11], s46 offen lds
  gemm2_kernel_wsk19:
  s_waitcnt lgkmcnt(6)
  v_mfma_f32_16x16x32_bf16 v[20:23], v[84:87], v[76:79], v[20:23]
  v_mfma_f32_16x16x32_bf16 v[56:59], v[84:87], v[80:83], v[56:59]
  ds_read_b64_tr_b16 v[84:85], v108 offset:256
  ds_read_b64_tr_b16 v[86:87], v108 offset:1408
  s_waitcnt lgkmcnt(6)
  v_mfma_f32_16x16x32_bf16 v[24:27], v[88:91], v[76:79], v[24:27]
  v_mfma_f32_16x16x32_bf16 v[60:63], v[88:91], v[80:83], v[60:63]
  s_waitcnt lgkmcnt(4)
  v_mfma_f32_16x16x32_bf16 v[28:31], v[92:95], v[76:79], v[28:31]
  v_mfma_f32_16x16x32_bf16 v[64:67], v[92:95], v[80:83], v[64:67]
  s_waitcnt lgkmcnt(2)
  v_mfma_f32_16x16x32_bf16 v[32:35], v[96:99], v[76:79], v[32:35]
  v_mfma_f32_16x16x32_bf16 v[68:71], v[96:99], v[80:83], v[68:71]
  s_waitcnt lgkmcnt(0)
  v_mfma_f32_16x16x32_bf16 v[36:39], v[84:87], v[76:79], v[36:39]
  v_mfma_f32_16x16x32_bf16 v[72:75], v[84:87], v[80:83], v[72:75]
  s_waitcnt vmcnt(4)
  s_barrier
  ds_read_b64_tr_b16 v[84:85], v106 offset:0
  ds_read_b64_tr_b16 v[86:87], v106 offset:1152
  ds_read_b128 v[76:79], v100 offset:0
  ds_read_b128 v[80:83], v100 offset:2048
  ds_read_b64_tr_b16 v[88:89], v106 offset:32
  ds_read_b64_tr_b16 v[90:91], v106 offset:1184
  ds_read_b64_tr_b16 v[92:93], v106 offset:64
  ds_read_b64_tr_b16 v[94:95], v106 offset:1216
  ds_read_b64_tr_b16 v[96:97], v106 offset:96
  ds_read_b64_tr_b16 v[98:99], v106 offset:1248
  s_add_u32 m0, s44, 71680
  s_add_u32 s46, s43, 34816
  buffer_load_dwordx4 v109, s[4:7], s46 offen lds
  s_waitcnt lgkmcnt(6)
  v_mfma_f32_16x16x32_bf16 v[4:7], v[84:87], v[76:79], v[4:7]
  v_mfma_f32_16x16x32_bf16 v[40:43], v[84:87], v[80:83], v[40:43]
  ds_read_b64_tr_b16 v[84:85], v106 offset:128
  ds_read_b64_tr_b16 v[86:87], v106 offset:1280
  s_add_u32 m0, s44, 72704
  s_add_u32 s46, s43, 34816
  buffer_load_dwordx4 v110, s[4:7], s46 offen lds
  s_waitcnt lgkmcnt(6)
  v_mfma_f32_16x16x32_bf16 v[8:11], v[88:91], v[76:79], v[8:11]
  v_mfma_f32_16x16x32_bf16 v[44:47], v[88:91], v[80:83], v[44:47]
  ds_read_b64_tr_b16 v[88:89], v106 offset:160
  ds_read_b64_tr_b16 v[90:91], v106 offset:1312
  s_add_u32 m0, s45, 71680
  s_add_u32 s46, s33, 1253376
  buffer_load_dwordx4 v111, s[8:11], s46 offen lds
  s_waitcnt lgkmcnt(6)
  v_mfma_f32_16x16x32_bf16 v[12:15], v[92:95], v[76:79], v[12:15]
  v_mfma_f32_16x16x32_bf16 v[48:51], v[92:95], v[80:83], v[48:51]
  ds_read_b64_tr_b16 v[92:93], v106 offset:192
  ds_read_b64_tr_b16 v[94:95], v106 offset:1344
  s_add_u32 m0, s45, 79872
  s_add_u32 s46, s33, 1253376
  buffer_load_dwordx4 v112, s[8:11], s46 offen lds
  s_waitcnt lgkmcnt(6)
  v_mfma_f32_16x16x32_bf16 v[16:19], v[96:99], v[76:79], v[16:19]
  v_mfma_f32_16x16x32_bf16 v[52:55], v[96:99], v[80:83], v[52:55]
  ds_read_b64_tr_b16 v[96:97], v106 offset:224
  ds_read_b64_tr_b16 v[98:99], v106 offset:1376
  s_cmp_ge_u32 s40, 3
  s_cbranch_scc1 gemm2_kernel_wsk20
  s_add_u32 m0, s45, 88064
  s_add_u32 s46, s33, 1253376
  buffer_load_dwordx4 v113, s[8:11], s46 offen lds
  gemm2_kernel_wsk20:
  s_waitcnt lgkmcnt(6)
  v_mfma_f32_16x16x32_bf16 v[20:23], v[84:87], v[76:79], v[20:23]
  v_mfma_f32_16x16x32_bf16 v[56:59], v[84:87], v[80:83], v[56:59]
  ds_read_b64_tr_b16 v[84:85], v106 offset:256
  ds_read_b64_tr_b16 v[86:87], v106 offset:1408
  s_waitcnt lgkmcnt(6)
  v_mfma_f32_16x16x32_bf16 v[24:27], v[88:91], v[76:79], v[24:27]
  v_mfma_f32_16x16x32_bf16 v[60:63], v[88:91], v[80:83], v[60:63]
  s_waitcnt lgkmcnt(4)
  v_mfma_f32_16x16x32_bf16 v[28:31], v[92:95], v[76:79], v[28:31]
  v_mfma_f32_16x16x32_bf16 v[64:67], v[92:95], v[80:83], v[64:67]
  s_waitcnt lgkmcnt(2)
  v_mfma_f32_16x16x32_bf16 v[32:35], v[96:99], v[76:79], v[32:35]
  v_mfma_f32_16x16x32_bf16 v[68:71], v[96:99], v[80:83], v[68:71]
  s_waitcnt lgkmcnt(0)
  v_mfma_f32_16x16x32_bf16 v[36:39], v[84:87], v[76:79], v[36:39]
  v_mfma_f32_16x16x32_bf16 v[72:75], v[84:87], v[80:83], v[72:75]
  s_waitcnt vmcnt(4)
  s_barrier
  ds_read_b64_tr_b16 v[84:85], v107 offset:0
  ds_read_b64_tr_b16 v[86:87], v107 offset:1152
  ds_read_b128 v[76:79], v102 offset:0
  ds_read_b128 v[80:83], v102 offset:2048
  ds_read_b64_tr_b16 v[88:89], v107 offset:32
  ds_read_b64_tr_b16 v[90:91], v107 offset:1184
  ds_read_b64_tr_b16 v[92:93], v107 offset:64
  ds_read_b64_tr_b16 v[94:95], v107 offset:1216
  ds_read_b64_tr_b16 v[96:97], v107 offset:96
  ds_read_b64_tr_b16 v[98:99], v107 offset:1248
  s_waitcnt lgkmcnt(6)
  v_mfma_f32_16x16x32_bf16 v[4:7], v[84:87], v[76:79], v[4:7]
  v_mfma_f32_16x16x32_bf16 v[40:43], v[84:87], v[80:83], v[40:43]
  ds_read_b64_tr_b16 v[84:85], v107 offset:128
  ds_read_b64_tr_b16 v[86:87], v107 offset:1280
  s_waitcnt lgkmcnt(6)
  v_mfma_f32_16x16x32_bf16 v[8:11], v[88:91], v[76:79], v[8:11]
  v_mfma_f32_16x16x32_bf16 v[44:47], v[88:91], v[80:83], v[44:47]
  ds_read_b64_tr_b16 v[88:89], v107 offset:160
  ds_read_b64_tr_b16 v[90:91], v107 offset:1312
  s_waitcnt lgkmcnt(6)
  v_mfma_f32_16x16x32_bf16 v[12:15], v[92:95], v[76:79], v[12:15]
  v_mfma_f32_16x16x32_bf16 v[48:51], v[92:95], v[80:83], v[48:51]
  ds_read_b64_tr_b16 v[92:93], v107 offset:192
  ds_read_b64_tr_b16 v[94:95], v107 offset:1344
  s_waitcnt lgkmcnt(6)
  v_mfma_f32_16x16x32_bf16 v[16:19], v[96:99], v[76:79], v[16:19]
  v_mfma_f32_16x16x32_bf16 v[52:55], v[96:99], v[80:83], v[52:55]
  ds_read_b64_tr_b16 v[96:97], v107 offset:224
  ds_read_b64_tr_b16 v[98:99], v107 offset:1376
  s_waitcnt lgkmcnt(6)
  v_mfma_f32_16x16x32_bf16 v[20:23], v[84:87], v[76:79], v[20:23]
  v_mfma_f32_16x16x32_bf16 v[56:59], v[84:87], v[80:83], v[56:59]
  ds_read_b64_tr_b16 v[84:85], v107 offset:256
  ds_read_b64_tr_b16 v[86:87], v107 offset:1408
  s_waitcnt lgkmcnt(6)
  v_mfma_f32_16x16x32_bf16 v[24:27], v[88:91], v[76:79], v[24:27]
  v_mfma_f32_16x16x32_bf16 v[60:63], v[88:91], v[80:83], v[60:63]
  s_waitcnt lgkmcnt(4)
  v_mfma_f32_16x16x32_bf16 v[28:31], v[92:95], v[76:79], v[28:31]
  v_mfma_f32_16x16x32_bf16 v[64:67], v[92:95], v[80:83], v[64:67]
  s_waitcnt lgkmcnt(2)
  v_mfma_f32_16x16x32_bf16 v[32:35], v[96:99], v[76:79], v[32:35]
  v_mfma_f32_16x16x32_bf16 v[68:71], v[96:99], v[80:83], v[68:71]
  s_waitcnt lgkmcnt(0)
  v_mfma_f32_16x16x32_bf16 v[36:39], v[84:87], v[76:79], v[36:39]
  v_mfma_f32_16x16x32_bf16 v[72:75], v[84:87], v[80:83], v[72:75]
  s_waitcnt vmcnt(0)
  s_barrier
  ds_read_b64_tr_b16 v[84:85], v108 offset:0
  ds_read_b64_tr_b16 v[86:87], v108 offset:1152
  ds_read_b128 v[76:79], v104 offset:0
  ds_read_b128 v[80:83], v104 offset:2048
  ds_read_b64_tr_b16 v[88:89], v108 offset:32
  ds_read_b64_tr_b16 v[90:91], v108 offset:1184
  ds_read_b64_tr_b16 v[92:93], v108 offset:64
  ds_read_b64_tr_b16 v[94:95], v108 offset:1216
  ds_read_b64_tr_b16 v[96:97], v108 offset:96
  ds_read_b64_tr_b16 v[98:99], v108 offset:1248
  s_waitcnt lgkmcnt(6)
  v_mfma_f32_16x16x32_bf16 v[4:7], v[84:87], v[76:79], v[4:7]
  v_mfma_f32_16x16x32_bf16 v[40:43], v[84:87], v[80:83], v[40:43]
  ds_read_b64_tr_b16 v[84:85], v108 offset:128
  ds_read_b64_tr_b16 v[86:87], v108 offset:1280
  s_waitcnt lgkmcnt(6)
  v_mfma_f32_16x16x32_bf16 v[8:11], v[88:91], v[76:79], v[8:11]
  v_mfma_f32_16x16x32_bf16 v[44:47], v[88:91], v[80:83], v[44:47]
  ds_read_b64_tr_b16 v[88:89], v108 offset:160
  ds_read_b64_tr_b16 v[90:91], v108 offset:1312
  s_waitcnt lgkmcnt(6)
  v_mfma_f32_16x16x32_bf16 v[12:15], v[92:95], v[76:79], v[12:15]
  v_mfma_f32_16x16x32_bf16 v[48:51], v[92:95], v[80:83], v[48:51]
  ds_read_b64_tr_b16 v[92:93], v108 offset:192
  ds_read_b64_tr_b16 v[94:95], v108 offset:1344
  s_waitcnt lgkmcnt(6)
  v_mfma_f32_16x16x32_bf16 v[16:19], v[96:99], v[76:79], v[16:19]
  v_mfma_f32_16x16x32_bf16 v[52:55], v[96:99], v[80:83], v[52:55]
  ds_read_b64_tr_b16 v[96:97], v108 offset:224
  ds_read_b64_tr_b16 v[98:99], v108 offset:1376
  s_waitcnt lgkmcnt(6)
  v_mfma_f32_16x16x32_bf16 v[20:23], v[84:87], v[76:79], v[20:23]
  v_mfma_f32_16x16x32_bf16 v[56:59], v[84:87], v[80:83], v[56:59]
  ds_read_b64_tr_b16 v[84:85], v108 offset:256
  ds_read_b64_tr_b16 v[86:87], v108 offset:1408
  s_waitcnt lgkmcnt(6)
  v_mfma_f32_16x16x32_bf16 v[24:27], v[88:91], v[76:79], v[24:27]
  v_mfma_f32_16x16x32_bf16 v[60:63], v[88:91], v[80:83], v[60:63]
  s_waitcnt lgkmcnt(4)
  v_mfma_f32_16x16x32_bf16 v[28:31], v[92:95], v[76:79], v[28:31]
  v_mfma_f32_16x16x32_bf16 v[64:67], v[92:95], v[80:83], v[64:67]
  s_waitcnt lgkmcnt(2)
  v_mfma_f32_16x16x32_bf16 v[32:35], v[96:99], v[76:79], v[32:35]
  v_mfma_f32_16x16x32_bf16 v[68:71], v[96:99], v[80:83], v[68:71]
  s_waitcnt lgkmcnt(0)
  v_mfma_f32_16x16x32_bf16 v[36:39], v[84:87], v[76:79], v[36:39]
  v_mfma_f32_16x16x32_bf16 v[72:75], v[84:87], v[80:83], v[72:75]
  s_nop 7
  s_nop 7
  s_barrier
  v_and_b32 v114, 63, v0
  v_lshlrev_b32 v114, 4, v114
  s_mul_i32 s34, s40, 9216
  v_add_u32 v115, s34, v114
  s_xor_b32 s35, s40, 4
  s_mul_i32 s34, s35, 9216
  v_add_u32 v116, s34, v114
  s_cmp_eq_u32 s42, 1
  s_cbranch_scc1 gemm2_kernel_wk121
  ds_write_b128 v115, v[40:43] offset:0
  ds_write_b128 v115, v[44:47] offset:1024
  ds_write_b128 v115, v[48:51] offset:2048
  ds_write_b128 v115, v[52:55] offset:3072
  ds_write_b128 v115, v[56:59] offset:4096
  ds_write_b128 v115, v[60:63] offset:5120
  ds_write_b128 v115, v[64:67] offset:6144
  ds_write_b128 v115, v[68:71] offset:7168
  ds_write_b128 v115, v[72:75] offset:8192
  s_branch gemm2_kernel_join22
gemm2_kernel_wk121:
  ds_write_b128 v115, v[4:7] offset:0
  ds_write_b128 v115, v[8:11] offset:1024
  ds_write_b128 v115, v[12:15] offset:2048
  ds_write_b128 v115, v[16:19] offset:3072
  ds_write_b128 v115, v[20:23] offset:4096
  ds_write_b128 v115, v[24:27] offset:5120
  ds_write_b128 v115, v[28:31] offset:6144
  ds_write_b128 v115, v[32:35] offset:7168
  ds_write_b128 v115, v[36:39] offset:8192
  s_nop 1
  v_mov_b32 v4, v40
  v_mov_b32 v5, v41
  v_mov_b32 v6, v42
  v_mov_b32 v7, v43
  v_mov_b32 v8, v44
  v_mov_b32 v9, v45
  v_mov_b32 v10, v46
  v_mov_b32 v11, v47
  v_mov_b32 v12, v48
  v_mov_b32 v13, v49
  v_mov_b32 v14, v50
  v_mov_b32 v15, v51
  v_mov_b32 v16, v52
  v_mov_b32 v17, v53
  v_mov_b32 v18, v54
  v_mov_b32 v19, v55
  v_mov_b32 v20, v56
  v_mov_b32 v21, v57
  v_mov_b32 v22, v58
  v_mov_b32 v23, v59
  v_mov_b32 v24, v60
  v_mov_b32 v25, v61
  v_mov_b32 v26, v62
  v_mov_b32 v27, v63
  v_mov_b32 v28, v64
  v_mov_b32 v29, v65
  v_mov_b32 v30, v66
  v_mov_b32 v31, v67
  v_mov_b32 v32, v68
  v_mov_b32 v33, v69
  v_mov_b32 v34, v70
  v_mov_b32 v35, v71
  v_mov_b32 v36, v72
  v_mov_b32 v37, v73
  v_mov_b32 v38, v74
  v_mov_b32 v39, v75
gemm2_kernel_join22:
  s_waitcnt lgkmcnt(0)
  s_barrier
  ds_read_b128 v[40:43], v116 offset:0
  ds_read_b128 v[44:47], v116 offset:1024
  ds_read_b128 v[48:51], v116 offset:2048
  ds_read_b128 v[52:55], v116 offset:3072
  ds_read_b128 v[56:59], v116 offset:4096
  ds_read_b128 v[60:63], v116 offset:5120
  ds_read_b128 v[64:67], v116 offset:6144
  ds_read_b128 v[68:71], v116 offset:7168
  ds_read_b128 v[72:75], v116 offset:8192
  s_lshl_b32 s34, s37, 7
  s_lshl_b32 s35, s30, 3
  s_add_u32 s34, s34, s35
  s_lshl_b32 s35, s41, 1
  s_add_u32 s34, s34, s35
  s_add_u32 s34, s34, s42
  s_mul_i32 s34, s34, 36
  s_mul_i32 s35, s36, 9
  s_add_u32 s34, s34, s35
  s_lshl_b32 s34, s34, 10
  s_waitcnt lgkmcnt(8)
  v_add_f32 v4, v4, v40
  v_add_f32 v5, v5, v41
  v_add_f32 v6, v6, v42
  v_add_f32 v7, v7, v43
  s_add_u32 s35, s34, 0
  buffer_store_dwordx4 v[4:7], v114, s[12:15], s35 offen sc1
  s_waitcnt lgkmcnt(7)
  v_add_f32 v8, v8, v44
  v_add_f32 v9, v9, v45
  v_add_f32 v10, v10, v46
  v_add_f32 v11, v11, v47
  s_add_u32 s35, s34, 1024
  buffer_store_dwordx4 v[8:11], v114, s[12:15], s35 offen sc1
  s_waitcnt lgkmcnt(6)
  v_add_f32 v12, v12, v48
  v_add_f32 v13, v13, v49
  v_add_f32 v14, v14, v50
  v_add_f32 v15, v15, v51
  s_add_u32 s35, s34, 2048
  buffer_store_dwordx4 v[12:15], v114, s[12:15], s35 offen sc1
  s_waitcnt lgkmcnt(5)
  v_add_f32 v16, v16, v52
  v_add_f32 v17, v17, v53
  v_add_f32 v18, v18, v54
  v_add_f32 v19, v19, v55
  s_add_u32 s35, s34, 3072
  buffer_store_dwordx4 v[16:19], v114, s[12:15], s35 offen sc1
  s_waitcnt lgkmcnt(4)
  v_add_f32 v20, v20, v56
  v_add_f32 v21, v21, v57
  v_add_f32 v22, v22, v58
  v_add_f32 v23, v23, v59
  s_add_u32 s35, s34, 4096
  buffer_store_dwordx4 v[20:23], v114, s[12:15], s35 offen sc1
  s_waitcnt lgkmcnt(3)
  v_add_f32 v24, v24, v60
  v_add_f32 v25, v25, v61
  v_add_f32 v26, v26, v62
  v_add_f32 v27, v27, v63
  s_add_u32 s35, s34, 5120
  buffer_store_dwordx4 v[24:27], v114, s[12:15], s35 offen sc1
  s_waitcnt lgkmcnt(2)
  v_add_f32 v28, v28, v64
  v_add_f32 v29, v29, v65
  v_add_f32 v30, v30, v66
  v_add_f32 v31, v31, v67
  s_add_u32 s35, s34, 6144
  buffer_store_dwordx4 v[28:31], v114, s[12:15], s35 offen sc1
  s_waitcnt lgkmcnt(1)
  v_add_f32 v32, v32, v68
  v_add_f32 v33, v33, v69
  v_add_f32 v34, v34, v70
  v_add_f32 v35, v35, v71
  s_add_u32 s35, s34, 7168
  buffer_store_dwordx4 v[32:35], v114, s[12:15], s35 offen sc1
  s_waitcnt lgkmcnt(0)
  v_add_f32 v36, v36, v72
  v_add_f32 v37, v37, v73
  v_add_f32 v38, v38, v74
  v_add_f32 v39, v39, v75
  s_add_u32 s35, s34, 8192
  buffer_store_dwordx4 v[36:39], v114, s[12:15], s35 offen sc1
  s_endpgm
gemm2_kernel_att2:
  s_load_dwordx2 s[4:5], s[0:1], 96
  s_load_dwordx2 s[8:9], s[0:1], 96
  s_load_dwordx2 s[12:13], s[0:1], 96
  s_waitcnt lgkmcnt(0)
  s_add_u32 s4, s4, 4718592
  s_addc_u32 s5, s5, 0
  s_mov_b32 s6, 2359296
  s_mov_b32 s7, 0x00020000
  s_add_u32 s8, s8, 9510912
  s_addc_u32 s9, s9, 0
  s_mov_b32 s10, 212992
  s_mov_b32 s11, 0x00020000
  s_add_u32 s12, s12, 7077888
  s_addc_u32 s13, s13, 0
  s_mov_b32 s14, 2359296
  s_mov_b32 s15, 0x00020000
  s_setprio 3
  v_bfe_u32 v100, v0, 6, 3
  s_nop 0
  v_readfirstlane_b32 s16, v100
  s_nop 3
  s_lshl_b32 s17, s2, 3
  s_add_u32 s16, s16, s17
  s_lshr_b32 s17, s16, 6
  s_and_b32 s18, s16, 63
  v_and_b32 v100, 31, v0
  v_bfe_u32 v101, v0, 5, 1
  v_mov_b32 v114, 0x80000000
  s_lshl_b32 s19, s18, 5
  v_add_u32 v102, s19, v100
  s_movk_i32 s19, 1152
  v_mul_lo_u32 v102, v102, s19
  s_mul_i32 s19, s17, 36
  v_add_u32 v113, s19, v102
  v_lshl_add_u32 v102, v101, 4, v113
  buffer_load_dwordx4 v[4:7], v102, s[4:7], 0 offen
  v_cmp_eq_u32 vcc, 0, v101
  s_nop 1
  v_cndmask_b32 v103, v114, v113, vcc
  buffer_load_dword v8, v103, s[4:7], 0 offen offset:32
  v_cndmask_b32 v112, 0, -1, vcc
  v_mov_b32 v9, 0
  v_mov_b32 v10, 0
  v_mov_b32 v11, 0
  v_mov_b32 v111, 0
  v_and_b32 v108, 63, v0
  v_lshlrev_b32 v108, 4, v108
  v_lshlrev_b32 v109, 2, v100
  v_add_u32 v109, 65536, v109
  v_min_u32 v110, 18, v100
  v_lshl_add_u32 v110, v101, 5, v110
  v_lshlrev_b32 v110, 4, v110
  v_add_u32 v110, 73728, v110
  v_mov_b32 v21, 0x3f80
  v_mov_b32 v22, 0
  v_mov_b32 v23, 0
  v_mov_b32 v25, 0x3f80
  v_mov_b32 v26, 0
  v_mov_b32 v27, 0
  s_mov_b32 s26, 0x20133333
  s_mov_b32 s27, 0
gemm2_kernel_restart23:
  v_mov_b32 v84, 0
  v_mov_b32 v85, 0
  v_mov_b32 v86, 0
  v_mov_b32 v87, 0
  v_mov_b32 v88, 0
  v_mov_b32 v89, 0
  v_mov_b32 v90, 0
  v_mov_b32 v91, 0
  v_mov_b32 v92, 0
  v_mov_b32 v93, 0
  v_mov_b32 v94, 0
  v_mov_b32 v95, 0
  v_mov_b32 v96, 0
  v_mov_b32 v97, 0
  v_mov_b32 v98, 0
  v_mov_b32 v99, 0
  v_mov_b32 v9, 0
  v_mov_b32 v111, 0
  s_mov_b32 s23, 0xff800000
  s_mov_b32 s24, 0xff800000
  s_mov_b32 s20, 0
  s_mov_b32 s21, 0
  s_mov_b32 s22, 0
  buffer_load_dwordx4 v[12:15], v108, s[8:11], s20 offen
  buffer_load_dword v20, v109, s[8:11], s21 offen
  s_add_u32 s20, s20, 1024
  s_add_u32 s21, s21, 128
  buffer_load_dwordx4 v[16:19], v108, s[8:11], s20 offen
  buffer_load_dword v24, v109, s[8:11], s21 offen
  s_add_u32 s20, s20, 1024
  s_add_u32 s21, s21, 128
  buffer_load_dwordx4 v[28:31], v110, s[8:11], s22 offen
  buffer_load_dwordx4 v[32:35], v110, s[8:11], s22 offen offset:1024
  s_add_u32 s22, s22, 2048
  s_waitcnt vmcnt(4)
  v_mfma_f32_32x32x16_bf16 v[44:59], v[12:15], v[4:7], 0
  v_mfma_f32_32x32x16_bf16 v[44:59], v[20:23], v[8:11], v[44:59]
  buffer_load_dwordx4 v[12:15], v108, s[8:11], s20 offen
  buffer_load_dword v20, v109, s[8:11], s21 offen
  s_add_u32 s20, s20, 1024
  s_add_u32 s21, s21, 128
  buffer_load_dwordx4 v[36:39], v110, s[8:11], s22 offen
  buffer_load_dwordx4 v[40:43], v110, s[8:11], s22 offen offset:1024
  s_add_u32 s22, s22, 2048
  s_mov_b32 s25, 0
  s_nop 7
  s_nop 7
  s_cmp_lg_u32 s27, 0
  s_cbranch_scc1 gemm2_kernel_safe24
  s_and_b32 s19, s16, 7
  s_lshl_b32 s60, s19, 10
  s_add_u32 s60, s60, 1024
  s_mov_b32 s64, 8192
  s_lshl_b32 s61, s19, 10
  s_add_u32 s61, s61, 72704
  s_mov_b32 s65, 16384
  s_cmp_eq_u32 s19, 0
  s_cselect_b32 s61, 65664, s61
  s_cselect_b32 s65, 1024, s65
  s_lshl_b32 s62, s19, 10
  s_add_u32 s62, s62, 80896
  s_mov_b32 s66, 16384
  s_mov_b32 s63, 89088
  s_mov_b32 s67, 16384
  s_lshl_b32 s68, s19, 10
  s_add_u32 s68, s68, 107520
  s_mov_b32 s69, 0
  s_add_u32 s23, s68, s69
  s_add_u32 m0, s23, 0
  s_nop 0
  buffer_load_dwordx4 v108, s[8:11], s60 offen lds
  s_add_u32 s60, s60, s64
  s_add_u32 s23, s68, s69
  s_add_u32 m0, s23, 8192
  s_nop 0
  buffer_load_dwordx4 v108, s[8:11], s61 offen lds
  s_add_u32 s61, s61, s65
  s_add_u32 s23, s68, s69
  s_add_u32 m0, s23, 16384
  s_nop 0
  buffer_load_dwordx4 v108, s[8:11], s62 offen lds
  s_add_u32 s62, s62, s66
  s_cmp_lg_u32 s19, 0
  s_cbranch_scc1 gemm2_kernel_nd26
  s_add_u32 s23, s68, s69
  s_add_u32 m0, s23, 24576
  s_nop 0
  buffer_load_dwordx4 v108, s[8:11], s63 offen lds
  s_add_u32 s63, s63, s67
gemm2_kernel_nd26:
  s_xor_b32 s69, s69, 25600
  v_max3_f32 v100, v44, v45, v46
  v_max3_f32 v101, v47, v48, v49
  v_max3_f32 v102, v50, v51, v52
  v_max3_f32 v103, v53, v54, v55
  v_max3_f32 v104, v56, v57, v58
  v_max3_f32 v100, v100, v101, v59
  v_max3_f32 v102, v102, v103, v104
  v_max_f32 v100, v100, v102
  v_mov_b32 v101, v100
  s_nop 7
  v_permlane32_swap_b32 v100, v101
  s_nop 1
  v_max_f32 v100, v100, v101
  v_max_f32 v100, s24, v100
  v_sub_f32 v101, v111, v100
  v_cvt_pk_bf16_f32 v101, v101, v101
  v_lshlrev_b32 v101, 16, v101
  v_sub_f32 v102, v111, v101
  v_mov_b32 v111, v101
  v_lshrrev_b32 v103, 16, v101
  v_and_b32 v9, v103, v112
  v_exp_f32 v103, -v102
  s_nop 7
  v_min_f32 v103, 1.0, v103
  v_sub_f32 v44, v44, v102
  v_sub_f32 v45, v45, v102
  v_sub_f32 v46, v46, v102
  v_sub_f32 v47, v47, v102
  v_sub_f32 v48, v48, v102
  v_sub_f32 v49, v49, v102
  v_sub_f32 v50, v50, v102
  v_sub_f32 v51, v51, v102
  v_sub_f32 v52, v52, v102
  v_sub_f32 v53, v53, v102
  v_sub_f32 v54, v54, v102
  v_sub_f32 v55, v55, v102
  v_sub_f32 v56, v56, v102
  v_sub_f32 v57, v57, v102
  v_sub_f32 v58, v58, v102
  v_sub_f32 v59, v59, v102
  v_mul_f32 v84, v84, v103
  v_mul_f32 v85, v85, v103
  v_mul_f32 v86, v86, v103
  v_mul_f32 v87, v87, v103
  v_mul_f32 v88, v88, v103
  v_mul_f32 v89, v89, v103
  v_mul_f32 v90, v90, v103
  v_mul_f32 v91, v91, v103
  v_mul_f32 v92, v92, v103
  v_mul_f32 v93, v93, v103
  v_mul_f32 v94, v94, v103
  s_mov_b32 s23, 0x41000000
  s_mov_b32 s24, 0
  s_waitcnt vmcnt(0)
  v_add_u32 v24, 107520, v108
  v_subrev_u32 v26, -50176, v109
  v_subrev_u32 v27, -43008, v110
  s_barrier
  s_add_u32 s23, s68, s69
  s_add_u32 m0, s23, 0
  s_nop 0
  buffer_load_dwordx4 v108, s[8:11], s60 offen lds
  s_add_u32 s60, s60, s64
  s_add_u32 s23, s68, s69
  s_add_u32 m0, s23, 8192
  s_nop 0
  buffer_load_dwordx4 v108, s[8:11], s61 offen lds
  s_add_u32 s61, s61, s65
  s_add_u32 s23, s68, s69
  s_add_u32 m0, s23, 16384
  s_nop 0
  buffer_load_dwordx4 v108, s[8:11], s62 offen lds
  s_add_u32 s62, s62, s66
  s_cmp_lg_u32 s19, 0
  s_cbranch_scc1 gemm2_kernel_nd27
  s_add_u32 s23, s68, s69
  s_add_u32 m0, s23, 24576
  s_nop 0
  buffer_load_dwordx4 v108, s[8:11], s63 offen lds
  s_add_u32 s63, s63, s67
gemm2_kernel_nd27:
  s_xor_b32 s69, s69, 25600
  ds_read_b128 v[12:15], v24 offset:0
  ds_read_b32 v20, v26 offset:0
  ds_read_b128 v[28:31], v27 offset:0
  ds_read_b128 v[32:35], v27 offset:1024
  s_mov_b32 s25, 0
gemm2_kernel_floop28:
  v_exp_f32 v44, v44
  v_exp_f32 v45, v45
  v_exp_f32 v46, v46
  v_exp_f32 v47, v47
  s_waitcnt lgkmcnt(3)
  v_mfma_f32_32x32x16_bf16 v[60:75], v[12:15], v[4:7], 0
  v_exp_f32 v48, v48
  v_exp_f32 v49, v49
  v_exp_f32 v50, v50
  v_exp_f32 v51, v51
  s_waitcnt lgkmcnt(2)
  v_mfma_f32_32x32x16_bf16 v[60:75], v[20:23], v[8:11], v[60:75]
  v_exp_f32 v52, v52
  v_cvt_pk_bf16_f32 v76, v44, v45
  v_cvt_pk_bf16_f32 v77, v46, v47
  v_cvt_pk_bf16_f32 v78, v48, v49
  v_cvt_pk_bf16_f32 v79, v50, v51
  v_exp_f32 v53, v53
  s_waitcnt lgkmcnt(1)
  v_mfma_f32_32x32x16_bf16 v[84:99], v[28:31], v[76:79], v[84:99]
  v_exp_f32 v54, v54
  v_exp_f32 v55, v55
  v_exp_f32 v56, v56
  v_exp_f32 v57, v57
  v_exp_f32 v58, v58
  v_exp_f32 v59, v59
  v_cvt_pk_bf16_f32 v80, v52, v53
  v_cvt_pk_bf16_f32 v81, v54, v55
  v_cvt_pk_bf16_f32 v82, v56, v57
  v_cvt_pk_bf16_f32 v83, v58, v59
  s_waitcnt lgkmcnt(0)
  s_nop 0
  v_mfma_f32_32x32x16_bf16 v[84:99], v[32:35], v[80:83], v[84:99]
  ds_read_b128 v[12:15], v24 offset:1024
  ds_read_b32 v20, v26 offset:128
  ds_read_b128 v[28:31], v27 offset:2048
  ds_read_b128 v[32:35], v27 offset:3072
  v_exp_f32 v60, v60
  v_exp_f32 v61, v61
  v_exp_f32 v62, v62
  v_exp_f32 v63, v63
  s_waitcnt lgkmcnt(3)
  v_mfma_f32_32x32x16_bf16 v[44:59], v[12:15], v[4:7], 0
  v_exp_f32 v64, v64
  v_exp_f32 v65, v65
  v_exp_f32 v66, v66
  v_exp_f32 v67, v67
  s_waitcnt lgkmcnt(2)
  v_mfma_f32_32x32x16_bf16 v[44:59], v[20:23], v[8:11], v[44:59]
  v_exp_f32 v68, v68
  v_cvt_pk_bf16_f32 v76, v60, v61
  v_cvt_pk_bf16_f32 v77, v62, v63
  v_cvt_pk_bf16_f32 v78, v64, v65
  v_cvt_pk_bf16_f32 v79, v66, v67
  v_exp_f32 v69, v69
  s_waitcnt lgkmcnt(1)
  v_mfma_f32_32x32x16_bf16 v[84:99], v[28:31], v[76:79], v[84:99]
  v_exp_f32 v70, v70
  v_exp_f32 v71, v71
  v_exp_f32 v72, v72
  v_exp_f32 v73, v73
  v_exp_f32 v74, v74
  v_exp_f32 v75, v75
  v_cvt_pk_bf16_f32 v80, v68, v69
  v_cvt_pk_bf16_f32 v81, v70, v71
  v_cvt_pk_bf16_f32 v82, v72, v73
  v_cvt_pk_bf16_f32 v83, v74, v75
  s_waitcnt lgkmcnt(0)
  s_nop 0
  v_mfma_f32_32x32x16_bf16 v[84:99], v[32:35], v[80:83], v[84:99]
  ds_read_b128 v[12:15], v24 offset:2048
  ds_read_b32 v20, v26 offset:256
  ds_read_b128 v[28:31], v27 offset:4096
  ds_read_b128 v[32:35], v27 offset:5120
  s_bitcmp1_b32 s26, s25
  s_cbranch_scc0 gemm2_kernel_nobar29
  s_barrier
gemm2_kernel_nobar29:
  s_add_u32 s25, s25, 1
  v_exp_f32 v44, v44
  v_exp_f32 v45, v45
  v_exp_f32 v46, v46
  v_exp_f32 v47, v47
  s_waitcnt lgkmcnt(3)
  v_mfma_f32_32x32x16_bf16 v[60:75], v[12:15], v[4:7], 0
  v_exp_f32 v48, v48
  v_exp_f32 v49, v49
  v_exp_f32 v50, v50
  v_exp_f32 v51, v51
  s_waitcnt lgkmcnt(2)
  v_mfma_f32_32x32x16_bf16 v[60:75], v[20:23], v[8:11], v[60:75]
  v_exp_f32 v52, v52
  v_cvt_pk_bf16_f32 v76, v44, v45
  v_cvt_pk_bf16_f32 v77, v46, v47
  v_cvt_pk_bf16_f32 v78, v48, v49
  v_cvt_pk_bf16_f32 v79, v50, v51
  v_exp_f32 v53, v53
  s_waitcnt lgkmcnt(1)
  v_mfma_f32_32x32x16_bf16 v[84:99], v[28:31], v[76:79], v[84:99]
  v_exp_f32 v54, v54
  v_exp_f32 v55, v55
  v_exp_f32 v56, v56
  v_exp_f32 v57, v57
  v_exp_f32 v58, v58
  v_exp_f32 v59, v59
  v_cvt_pk_bf16_f32 v80, v52, v53
  v_cvt_pk_bf16_f32 v81, v54, v55
  v_cvt_pk_bf16_f32 v82, v56, v57
  v_cvt_pk_bf16_f32 v83, v58, v59
  s_waitcnt lgkmcnt(0)
  s_nop 0
  v_mfma_f32_32x32x16_bf16 v[84:99], v[32:35], v[80:83], v[84:99]
  ds_read_b128 v[12:15], v24 offset:3072
  ds_read_b32 v20, v26 offset:384
  ds_read_b128 v[28:31], v27 offset:6144
  ds_read_b128 v[32:35], v27 offset:7168
  v_exp_f32 v60, v60
  v_exp_f32 v61, v61
  v_exp_f32 v62, v62
  v_exp_f32 v63, v63
  s_waitcnt lgkmcnt(3)
  v_mfma_f32_32x32x16_bf16 v[44:59], v[12:15], v[4:7], 0
  v_exp_f32 v64, v64
  v_exp_f32 v65, v65
  v_exp_f32 v66, v66
  v_exp_f32 v67, v67
  s_waitcnt lgkmcnt(2)
  v_mfma_f32_32x32x16_bf16 v[44:59], v[20:23], v[8:11], v[44:59]
  v_exp_f32 v68, v68
  v_cvt_pk_bf16_f32 v76, v60, v61
  v_cvt_pk_bf16_f32 v77, v62, v63
  v_cvt_pk_bf16_f32 v78, v64, v65
  v_cvt_pk_bf16_f32 v79, v66, v67
  v_exp_f32 v69, v69
  s_waitcnt lgkmcnt(1)
  v_mfma_f32_32x32x16_bf16 v[84:99], v[28:31], v[76:79], v[84:99]
  v_exp_f32 v70, v70
  v_exp_f32 v71, v71
  v_exp_f32 v72, v72
  v_exp_f32 v73, v73
  v_exp_f32 v74, v74
  v_exp_f32 v75, v75
  v_cvt_pk_bf16_f32 v80, v68, v69
  v_cvt_pk_bf16_f32 v81, v70, v71
  v_cvt_pk_bf16_f32 v82, v72, v73
  v_cvt_pk_bf16_f32 v83, v74, v75
  s_waitcnt lgkmcnt(0)
  s_nop 0
  v_mfma_f32_32x32x16_bf16 v[84:99], v[32:35], v[80:83], v[84:99]
  ds_read_b128 v[12:15], v24 offset:4096
  ds_read_b32 v20, v26 offset:512
  ds_read_b128 v[28:31], v27 offset:8192
  ds_read_b128 v[32:35], v27 offset:9216
  s_bitcmp1_b32 s26, s25
  s_cbranch_scc0 gemm2_kernel_nobar30
  s_barrier
gemm2_kernel_nobar30:
  s_add_u32 s25, s25, 1
  v_exp_f32 v44, v44
  v_exp_f32 v45, v45
  v_exp_f32 v46, v46
  v_exp_f32 v47, v47
  s_waitcnt lgkmcnt(3)
  v_mfma_f32_32x32x16_bf16 v[60:75], v[12:15], v[4:7], 0
  v_exp_f32 v48, v48
  v_exp_f32 v49, v49
  v_exp_f32 v50, v50
  v_exp_f32 v51, v51
  s_waitcnt lgkmcnt(2)
  v_mfma_f32_32x32x16_bf16 v[60:75], v[20:23], v[8:11], v[60:75]
  v_exp_f32 v52, v52
  v_cvt_pk_bf16_f32 v76, v44, v45
  v_cvt_pk_bf16_f32 v77, v46, v47
  v_cvt_pk_bf16_f32 v78, v48, v49
  v_cvt_pk_bf16_f32 v79, v50, v51
  v_exp_f32 v53, v53
  s_waitcnt lgkmcnt(1)
  v_mfma_f32_32x32x16_bf16 v[84:99], v[28:31], v[76:79], v[84:99]
  v_exp_f32 v54, v54
  v_exp_f32 v55, v55
  v_exp_f32 v56, v56
  v_exp_f32 v57, v57
  v_exp_f32 v58, v58
  v_exp_f32 v59, v59
  v_cvt_pk_bf16_f32 v80, v52, v53
  v_cvt_pk_bf16_f32 v81, v54, v55
  v_cvt_pk_bf16_f32 v82, v56, v57
  v_cvt_pk_bf16_f32 v83, v58, v59
  s_waitcnt lgkmcnt(0)
  s_nop 0
  v_mfma_f32_32x32x16_bf16 v[84:99], v[32:35], v[80:83], v[84:99]
  ds_read_b128 v[12:15], v24 offset:5120
  ds_read_b32 v20, v26 offset:640
  ds_read_b128 v[28:31], v27 offset:10240
  ds_read_b128 v[32:35], v27 offset:11264
  v_exp_f32 v60, v60
  v_exp_f32 v61, v61
  v_exp_f32 v62, v62
  v_exp_f32 v63, v63
  s_waitcnt lgkmcnt(3)
  v_mfma_f32_32x32x16_bf16 v[44:59], v[12:15], v[4:7], 0
  v_exp_f32 v64, v64
  v_exp_f32 v65, v65
  v_exp_f32 v66, v66
  v_exp_f32 v67, v67
  s_waitcnt lgkmcnt(2)
  v_mfma_f32_32x32x16_bf16 v[44:59], v[20:23], v[8:11], v[44:59]
  v_exp_f32 v68, v68
  v_cvt_pk_bf16_f32 v76, v60, v61
  v_cvt_pk_bf16_f32 v77, v62, v63
  v_cvt_pk_bf16_f32 v78, v64, v65
  v_cvt_pk_bf16_f32 v79, v66, v67
  v_exp_f32 v69, v69
  s_waitcnt lgkmcnt(1)
  v_mfma_f32_32x32x16_bf16 v[84:99], v[28:31], v[76:79], v[84:99]
  v_exp_f32 v70, v70
  v_exp_f32 v71, v71
  v_exp_f32 v72, v72
  v_exp_f32 v73, v73
  v_exp_f32 v74, v74
  v_exp_f32 v75, v75
  v_cvt_pk_bf16_f32 v80, v68, v69
  v_cvt_pk_bf16_f32 v81, v70, v71
  v_cvt_pk_bf16_f32 v82, v72, v73
  v_cvt_pk_bf16_f32 v83, v74, v75
  s_waitcnt lgkmcnt(0)
  s_nop 0
  v_mfma_f32_32x32x16_bf16 v[84:99], v[32:35], v[80:83], v[84:99]
  ds_read_b128 v[12:15], v24 offset:6144
  ds_read_b32 v20, v26 offset:768
  ds_read_b128 v[28:31], v27 offset:12288
  ds_read_b128 v[32:35], v27 offset:13312
  s_bitcmp1_b32 s26, s25
  s_cbranch_scc0 gemm2_kernel_nobar31
  s_barrier
gemm2_kernel_nobar31:
  s_add_u32 s25, s25, 1
  v_exp_f32 v44, v44
  v_exp_f32 v45, v45
  v_exp_f32 v46, v46
  v_exp_f32 v47, v47
  s_waitcnt lgkmcnt(3)
  v_mfma_f32_32x32x16_bf16 v[60:75], v[12:15], v[4:7], 0
  v_exp_f32 v48, v48
  v_exp_f32 v49, v49
  v_exp_f32 v50, v50
  v_exp_f32 v51, v51
  s_waitcnt lgkmcnt(2)
  v_mfma_f32_32x32x16_bf16 v[60:75], v[20:23], v[8:11], v[60:75]
  v_exp_f32 v52, v52
  v_cvt_pk_bf16_f32 v76, v44, v45
  v_cvt_pk_bf16_f32 v77, v46, v47
  v_cvt_pk_bf16_f32 v78, v48, v49
  v_cvt_pk_bf16_f32 v79, v50, v51
  v_exp_f32 v53, v53
  s_waitcnt lgkmcnt(1)
  v_mfma_f32_32x32x16_bf16 v[84:99], v[28:31], v[76:79], v[84:99]
  v_exp_f32 v54, v54
  v_exp_f32 v55, v55
  v_exp_f32 v56, v56
  v_exp_f32 v57, v57
  v_exp_f32 v58, v58
  v_exp_f32 v59, v59
  v_cvt_pk_bf16_f32 v80, v52, v53
  v_cvt_pk_bf16_f32 v81, v54, v55
  v_cvt_pk_bf16_f32 v82, v56, v57
  v_cvt_pk_bf16_f32 v83, v58, v59
  s_waitcnt lgkmcnt(0)
  s_nop 0
  v_mfma_f32_32x32x16_bf16 v[84:99], v[32:35], v[80:83], v[84:99]
  ds_read_b128 v[12:15], v24 offset:7168
  ds_read_b32 v20, v26 offset:896
  ds_read_b128 v[28:31], v27 offset:14336
  ds_read_b128 v[32:35], v27 offset:15360
  v_exp_f32 v60, v60
  v_exp_f32 v61, v61
  v_exp_f32 v62, v62
  v_exp_f32 v63, v63
  s_waitcnt lgkmcnt(3)
  v_mfma_f32_32x32x16_bf16 v[44:59], v[12:15], v[4:7], 0
  v_exp_f32 v64, v64
  v_exp_f32 v65, v65
  v_exp_f32 v66, v66
  v_exp_f32 v67, v67
  s_waitcnt lgkmcnt(2)
  v_mfma_f32_32x32x16_bf16 v[44:59], v[20:23], v[8:11], v[44:59]
  v_exp_f32 v68, v68
  v_cvt_pk_bf16_f32 v76, v60, v61
  v_cvt_pk_bf16_f32 v77, v62, v63
  v_cvt_pk_bf16_f32 v78, v64, v65
  v_cvt_pk_bf16_f32 v79, v66, v67
  v_exp_f32 v69, v69
  s_waitcnt lgkmcnt(1)
  v_mfma_f32_32x32x16_bf16 v[84:99], v[28:31], v[76:79], v[84:99]
  v_exp_f32 v70, v70
  v_exp_f32 v71, v71
  v_exp_f32 v72, v72
  v_exp_f32 v73, v73
  v_exp_f32 v74, v74
  v_exp_f32 v75, v75
  v_cvt_pk_bf16_f32 v80, v68, v69
  v_cvt_pk_bf16_f32 v81, v70, v71
  v_cvt_pk_bf16_f32 v82, v72, v73
  v_cvt_pk_bf16_f32 v83, v74, v75
  s_waitcnt lgkmcnt(0)
  s_nop 0
  v_mfma_f32_32x32x16_bf16 v[84:99], v[32:35], v[80:83], v[84:99]
  s_waitcnt vmcnt(0)
  s_barrier
  s_sub_u32 s23, 25600, s69
  s_lshl_b32 s23, s23, 1
  s_sub_u32 s23, s23, 25600
  v_add_u32 v24, s23, v24
  v_add_u32 v26, s23, v26
  v_add_u32 v27, s23, v27
  s_add_u32 s23, s68, s69
  s_add_u32 m0, s23, 0
  s_nop 0
  buffer_load_dwordx4 v108, s[8:11], s60 offen lds
  s_add_u32 s60, s60, s64
  s_add_u32 s23, s68, s69
  s_add_u32 m0, s23, 8192
  s_nop 0
  buffer_load_dwordx4 v108, s[8:11], s61 offen lds
  s_add_u32 s61, s61, s65
  s_add_u32 s23, s68, s69
  s_add_u32 m0, s23, 16384
  s_nop 0
  buffer_load_dwordx4 v108, s[8:11], s62 offen lds
  s_add_u32 s62, s62, s66
  s_cmp_lg_u32 s19, 0
  s_cbranch_scc1 gemm2_kernel_nd33
  s_add_u32 s23, s68, s69
  s_add_u32 m0, s23, 24576
  s_nop 0
  buffer_load_dwordx4 v108, s[8:11], s63 offen lds
  s_add_u32 s63, s63, s67
gemm2_kernel_nd33:
  s_xor_b32 s69, s69, 25600
  ds_read_b128 v[12:15], v24 offset:0
  ds_read_b32 v20, v26 offset:0
  ds_read_b128 v[28:31], v27 offset:0
  ds_read_b128 v[32:35], v27 offset:1024
  s_add_u32 s25, s25, 1
  s_cmp_lt_u32 s25, 32
  s_cbranch_scc1 gemm2_kernel_floop28
  s_waitcnt vmcnt(0) lgkmcnt(0)
  v_mov_b32 v21, 0x3f80
  v_mov_b32 v22, 0
  v_mov_b32 v23, 0
  v_mov_b32 v25, 0x3f80
  v_mov_b32 v26, 0
  v_mov_b32 v27, 0
  s_nop 15
  s_nop 3
  v_mov_b32 v100, v94
  v_mov_b32 v101, v94
  s_nop 1
  v_permlane32_swap_b32 v100, v101
  s_mov_b32 s23, 0x5f800000
  s_nop 1
  v_cmp_ngt_f32 vcc, s23, v100
  s_cbranch_vccz gemm2_kernel_epi25
  s_waitcnt vmcnt(0)
  s_mov_b32 s27, 1
  s_branch gemm2_kernel_restart23
gemm2_kernel_safe24:
gemm2_kernel_loop34:
  v_max3_f32 v100, v44, v45, v46
  v_max3_f32 v101, v47, v48, v49
  v_max3_f32 v102, v50, v51, v52
  v_max3_f32 v103, v53, v54, v55
  v_max3_f32 v104, v56, v57, v58
  v_max3_f32 v100, v100, v101, v59
  v_max3_f32 v102, v102, v103, v104
  v_max_f32 v100, v100, v102
  v_cmp_lt_f32 vcc, s23, v100
  s_cbranch_vccnz gemm2_kernel_rare35
gemm2_kernel_back36:
  s_waitcnt vmcnt(6)
  v_mfma_f32_32x32x16_bf16 v[60:75], v[16:19], v[4:7], 0
  v_exp_f32 v44, v44
  v_exp_f32 v45, v45
  v_exp_f32 v46, v46
  v_exp_f32 v47, v47
  v_mfma_f32_32x32x16_bf16 v[60:75], v[24:27], v[8:11], v[60:75]
  buffer_load_dwordx4 v[16:19], v108, s[8:11], s20 offen
  buffer_load_dword v24, v109, s[8:11], s21 offen
  s_add_u32 s20, s20, 1024
  s_add_u32 s21, s21, 128
  v_exp_f32 v48, v48
  v_exp_f32 v49, v49
  v_exp_f32 v50, v50
  v_exp_f32 v51, v51
  v_exp_f32 v52, v52
  v_cvt_pk_bf16_f32 v76, v44, v45
  v_cvt_pk_bf16_f32 v77, v46, v47
  v_cvt_pk_bf16_f32 v78, v48, v49
  v_cvt_pk_bf16_f32 v79, v50, v51
  v_exp_f32 v53, v53
  s_waitcnt vmcnt(6)
  v_mfma_f32_32x32x16_bf16 v[84:99], v[28:31], v[76:79], v[84:99]
  v_exp_f32 v54, v54
  v_exp_f32 v55, v55
  v_exp_f32 v56, v56
  v_exp_f32 v57, v57
  v_exp_f32 v58, v58
  v_exp_f32 v59, v59
  v_cvt_pk_bf16_f32 v80, v52, v53
  v_cvt_pk_bf16_f32 v81, v54, v55
  v_cvt_pk_bf16_f32 v82, v56, v57
  v_cvt_pk_bf16_f32 v83, v58, v59
  s_nop 1
  v_mfma_f32_32x32x16_bf16 v[84:99], v[32:35], v[80:83], v[84:99]
  buffer_load_dwordx4 v[28:31], v110, s[8:11], s22 offen
  buffer_load_dwordx4 v[32:35], v110, s[8:11], s22 offen offset:1024
  s_add_u32 s22, s22, 2048
  v_max3_f32 v100, v60, v61, v62
  v_max3_f32 v101, v63, v64, v65
  v_max3_f32 v102, v66, v67, v68
  v_max3_f32 v103, v69, v70, v71
  v_max3_f32 v104, v72, v73, v74
  v_max3_f32 v100, v100, v101, v75
  v_max3_f32 v102, v102, v103, v104
  v_max_f32 v100, v100, v102
  v_cmp_lt_f32 vcc, s23, v100
  s_cbranch_vccnz gemm2_kernel_rare37
gemm2_kernel_back38:
  s_waitcnt vmcnt(6)
  v_mfma_f32_32x32x16_bf16 v[44:59], v[12:15], v[4:7], 0
  v_exp_f32 v60, v60
  v_exp_f32 v61, v61
  v_exp_f32 v62, v62
  v_exp_f32 v63, v63
  v_mfma_f32_32x32x16_bf16 v[44:59], v[20:23], v[8:11], v[44:59]
  buffer_load_dwordx4 v[12:15], v108, s[8:11], s20 offen
  buffer_load_dword v20, v109, s[8:11], s21 offen
  s_add_u32 s20, s20, 1024
  s_add_u32 s21, s21, 128
  v_exp_f32 v64, v64
  v_exp_f32 v65, v65
  v_exp_f32 v66, v66
  v_exp_f32 v67, v67
  v_exp_f32 v68, v68
  v_cvt_pk_bf16_f32 v76, v60, v61
  v_cvt_pk_bf16_f32 v77, v62, v63
  v_cvt_pk_bf16_f32 v78, v64, v65
  v_cvt_pk_bf16_f32 v79, v66, v67
  v_exp_f32 v69, v69
  s_waitcnt vmcnt(6)
  v_mfma_f32_32x32x16_bf16 v[84:99], v[36:39], v[76:79], v[84:99]
  v_exp_f32 v70, v70
  v_exp_f32 v71, v71
  v_exp_f32 v72, v72
  v_exp_f32 v73, v73
  v_exp_f32 v74, v74
  v_exp_f32 v75, v75
  v_cvt_pk_bf16_f32 v80, v68, v69
  v_cvt_pk_bf16_f32 v81, v70, v71
  v_cvt_pk_bf16_f32 v82, v72, v73
  v_cvt_pk_bf16_f32 v83, v74, v75
  s_nop 1
  v_mfma_f32_32x32x16_bf16 v[84:99], v[40:43], v[80:83], v[84:99]
  buffer_load_dwordx4 v[36:39], v110, s[8:11], s22 offen
  buffer_load_dwordx4 v[40:43], v110, s[8:11], s22 offen offset:1024
  s_add_u32 s22, s22, 2048
  s_add_u32 s25, s25, 1
  s_cmp_lt_u32 s25, 32
  s_cbranch_scc1 gemm2_kernel_loop34
  s_nop 15
  s_nop 3
  v_mov_b32 v100, v94
  v_mov_b32 v101, v94
  s_nop 1
  v_permlane32_swap_b32 v100, v101
  s_nop 1
gemm2_kernel_epi25:
  v_rcp_f32 v100, v100
  s_nop 0
  v_mul_f32 v84, v84, v100
  v_mul_f32 v85, v85, v100
  v_mul_f32 v86, v86, v100
  v_mul_f32 v87, v87, v100
  v_mul_f32 v88, v88, v100
  v_mul_f32 v89, v89, v100
  v_mul_f32 v90, v90, v100
  v_mul_f32 v91, v91, v100
  v_mul_f32 v92, v92, v100
  v_mul_f32 v93, v93, v100
  v_cvt_pk_bf16_f32 v84, v84, v85
  v_cvt_pk_bf16_f32 v85, v86, v87
  v_cvt_pk_bf16_f32 v86, v88, v89
  v_cvt_pk_bf16_f32 v87, v90, v91
  v_cvt_pk_bf16_f32 v88, v92, v93
  v_bfe_u32 v101, v0, 5, 1
  v_lshl_add_u32 v102, v101, 3, v113
  buffer_store_dwordx2 v[84:85], v102, s[12:15], 0 offen
  buffer_store_dwordx2 v[86:87], v102, s[12:15], 0 offen offset:16
  v_cmp_eq_u32 vcc, 0, v101
  s_nop 1
  v_cndmask_b32 v103, v114, v113, vcc
  buffer_store_dword v88, v103, s[12:15], 0 offen offset:32
  s_branch gemm2_kernel_done1
gemm2_kernel_rare35:
  v_mov_b32 v101, v100
  s_nop 7
  v_permlane32_swap_b32 v100, v101
  s_nop 1
  v_max_f32 v100, v100, v101
  v_max_f32 v100, s24, v100
  v_sub_f32 v101, v111, v100
  v_cvt_pk_bf16_f32 v101, v101, v101
  v_lshlrev_b32 v101, 16, v101
  v_sub_f32 v102, v111, v101
  v_mov_b32 v111, v101
  v_lshrrev_b32 v103, 16, v101
  v_and_b32 v9, v103, v112
  v_exp_f32 v103, -v102
  s_nop 7
  v_min_f32 v103, 1.0, v103
  v_sub_f32 v44, v44, v102
  v_sub_f32 v45, v45, v102
  v_sub_f32 v46, v46, v102
  v_sub_f32 v47, v47, v102
  v_sub_f32 v48, v48, v102
  v_sub_f32 v49, v49, v102
  v_sub_f32 v50, v50, v102
  v_sub_f32 v51, v51, v102
  v_sub_f32 v52, v52, v102
  v_sub_f32 v53, v53, v102
  v_sub_f32 v54, v54, v102
  v_sub_f32 v55, v55, v102
  v_sub_f32 v56, v56, v102
  v_sub_f32 v57, v57, v102
  v_sub_f32 v58, v58, v102
  v_sub_f32 v59, v59, v102
  v_mul_f32 v84, v84, v103
  v_mul_f32 v85, v85, v103
  v_mul_f32 v86, v86, v103
  v_mul_f32 v87, v87, v103
  v_mul_f32 v88, v88, v103
  v_mul_f32 v89, v89, v103
  v_mul_f32 v90, v90, v103
  v_mul_f32 v91, v91, v103
  v_mul_f32 v92, v92, v103
  v_mul_f32 v93, v93, v103
  v_mul_f32 v94, v94, v103
  s_mov_b32 s23, 0x41000000
  s_mov_b32 s24, 0
  s_branch gemm2_kernel_back36
gemm2_kernel_rare37:
  v_mov_b32 v101, v100
  s_nop 7
  v_permlane32_swap_b32 v100, v101
  s_nop 1
  v_max_f32 v100, v100, v101
  v_max_f32 v100, s24, v100
  v_sub_f32 v101, v111, v100
  v_cvt_pk_bf16_f32 v101, v101, v101
  v_lshlrev_b32 v101, 16, v101
  v_sub_f32 v102, v111, v101
  v_mov_b32 v111, v101
  v_lshrrev_b32 v103, 16, v101
  v_and_b32 v9, v103, v112
  v_exp_f32 v103, -v102
  s_nop 7
  v_min_f32 v103, 1.0, v103
  v_sub_f32 v60, v60, v102
  v_sub_f32 v61, v61, v102
  v_sub_f32 v62, v62, v102
  v_sub_f32 v63, v63, v102
  v_sub_f32 v64, v64, v102
  v_sub_f32 v65, v65, v102
  v_sub_f32 v66, v66, v102
  v_sub_f32 v67, v67, v102
  v_sub_f32 v68, v68, v102
  v_sub_f32 v69, v69, v102
  v_sub_f32 v70, v70, v102
  v_sub_f32 v71, v71, v102
  v_sub_f32 v72, v72, v102
  v_sub_f32 v73, v73, v102
  v_sub_f32 v74, v74, v102
  v_sub_f32 v75, v75, v102
  v_mul_f32 v84, v84, v103
  v_mul_f32 v85, v85, v103
  v_mul_f32 v86, v86, v103
  v_mul_f32 v87, v87, v103
  v_mul_f32 v88, v88, v103
  v_mul_f32 v89, v89, v103
  v_mul_f32 v90, v90, v103
  v_mul_f32 v91, v91, v103
  v_mul_f32 v92, v92, v103
  v_mul_f32 v93, v93, v103
  v_mul_f32 v94, v94, v103
  s_mov_b32 s23, 0x41000000
  s_mov_b32 s24, 0
  s_branch gemm2_kernel_back38
gemm2_kernel_done1:
  s_endpgm
.globl final_kernel
.p2align 8
.type final_kernel,@function
final_kernel:
  s_cmp_ge_u32 s2, 256
  s_cbranch_scc1 final_kernel_done1
  s_load_dwordx2 s[4:5], s[0:1], 96
  s_load_dwordx2 s[8:9], s[0:1], 32
  s_load_dwordx2 s[12:13], s[0:1], 96
  s_load_dwordx2 s[16:17], s[0:1], 0
  s_load_dwordx2 s[20:21], s[0:1], 72
  s_load_dwordx2 s[24:25], s[0:1], 80
  s_waitcnt lgkmcnt(0)
  s_add_u32 s4, s4, 7077888
  s_addc_u32 s5, s5, 0
  s_mov_b32 s6, 2359296
  s_mov_b32 s7, 0x00020000
  s_mov_b32 s10, 663552
  s_mov_b32 s11, 0x00020000
  s_add_u32 s12, s12, 28598272
  s_addc_u32 s13, s13, 0
  s_mov_b32 s14, 18874368
  s_mov_b32 s15, 0x00020000
  s_mov_b32 s18, 2359296
  s_mov_b32 s19, 0x00020000
  s_mov_b32 s22, 1152
  s_mov_b32 s23, 0x00020000
  s_mov_b32 s26, 2359296
  s_mov_b32 s27, 0x00020000
  s_lshr_b32 s30, s2, 2
  s_and_b32 s31, s2, 3
  s_mul_i32 s32, s30, 36864
  s_mul_i32 s33, s31, 288
  v_lshrrev_b32 v101, 6, v0
  s_nop 0
  v_readfirstlane_b32 s40, v101
  v_and_b32 v102, 63, v0
  s_nop 2
  s_and_b32 s41, s40, 1
  s_lshr_b32 s42, s40, 1
  v_lshrrev_b32 v101, 3, v102
  s_mov_b32 s46, 1152
  v_mul_lo_u32 v101, v101, s46
  v_lshrrev_b32 v103, 4, v102
  v_and_b32 v104, 7, v102
  v_xor_b32 v103, v103, v104
  s_and_b32 s46, s40, 1
  s_lshl_b32 s46, s46, 2
  v_xor_b32 v103, s46, v103
  v_lshl_add_u32 v94, v103, 4, v101
  v_xor_b32 v103, 4, v103
  v_lshl_add_u32 v95, v103, 4, v101
  s_mul_i32 s43, s40, 9216
  s_add_u32 s43, s43, s32
  s_mul_i32 s44, s40, 1024
  s_lshl_b32 s45, s40, 10
  s_add_u32 s45, s45, 4096
  s_lshl_b32 s46, s40, 6
  s_add_u32 s46, s46, 0
  v_add_u32 v101, s46, v102
  s_mov_b32 s46, 863
  v_mul_lo_u32 v103, v101, s46
  v_lshrrev_b32 v103, 17, v103
  v_mul_u32_u24 v104, 152, v103
  v_sub_u32 v101, v101, v104
  v_mul_u32_u24 v104, 57, v101
  v_lshrrev_b32 v104, 10, v104
  v_mul_u32_u24 v96, 18, v104
  v_sub_u32 v96, v101, v96
  v_lshlrev_b32 v96, 4, v96
  v_lshl_add_u32 v104, v103, 3, v104
  s_mov_b32 s46, 1152
  v_mul_lo_u32 v104, v104, s46
  v_add_u32 v96, v96, v104
  v_cmp_gt_u32 vcc, 144, v101
  v_cmp_gt_u32 s[48:49], 8, v103
  s_nop 1
  s_and_b64 vcc, vcc, s[48:49]
  v_mov_b32 v104, 0x80000000
  s_nop 1
  v_cndmask_b32 v96, v104, v96, vcc
  s_lshl_b32 s46, s40, 6
  s_add_u32 s46, s46, 256
  v_add_u32 v101, s46, v102
  s_mov_b32 s46, 863
  v_mul_lo_u32 v103, v101, s46
  v_lshrrev_b32 v103, 17, v103
  v_mul_u32_u24 v104, 152, v103
  v_sub_u32 v101, v101, v104
  v_mul_u32_u24 v104, 57, v101
  v_lshrrev_b32 v104, 10, v104
  v_mul_u32_u24 v97, 18, v104
  v_sub_u32 v97, v101, v97
  v_lshlrev_b32 v97, 4, v97
  v_lshl_add_u32 v104, v103, 3, v104
  s_mov_b32 s46, 1152
  v_mul_lo_u32 v104, v104, s46
  v_add_u32 v97, v97, v104
  v_cmp_gt_u32 vcc, 144, v101
  v_cmp_gt_u32 s[48:49], 8, v103
  s_nop 1
  s_and_b64 vcc, vcc, s[48:49]
  v_mov_b32 v104, 0x80000000
  s_nop 1
  v_cndmask_b32 v97, v104, v97, vcc
  s_lshl_b32 s46, s40, 6
  s_add_u32 s46, s46, 512
  v_add_u32 v101, s46, v102
  s_mov_b32 s46, 863
  v_mul_lo_u32 v103, v101, s46
  v_lshrrev_b32 v103, 17, v103
  v_mul_u32_u24 v104, 152, v103
  v_sub_u32 v101, v101, v104
  v_mul_u32_u24 v104, 57, v101
  v_lshrrev_b32 v104, 10, v104
  v_mul_u32_u24 v98, 18, v104
  v_sub_u32 v98, v101, v98
  v_lshlrev_b32 v98, 4, v98
  v_lshl_add_u32 v104, v103, 3, v104
  s_mov_b32 s46, 1152
  v_mul_lo_u32 v104, v104, s46
  v_add_u32 v98, v98, v104
  v_cmp_gt_u32 vcc, 144, v101
  v_cmp_gt_u32 s[48:49], 8, v103
  s_nop 1
  s_and_b64 vcc, vcc, s[48:49]
  v_mov_b32 v104, 0x80000000
  s_nop 1
  v_cndmask_b32 v98, v104, v98, vcc
  s_lshl_b32 s46, s40, 6
  s_add_u32 s46, s46, 768
  v_add_u32 v101, s46, v102
  s_mov_b32 s46, 863
  v_mul_lo_u32 v103, v101, s46
  v_lshrrev_b32 v103, 17, v103
  v_mul_u32_u24 v104, 152, v103
  v_sub_u32 v101, v101, v104
  v_mul_u32_u24 v104, 57, v101
  v_lshrrev_b32 v104, 10, v104
  v_mul_u32_u24 v99, 18, v104
  v_sub_u32 v99, v101, v99
  v_lshlrev_b32 v99, 4, v99
  v_lshl_add_u32 v104, v103, 3, v104
  s_mov_b32 s46, 1152
  v_mul_lo_u32 v104, v104, s46
  v_add_u32 v99, v99, v104
  v_cmp_gt_u32 vcc, 144, v101
  v_cmp_gt_u32 s[48:49], 8, v103
  s_nop 1
  s_and_b64 vcc, vcc, s[48:49]
  v_mov_b32 v104, 0x80000000
  s_nop 1
  v_cndmask_b32 v99, v104, v99, vcc
  s_lshl_b32 s46, s40, 6
  s_add_u32 s46, s46, 1024
  v_add_u32 v101, s46, v102
  s_mov_b32 s46, 863
  v_mul_lo_u32 v103, v101, s46
  v_lshrrev_b32 v103, 17, v103
  v_mul_u32_u24 v104, 152, v103
  v_sub_u32 v101, v101, v104
  v_mul_u32_u24 v104, 57, v101
  v_lshrrev_b32 v104, 10, v104
  v_mul_u32_u24 v100, 18, v104
  v_sub_u32 v100, v101, v100
  v_lshlrev_b32 v100, 4, v100
  v_lshl_add_u32 v104, v103, 3, v104
  s_mov_b32 s46, 1152
  v_mul_lo_u32 v104, v104, s46
  v_add_u32 v100, v100, v104
  v_cmp_gt_u32 vcc, 144, v101
  v_cmp_gt_u32 s[48:49], 8, v103
  s_nop 1
  s_and_b64 vcc, vcc, s[48:49]
  v_mov_b32 v104, 0x80000000
  s_nop 1
  v_cndmask_b32 v100, v104, v100, vcc
  v_and_b32 v108, 15, v0
  v_bfe_u32 v109, v0, 4, 2
  v_bfe_u32 v110, v0, 6, 1
  v_lshl_add_u32 v108, v110, 4, v108
  s_movk_i32 s34, 1152
  v_mul_lo_u32 v110, v108, s34
  v_lshl_add_u32 v110, v109, 3, v110
  v_and_b32 v111, 63, v0
  v_lshlrev_b32 v111, 4, v111
  v_lshlrev_b32 v109, 3, v109
  s_add_u32 s34, s32, s33
  s_lshl_b32 s36, s30, 1
  s_add_u32 s35, s41, s36
  s_mul_i32 s35, s35, 36
  s_mul_i32 s36, s31, 9
  s_add_u32 s35, s35, s36
  s_lshl_b32 s35, s35, 10
  s_mul_i32 s36, s42, 9437184
  s_add_u32 s35, s35, s36
  s_add_u32 s36, s35, 0
  buffer_load_dwordx4 v[4:7], v111, s[12:15], s36 offen
  s_add_u32 s36, s35, 4718592
  buffer_load_dwordx4 v[116:119], v111, s[12:15], s36 offen
  s_add_u32 s36, s35, 1024
  buffer_load_dwordx4 v[8:11], v111, s[12:15], s36 offen
  s_add_u32 s36, s35, 4719616
  buffer_load_dwordx4 v[124:127], v111, s[12:15], s36 offen
  s_add_u32 s36, s35, 2048
  buffer_load_dwordx4 v[12:15], v111, s[12:15], s36 offen
  s_add_u32 s36, s35, 4720640
  buffer_load_dwordx4 v[132:135], v111, s[12:15], s36 offen
  s_add_u32 s36, s35, 3072
  buffer_load_dwordx4 v[16:19], v111, s[12:15], s36 offen
  s_add_u32 s36, s35, 4721664
  buffer_load_dwordx4 v[140:143], v111, s[12:15], s36 offen
  s_add_u32 s36, s35, 4096
  buffer_load_dwordx4 v[20:23], v111, s[12:15], s36 offen
  s_add_u32 s36, s35, 4722688
  buffer_load_dwordx4 v[148:151], v111, s[12:15], s36 offen
  s_add_u32 s36, s35, 5120
  buffer_load_dwordx4 v[24:27], v111, s[12:15], s36 offen
  s_add_u32 s36, s35, 4723712
  buffer_load_dwordx4 v[156:159], v111, s[12:15], s36 offen
  s_add_u32 s36, s35, 6144
  buffer_load_dwordx4 v[28:31], v111, s[12:15], s36 offen
  s_add_u32 s36, s35, 4724736
  buffer_load_dwordx4 v[164:167], v111, s[12:15], s36 offen
  s_add_u32 s36, s35, 7168
  buffer_load_dwordx4 v[32:35], v111, s[12:15], s36 offen
  s_add_u32 s36, s35, 4725760
  buffer_load_dwordx4 v[172:175], v111, s[12:15], s36 offen
  s_add_u32 s36, s35, 8192
  buffer_load_dwordx4 v[36:39], v111, s[12:15], s36 offen
  s_add_u32 s36, s35, 4726784
  buffer_load_dwordx4 v[180:183], v111, s[12:15], s36 offen
  s_cmp_eq_u32 s42, 1
  s_cbranch_scc1 final_kernel_lb22
  buffer_load_dwordx2 v[112:113], v110, s[16:19], s34 offen offset:0
  buffer_load_dwordx2 v[120:121], v110, s[16:19], s34 offen offset:32
  buffer_load_dwordx2 v[128:129], v110, s[16:19], s34 offen offset:64
  buffer_load_dwordx2 v[136:137], v110, s[16:19], s34 offen offset:96
  buffer_load_dwordx2 v[144:145], v110, s[16:19], s34 offen offset:128
  buffer_load_dwordx2 v[152:153], v110, s[16:19], s34 offen offset:160
  buffer_load_dwordx2 v[160:161], v110, s[16:19], s34 offen offset:192
  buffer_load_dwordx2 v[168:169], v110, s[16:19], s34 offen offset:224
  buffer_load_dwordx2 v[176:177], v110, s[16:19], s34 offen offset:256
  s_branch final_kernel_lbj3
final_kernel_lb22:
  buffer_load_dwordx2 v[112:113], v109, s[20:23], s33 offen offset:0
  buffer_load_dwordx2 v[120:121], v109, s[20:23], s33 offen offset:32
  buffer_load_dwordx2 v[128:129], v109, s[20:23], s33 offen offset:64
  buffer_load_dwordx2 v[136:137], v109, s[20:23], s33 offen offset:96
  buffer_load_dwordx2 v[144:145], v109, s[20:23], s33 offen offset:128
  buffer_load_dwordx2 v[152:153], v109, s[20:23], s33 offen offset:160
  buffer_load_dwordx2 v[160:161], v109, s[20:23], s33 offen offset:192
  buffer_load_dwordx2 v[168:169], v109, s[20:23], s33 offen offset:224
  buffer_load_dwordx2 v[176:177], v109, s[20:23], s33 offen offset:256
final_kernel_lbj3:
  s_add_u32 m0, s44, 0
  s_add_u32 s46, s43, 0
  buffer_load_dwordx4 v94, s[4:7], s46 offen lds
  s_add_u32 m0, s45, 0
  s_add_u32 s46, s33, 0
  buffer_load_dwordx4 v96, s[8:11], s46 offen lds
  s_add_u32 m0, s45, 4096
  s_add_u32 s46, s33, 0
  buffer_load_dwordx4 v97, s[8:11], s46 offen lds
  s_add_u32 m0, s45, 8192
  s_add_u32 s46, s33, 0
  buffer_load_dwordx4 v98, s[8:11], s46 offen lds
  s_add_u32 m0, s45, 12288
  s_add_u32 s46, s33, 0
  buffer_load_dwordx4 v99, s[8:11], s46 offen lds
  s_cmp_ge_u32 s40, 3
  s_cbranch_scc1 final_kernel_wsk4
  s_add_u32 m0, s45, 16384
  s_add_u32 s46, s33, 0
  buffer_load_dwordx4 v100, s[8:11], s46 offen lds
  final_kernel_wsk4:
  s_add_u32 m0, s44, 23552
  s_add_u32 s46, s43, 128
  buffer_load_dwordx4 v94, s[4:7], s46 offen lds
  s_add_u32 m0, s45, 23552
  s_add_u32 s46, s33, 73728
  buffer_load_dwordx4 v96, s[8:11], s46 offen lds
  s_add_u32 m0, s45, 27648
  s_add_u32 s46, s33, 73728
  buffer_load_dwordx4 v97, s[8:11], s46 offen lds
  s_add_u32 m0, s45, 31744
  s_add_u32 s46, s33, 73728
  buffer_load_dwordx4 v98, s[8:11], s46 offen lds
  s_add_u32 m0, s45, 35840
  s_add_u32 s46, s33, 73728
  buffer_load_dwordx4 v99, s[8:11], s46 offen lds
  s_cmp_ge_u32 s40, 3
  s_cbranch_scc1 final_kernel_wsk5
  s_add_u32 m0, s45, 39936
  s_add_u32 s46, s33, 73728
  buffer_load_dwordx4 v100, s[8:11], s46 offen lds
  final_kernel_wsk5:
  s_add_u32 m0, s44, 47104
  s_add_u32 s46, s43, 256
  buffer_load_dwordx4 v94, s[4:7], s46 offen lds
  s_add_u32 m0, s45, 47104
  s_add_u32 s46, s33, 147456
  buffer_load_dwordx4 v96, s[8:11], s46 offen lds
  s_add_u32 m0, s45, 51200
  s_add_u32 s46, s33, 147456
  buffer_load_dwordx4 v97, s[8:11], s46 offen lds
  s_add_u32 m0, s45, 55296
  s_add_u32 s46, s33, 147456
  buffer_load_dwordx4 v98, s[8:11], s46 offen lds
  s_add_u32 m0, s45, 59392
  s_add_u32 s46, s33, 147456
  buffer_load_dwordx4 v99, s[8:11], s46 offen lds
  s_cmp_ge_u32 s40, 3
  s_cbranch_scc1 final_kernel_wsk6
  s_add_u32 m0, s45, 63488
  s_add_u32 s46, s33, 147456
  buffer_load_dwordx4 v100, s[8:11], s46 offen lds
  final_kernel_wsk6:
  s_add_u32 m0, s44, 70656
  s_add_u32 s46, s43, 384
  buffer_load_dwordx4 v94, s[4:7], s46 offen lds
  s_add_u32 m0, s45, 70656
  s_add_u32 s46, s33, 221184
  buffer_load_dwordx4 v96, s[8:11], s46 offen lds
  s_add_u32 m0, s45, 74752
  s_add_u32 s46, s33, 221184
  buffer_load_dwordx4 v97, s[8:11], s46 offen lds
  s_add_u32 m0, s45, 78848
  s_add_u32 s46, s33, 221184
  buffer_load_dwordx4 v98, s[8:11], s46 offen lds
  s_add_u32 m0, s45, 82944
  s_add_u32 s46, s33, 221184
  buffer_load_dwordx4 v99, s[8:11], s46 offen lds
  s_cmp_ge_u32 s40, 3
  s_cbranch_scc1 final_kernel_wsk7
  s_add_u32 m0, s45, 87040
  s_add_u32 s46, s33, 221184
  buffer_load_dwordx4 v100, s[8:11], s46 offen lds
  final_kernel_wsk7:
  s_add_u32 m0, s44, 94208
  s_add_u32 s46, s43, 512
  buffer_load_dwordx4 v94, s[4:7], s46 offen lds
  s_add_u32 m0, s45, 94208
  s_add_u32 s46, s33, 294912
  buffer_load_dwordx4 v96, s[8:11], s46 offen lds
  s_add_u32 m0, s45, 98304
  s_add_u32 s46, s33, 294912
  buffer_load_dwordx4 v97, s[8:11], s46 offen lds
  s_add_u32 m0, s45, 102400
  s_add_u32 s46, s33, 294912
  buffer_load_dwordx4 v98, s[8:11], s46 offen lds
  s_add_u32 m0, s45, 106496
  s_add_u32 s46, s33, 294912
  buffer_load_dwordx4 v99, s[8:11], s46 offen lds
  s_cmp_ge_u32 s40, 3
  s_cbranch_scc1 final_kernel_wsk8
  s_add_u32 m0, s45, 110592
  s_add_u32 s46, s33, 294912
  buffer_load_dwordx4 v100, s[8:11], s46 offen lds
  final_kernel_wsk8:
  v_and_b32 v101, 15, v102
  v_lshrrev_b32 v103, 4, v102
  v_lshrrev_b32 v104, 1, v101
  v_xor_b32 v104, v104, v103
  v_lshlrev_b32 v101, 7, v101
  v_lshl_add_u32 v76, v104, 4, v101
  s_mul_i32 s46, s41, 2048
  v_add_u32 v76, s46, v76
  s_lshl_b32 s46, s42, 6
  v_xor_b32 v76, s46, v76
  v_xor_b32 v77, 64, v76
  v_bfe_u32 v101, v102, 2, 2
  v_lshl_add_u32 v101, v103, 3, v101
  v_mul_u32_u24 v101, 288, v101
  v_mul_u32_u24 v104, 128, v103
  v_add_u32 v101, v101, v104
  v_and_b32 v104, 3, v102
  v_lshl_add_u32 v88, v104, 3, v101
  s_mul_i32 s46, s42, 9728
  s_add_u32 s46, s46, 4096
  v_add_u32 v88, s46, v88
  v_add_u32 v78, 23552, v76
  v_add_u32 v79, 23552, v77
  v_add_u32 v89, 23552, v88
  v_add_u32 v80, 47104, v76
  v_add_u32 v81, 47104, v77
  v_add_u32 v90, 47104, v88
  v_add_u32 v82, 70656, v76
  v_add_u32 v83, 70656, v77
  v_add_u32 v91, 70656, v88
  v_add_u32 v84, 94208, v76
  v_add_u32 v85, 94208, v77
  v_add_u32 v92, 94208, v88
  v_add_u32 v86, 117760, v76
  v_add_u32 v87, 117760, v77
  v_add_u32 v93, 117760, v88
  s_waitcnt vmcnt(25)
  v_add_f32 v4, v4, v116
  v_add_f32 v5, v5, v117
  v_add_f32 v6, v6, v118
  v_add_f32 v7, v7, v119
  v_lshlrev_b32 v116, 16, v112
  v_and_b32 v117, 0xffff0000, v112
  v_lshlrev_b32 v118, 16, v113
  v_and_b32 v119, 0xffff0000, v113
  v_add_f32 v4, v4, v116
  v_add_f32 v5, v5, v117
  v_add_f32 v6, v6, v118
  v_add_f32 v7, v7, v119
  v_add_f32 v8, v8, v124
  v_add_f32 v9, v9, v125
  v_add_f32 v10, v10, v126
  v_add_f32 v11, v11, v127
  v_lshlrev_b32 v124, 16, v120
  v_and_b32 v125, 0xffff0000, v120
  v_lshlrev_b32 v126, 16, v121
  v_and_b32 v127, 0xffff0000, v121
  v_add_f32 v8, v8, v124
  v_add_f32 v9, v9, v125
  v_add_f32 v10, v10, v126
  v_add_f32 v11, v11, v127
  v_add_f32 v12, v12, v132
  v_add_f32 v13, v13, v133
  v_add_f32 v14, v14, v134
  v_add_f32 v15, v15, v135
  v_lshlrev_b32 v132, 16, v128
  v_and_b32 v133, 0xffff0000, v128
  v_lshlrev_b32 v134, 16, v129
  v_and_b32 v135, 0xffff0000, v129
  v_add_f32 v12, v12, v132
  v_add_f32 v13, v13, v133
  v_add_f32 v14, v14, v134
  v_add_f32 v15, v15, v135
  v_add_f32 v16, v16, v140
  v_add_f32 v17, v17, v141
  v_add_f32 v18, v18, v142
  v_add_f32 v19, v19, v143
  v_lshlrev_b32 v140, 16, v136
  v_and_b32 v141, 0xffff0000, v136
  v_lshlrev_b32 v142, 16, v137
  v_and_b32 v143, 0xffff0000, v137
  v_add_f32 v16, v16, v140
  v_add_f32 v17, v17, v141
  v_add_f32 v18, v18, v142
  v_add_f32 v19, v19, v143
  v_add_f32 v20, v20, v148
  v_add_f32 v21, v21, v149
  v_add_f32 v22, v22, v150
  v_add_f32 v23, v23, v151
  v_lshlrev_b32 v148, 16, v144
  v_and_b32 v149, 0xffff0000, v144
  v_lshlrev_b32 v150, 16, v145
  v_and_b32 v151, 0xffff0000, v145
  v_add_f32 v20, v20, v148
  v_add_f32 v21, v21, v149
  v_add_f32 v22, v22, v150
  v_add_f32 v23, v23, v151
  v_add_f32 v24, v24, v156
  v_add_f32 v25, v25, v157
  v_add_f32 v26, v26, v158
  v_add_f32 v27, v27, v159
  v_lshlrev_b32 v156, 16, v152
  v_and_b32 v157, 0xffff0000, v152
  v_lshlrev_b32 v158, 16, v153
  v_and_b32 v159, 0xffff0000, v153
  v_add_f32 v24, v24, v156
  v_add_f32 v25, v25, v157
  v_add_f32 v26, v26, v158
  v_add_f32 v27, v27, v159
  v_add_f32 v28, v28, v164
  v_add_f32 v29, v29, v165
  v_add_f32 v30, v30, v166
  v_add_f32 v31, v31, v167
  v_lshlrev_b32 v164, 16, v160
  v_and_b32 v165, 0xffff0000, v160
  v_lshlrev_b32 v166, 16, v161
  v_and_b32 v167, 0xffff0000, v161
  v_add_f32 v28, v28, v164
  v_add_f32 v29, v29, v165
  v_add_f32 v30, v30, v166
  v_add_f32 v31, v31, v167
  v_add_f32 v32, v32, v172
  v_add_f32 v33, v33, v173
  v_add_f32 v34, v34, v174
  v_add_f32 v35, v35, v175
  v_lshlrev_b32 v172, 16, v168
  v_and_b32 v173, 0xffff0000, v168
  v_lshlrev_b32 v174, 16, v169
  v_and_b32 v175, 0xffff0000, v169
  v_add_f32 v32, v32, v172
  v_add_f32 v33, v33, v173
  v_add_f32 v34, v34, v174
  v_add_f32 v35, v35, v175
  v_add_f32 v36, v36, v180
  v_add_f32 v37, v37, v181
  v_add_f32 v38, v38, v182
  v_add_f32 v39, v39, v183
  v_lshlrev_b32 v180, 16, v176
  v_and_b32 v181, 0xffff0000, v176
  v_lshlrev_b32 v182, 16, v177
  v_and_b32 v183, 0xffff0000, v177
  v_add_f32 v36, v36, v180
  v_add_f32 v37, v37, v181
  v_add_f32 v38, v38, v182
  v_add_f32 v39, v39, v183
  s_waitcnt vmcnt(20)
  s_barrier
  ds_read_b64_tr_b16 v[44:45], v88 offset:0
  ds_read_b64_tr_b16 v[46:47], v88 offset:1152
  ds_read_b128 v[40:43], v76 offset:0
  ds_read_b64_tr_b16 v[48:49], v88 offset:32
  ds_read_b64_tr_b16 v[50:51], v88 offset:1184
  ds_read_b64_tr_b16 v[52:53], v88 offset:64
  ds_read_b64_tr_b16 v[54:55], v88 offset:1216
  ds_read_b64_tr_b16 v[56:57], v88 offset:96
  ds_read_b64_tr_b16 v[58:59], v88 offset:1248
  ds_read_b64_tr_b16 v[60:61], v88 offset:128
  ds_read_b64_tr_b16 v[62:63], v88 offset:1280
  ds_read_b64_tr_b16 v[64:65], v88 offset:160
  ds_read_b64_tr_b16 v[66:67], v88 offset:1312
  ds_read_b64_tr_b16 v[68:69], v88 offset:192
  ds_read_b64_tr_b16 v[70:71], v88 offset:1344
  ds_read_b64_tr_b16 v[72:73], v88 offset:224
  ds_read_b64_tr_b16 v[74:75], v88 offset:1376
  s_add_u32 m0, s44, 117760
  s_add_u32 s46, s43, 640
  buffer_load_dwordx4 v94, s[4:7], s46 offen lds
  s_waitcnt lgkmcnt(14)
  v_mfma_f32_16x16x32_bf16 v[4:7], v[44:47], v[40:43], v[4:7]
  ds_read_b64_tr_b16 v[44:45], v88 offset:256
  ds_read_b64_tr_b16 v[46:47], v88 offset:1408
  s_add_u32 m0, s45, 117760
  s_add_u32 s46, s33, 368640
  buffer_load_dwordx4 v96, s[8:11], s46 offen lds
  s_waitcnt lgkmcnt(14)
  v_mfma_f32_16x16x32_bf16 v[8:11], v[48:51], v[40:43], v[8:11]
  s_add_u32 m0, s45, 121856
  s_add_u32 s46, s33, 368640
  buffer_load_dwordx4 v97, s[8:11], s46 offen lds
  s_waitcnt lgkmcnt(12)
  v_mfma_f32_16x16x32_bf16 v[12:15], v[52:55], v[40:43], v[12:15]
  s_add_u32 m0, s45, 125952
  s_add_u32 s46, s33, 368640
  buffer_load_dwordx4 v98, s[8:11], s46 offen lds
  s_waitcnt lgkmcnt(10)
  v_mfma_f32_16x16x32_bf16 v[16:19], v[56:59], v[40:43], v[16:19]
  s_add_u32 m0, s45, 130048
  s_add_u32 s46, s33, 368640
  buffer_load_dwordx4 v99, s[8:11], s46 offen lds
  s_waitcnt lgkmcnt(8)
  v_mfma_f32_16x16x32_bf16 v[20:23], v[60:63], v[40:43], v[20:23]
  s_cmp_ge_u32 s40, 3
  s_cbranch_scc1 final_kernel_wsk9
  s_add_u32 m0, s45, 134144
  s_add_u32 s46, s33, 368640
  buffer_load_dwordx4 v100, s[8:11], s46 offen lds
  final_kernel_wsk9:
  s_waitcnt lgkmcnt(6)
  v_mfma_f32_16x16x32_bf16 v[24:27], v[64:67], v[40:43], v[24:27]
  s_waitcnt lgkmcnt(4)
  v_mfma_f32_16x16x32_bf16 v[28:31], v[68:71], v[40:43], v[28:31]
  s_waitcnt lgkmcnt(2)
  v_mfma_f32_16x16x32_bf16 v[32:35], v[72:75], v[40:43], v[32:35]
  s_waitcnt lgkmcnt(0)
  v_mfma_f32_16x16x32_bf16 v[36:39], v[44:47], v[40:43], v[36:39]
  s_waitcnt vmcnt(20)
  s_barrier
  ds_read_b64_tr_b16 v[44:45], v89 offset:0
  ds_read_b64_tr_b16 v[46:47], v89 offset:1152
  ds_read_b128 v[40:43], v78 offset:0
  ds_read_b64_tr_b16 v[48:49], v89 offset:32
  ds_read_b64_tr_b16 v[50:51], v89 offset:1184
  ds_read_b64_tr_b16 v[52:53], v89 offset:64
  ds_read_b64_tr_b16 v[54:55], v89 offset:1216
  ds_read_b64_tr_b16 v[56:57], v89 offset:96
  ds_read_b64_tr_b16 v[58:59], v89 offset:1248
  ds_read_b64_tr_b16 v[60:61], v89 offset:128
  ds_read_b64_tr_b16 v[62:63], v89 offset:1280
  ds_read_b64_tr_b16 v[64:65], v89 offset:160
  ds_read_b64_tr_b16 v[66:67], v89 offset:1312
  ds_read_b64_tr_b16 v[68:69], v89 offset:192
  ds_read_b64_tr_b16 v[70:71], v89 offset:1344
  ds_read_b64_tr_b16 v[72:73], v89 offset:224
  ds_read_b64_tr_b16 v[74:75], v89 offset:1376
  s_add_u32 m0, s44, 0
  s_add_u32 s46, s43, 768
  buffer_load_dwordx4 v94, s[4:7], s46 offen lds
  s_waitcnt lgkmcnt(14)
  v_mfma_f32_16x16x32_bf16 v[4:7], v[44:47], v[40:43], v[4:7]
  ds_read_b64_tr_b16 v[44:45], v89 offset:256
  ds_read_b64_tr_b16 v[46:47], v89 offset:1408
  s_add_u32 m0, s45, 0
  s_add_u32 s46, s33, 442368
  buffer_load_dwordx4 v96, s[8:11], s46 offen lds
  s_waitcnt lgkmcnt(14)
  v_mfma_f32_16x16x32_bf16 v[8:11], v[48:51], v[40:43], v[8:11]
  s_add_u32 m0, s45, 4096
  s_add_u32 s46, s33, 442368
  buffer_load_dwordx4 v97, s[8:11], s46 offen lds
  s_waitcnt lgkmcnt(12)
  v_mfma_f32_16x16x32_bf16 v[12:15], v[52:55], v[40:43], v[12:15]
  s_add_u32 m0, s45, 8192
  s_add_u32 s46, s33, 442368
  buffer_load_dwordx4 v98, s[8:11], s46 offen lds
  s_waitcnt lgkmcnt(10)
  v_mfma_f32_16x16x32_bf16 v[16:19], v[56:59], v[40:43], v[16:19]
  s_add_u32 m0, s45, 12288
  s_add_u32 s46, s33, 442368
  buffer_load_dwordx4 v99, s[8:11], s46 offen lds
  s_waitcnt lgkmcnt(8)
  v_mfma_f32_16x16x32_bf16 v[20:23], v[60:63], v[40:43], v[20:23]
  s_cmp_ge_u32 s40, 3
  s_cbranch_scc1 final_kernel_wsk10
  s_add_u32 m0, s45, 16384
  s_add_u32 s46, s33, 442368
  buffer_load_dwordx4 v100, s[8:11], s46 offen lds
  final_kernel_wsk10:
  s_waitcnt lgkmcnt(6)
  v_mfma_f32_16x16x32_bf16 v[24:27], v[64:67], v[40:43], v[24:27]
  s_waitcnt lgkmcnt(4)
  v_mfma_f32_16x16x32_bf16 v[28:31], v[68:71], v[40:43], v[28:31]
  s_waitcnt lgkmcnt(2)
  v_mfma_f32_16x16x32_bf16 v[32:35], v[72:75], v[40:43], v[32:35]
  s_waitcnt lgkmcnt(0)
  v_mfma_f32_16x16x32_bf16 v[36:39], v[44:47], v[40:43], v[36:39]
  s_waitcnt vmcnt(20)
  s_barrier
  ds_read_b64_tr_b16 v[44:45], v90 offset:0
  ds_read_b64_tr_b16 v[46:47], v90 offset:1152
  ds_read_b128 v[40:43], v80 offset:0
  ds_read_b64_tr_b16 v[48:49], v90 offset:32
  ds_read_b64_tr_b16 v[50:51], v90 offset:1184
  ds_read_b64_tr_b16 v[52:53], v90 offset:64
  ds_read_b64_tr_b16 v[54:55], v90 offset:1216
  ds_read_b64_tr_b16 v[56:57], v90 offset:96
  ds_read_b64_tr_b16 v[58:59], v90 offset:1248
  ds_read_b64_tr_b16 v[60:61], v90 offset:128
  ds_read_b64_tr_b16 v[62:63], v90 offset:1280
  ds_read_b64_tr_b16 v[64:65], v90 offset:160
  ds_read_b64_tr_b16 v[66:67], v90 offset:1312
  ds_read_b64_tr_b16 v[68:69], v90 offset:192
  ds_read_b64_tr_b16 v[70:71], v90 offset:1344
  ds_read_b64_tr_b16 v[72:73], v90 offset:224
  ds_read_b64_tr_b16 v[74:75], v90 offset:1376
  s_add_u32 m0, s44, 23552
  s_add_u32 s46, s43, 896
  buffer_load_dwordx4 v94, s[4:7], s46 offen lds
  s_waitcnt lgkmcnt(14)
  v_mfma_f32_16x16x32_bf16 v[4:7], v[44:47], v[40:43], v[4:7]
  ds_read_b64_tr_b16 v[44:45], v90 offset:256
  ds_read_b64_tr_b16 v[46:47], v90 offset:1408
  s_add_u32 m0, s45, 23552
  s_add_u32 s46, s33, 516096
  buffer_load_dwordx4 v96, s[8:11], s46 offen lds
  s_waitcnt lgkmcnt(14)
  v_mfma_f32_16x16x32_bf16 v[8:11], v[48:51], v[40:43], v[8:11]
  s_add_u32 m0, s45, 27648
  s_add_u32 s46, s33, 516096
  buffer_load_dwordx4 v97, s[8:11], s46 offen lds
  s_waitcnt lgkmcnt(12)
  v_mfma_f32_16x16x32_bf16 v[12:15], v[52:55], v[40:43], v[12:15]
  s_add_u32 m0, s45, 31744
  s_add_u32 s46, s33, 516096
  buffer_load_dwordx4 v98, s[8:11], s46 offen lds
  s_waitcnt lgkmcnt(10)
  v_mfma_f32_16x16x32_bf16 v[16:19], v[56:59], v[40:43], v[16:19]
  s_add_u32 m0, s45, 35840
  s_add_u32 s46, s33, 516096
  buffer_load_dwordx4 v99, s[8:11], s46 offen lds
  s_waitcnt lgkmcnt(8)
  v_mfma_f32_16x16x32_bf16 v[20:23], v[60:63], v[40:43], v[20:23]
  s_cmp_ge_u32 s40, 3
  s_cbranch_scc1 final_kernel_wsk11
  s_add_u32 m0, s45, 39936
  s_add_u32 s46, s33, 516096
  buffer_load_dwordx4 v100, s[8:11], s46 offen lds
  final_kernel_wsk11:
  s_waitcnt lgkmcnt(6)
  v_mfma_f32_16x16x32_bf16 v[24:27], v[64:67], v[40:43], v[24:27]
  s_waitcnt lgkmcnt(4)
  v_mfma_f32_16x16x32_bf16 v[28:31], v[68:71], v[40:43], v[28:31]
  s_waitcnt lgkmcnt(2)
  v_mfma_f32_16x16x32_bf16 v[32:35], v[72:75], v[40:43], v[32:35]
  s_waitcnt lgkmcnt(0)
  v_mfma_f32_16x16x32_bf16 v[36:39], v[44:47], v[40:43], v[36:39]
  s_waitcnt vmcnt(20)
  s_barrier
  ds_read_b64_tr_b16 v[44:45], v91 offset:0
  ds_read_b64_tr_b16 v[46:47], v91 offset:1152
  ds_read_b128 v[40:43], v82 offset:0
  ds_read_b64_tr_b16 v[48:49], v91 offset:32
  ds_read_b64_tr_b16 v[50:51], v91 offset:1184
  ds_read_b64_tr_b16 v[52:53], v91 offset:64
  ds_read_b64_tr_b16 v[54:55], v91 offset:1216
  ds_read_b64_tr_b16 v[56:57], v91 offset:96
  ds_read_b64_tr_b16 v[58:59], v91 offset:1248
  ds_read_b64_tr_b16 v[60:61], v91 offset:128
  ds_read_b64_tr_b16 v[62:63], v91 offset:1280
  ds_read_b64_tr_b16 v[64:65], v91 offset:160
  ds_read_b64_tr_b16 v[66:67], v91 offset:1312
  ds_read_b64_tr_b16 v[68:69], v91 offset:192
  ds_read_b64_tr_b16 v[70:71], v91 offset:1344
  ds_read_b64_tr_b16 v[72:73], v91 offset:224
  ds_read_b64_tr_b16 v[74:75], v91 offset:1376
  s_add_u32 m0, s44, 47104
  s_add_u32 s46, s43, 1024
  buffer_load_dwordx4 v94, s[4:7], s46 offen lds
  s_waitcnt lgkmcnt(14)
  v_mfma_f32_16x16x32_bf16 v[4:7], v[44:47], v[40:43], v[4:7]
  ds_read_b64_tr_b16 v[44:45], v91 offset:256
  ds_read_b64_tr_b16 v[46:47], v91 offset:1408
  s_add_u32 m0, s45, 47104
  s_add_u32 s46, s33, 589824
  buffer_load_dwordx4 v96, s[8:11], s46 offen lds
  s_waitcnt lgkmcnt(14)
  v_mfma_f32_16x16x32_bf16 v[8:11], v[48:51], v[40:43], v[8:11]
  s_add_u32 m0, s45, 51200
  s_add_u32 s46, s33, 589824
  buffer_load_dwordx4 v97, s[8:11], s46 offen lds
  s_waitcnt lgkmcnt(12)
  v_mfma_f32_16x16x32_bf16 v[12:15], v[52:55], v[40:43], v[12:15]
  s_add_u32 m0, s45, 55296
  s_add_u32 s46, s33, 589824
  buffer_load_dwordx4 v98, s[8:11], s46 offen lds
  s_waitcnt lgkmcnt(10)
  v_mfma_f32_16x16x32_bf16 v[16:19], v[56:59], v[40:43], v[16:19]
  s_add_u32 m0, s45, 59392
  s_add_u32 s46, s33, 589824
  buffer_load_dwordx4 v99, s[8:11], s46 offen lds
  s_waitcnt lgkmcnt(8)
  v_mfma_f32_16x16x32_bf16 v[20:23], v[60:63], v[40:43], v[20:23]
  s_cmp_ge_u32 s40, 3
  s_cbranch_scc1 final_kernel_wsk12
  s_add_u32 m0, s45, 63488
  s_add_u32 s46, s33, 589824
  buffer_load_dwordx4 v100, s[8:11], s46 offen lds
  final_kernel_wsk12:
  s_waitcnt lgkmcnt(6)
  v_mfma_f32_16x16x32_bf16 v[24:27], v[64:67], v[40:43], v[24:27]
  s_waitcnt lgkmcnt(4)
  v_mfma_f32_16x16x32_bf16 v[28:31], v[68:71], v[40:43], v[28:31]
  s_waitcnt lgkmcnt(2)
  v_mfma_f32_16x16x32_bf16 v[32:35], v[72:75], v[40:43], v[32:35]
  s_waitcnt lgkmcnt(0)
  v_mfma_f32_16x16x32_bf16 v[36:39], v[44:47], v[40:43], v[36:39]
  s_waitcnt vmcnt(20)
  s_barrier
  ds_read_b64_tr_b16 v[44:45], v92 offset:0
  ds_read_b64_tr_b16 v[46:47], v92 offset:1152
  ds_read_b128 v[40:43], v84 offset:0
  ds_read_b64_tr_b16 v[48:49], v92 offset:32
  ds_read_b64_tr_b16 v[50:51], v92 offset:1184
  ds_read_b64_tr_b16 v[52:53], v92 offset:64
  ds_read_b64_tr_b16 v[54:55], v92 offset:1216
  ds_read_b64_tr_b16 v[56:57], v92 offset:96
  ds_read_b64_tr_b16 v[58:59], v92 offset:1248
  ds_read_b64_tr_b16 v[60:61], v92 offset:128
  ds_read_b64_tr_b16 v[62:63], v92 offset:1280
  ds_read_b64_tr_b16 v[64:65], v92 offset:160
  ds_read_b64_tr_b16 v[66:67], v92 offset:1312
  ds_read_b64_tr_b16 v[68:69], v92 offset:192
  ds_read_b64_tr_b16 v[70:71], v92 offset:1344
  ds_read_b64_tr_b16 v[72:73], v92 offset:224
  ds_read_b64_tr_b16 v[74:75], v92 offset:1376
  s_waitcnt lgkmcnt(14)
  v_mfma_f32_16x16x32_bf16 v[4:7], v[44:47], v[40:43], v[4:7]
  ds_read_b64_tr_b16 v[44:45], v92 offset:256
  ds_read_b64_tr_b16 v[46:47], v92 offset:1408
  s_waitcnt lgkmcnt(14)
  v_mfma_f32_16x16x32_bf16 v[8:11], v[48:51], v[40:43], v[8:11]
  s_waitcnt lgkmcnt(12)
  v_mfma_f32_16x16x32_bf16 v[12:15], v[52:55], v[40:43], v[12:15]
  s_waitcnt lgkmcnt(10)
  v_mfma_f32_16x16x32_bf16 v[16:19], v[56:59], v[40:43], v[16:19]
  s_waitcnt lgkmcnt(8)
  v_mfma_f32_16x16x32_bf16 v[20:23], v[60:63], v[40:43], v[20:23]
  s_waitcnt lgkmcnt(6)
  v_mfma_f32_16x16x32_bf16 v[24:27], v[64:67], v[40:43], v[24:27]
  s_waitcnt lgkmcnt(4)
  v_mfma_f32_16x16x32_bf16 v[28:31], v[68:71], v[40:43], v[28:31]
  s_waitcnt lgkmcnt(2)
  v_mfma_f32_16x16x32_bf16 v[32:35], v[72:75], v[40:43], v[32:35]
  s_waitcnt lgkmcnt(0)
  v_mfma_f32_16x16x32_bf16 v[36:39], v[44:47], v[40:43], v[36:39]
  s_waitcnt vmcnt(15)
  s_barrier
  ds_read_b64_tr_b16 v[44:45], v93 offset:0
  ds_read_b64_tr_b16 v[46:47], v93 offset:1152
  ds_read_b128 v[40:43], v86 offset:0
  ds_read_b64_tr_b16 v[48:49], v93 offset:32
  ds_read_b64_tr_b16 v[50:51], v93 offset:1184
  ds_read_b64_tr_b16 v[52:53], v93 offset:64
  ds_read_b64_tr_b16 v[54:55], v93 offset:1216
  ds_read_b64_tr_b16 v[56:57], v93 offset:96
  ds_read_b64_tr_b16 v[58:59], v93 offset:1248
  ds_read_b64_tr_b16 v[60:61], v93 offset:128
  ds_read_b64_tr_b16 v[62:63], v93 offset:1280
  ds_read_b64_tr_b16 v[64:65], v93 offset:160
  ds_read_b64_tr_b16 v[66:67], v93 offset:1312
  ds_read_b64_tr_b16 v[68:69], v93 offset:192
  ds_read_b64_tr_b16 v[70:71], v93 offset:1344
  ds_read_b64_tr_b16 v[72:73], v93 offset:224
  ds_read_b64_tr_b16 v[74:75], v93 offset:1376
  s_waitcnt lgkmcnt(14)
  v_mfma_f32_16x16x32_bf16 v[4:7], v[44:47], v[40:43], v[4:7]
  ds_read_b64_tr_b16 v[44:45], v93 offset:256
  ds_read_b64_tr_b16 v[46:47], v93 offset:1408
  s_waitcnt lgkmcnt(14)
  v_mfma_f32_16x16x32_bf16 v[8:11], v[48:51], v[40:43], v[8:11]
  s_waitcnt lgkmcnt(12)
  v_mfma_f32_16x16x32_bf16 v[12:15], v[52:55], v[40:43], v[12:15]
  s_waitcnt lgkmcnt(10)
  v_mfma_f32_16x16x32_bf16 v[16:19], v[56:59], v[40:43], v[16:19]
  s_waitcnt lgkmcnt(8)
  v_mfma_f32_16x16x32_bf16 v[20:23], v[60:63], v[40:43], v[20:23]
  s_waitcnt lgkmcnt(6)
  v_mfma_f32_16x16x32_bf16 v[24:27], v[64:67], v[40:43], v[24:27]
  s_waitcnt lgkmcnt(4)
  v_mfma_f32_16x16x32_bf16 v[28:31], v[68:71], v[40:43], v[28:31]
  s_waitcnt lgkmcnt(2)
  v_mfma_f32_16x16x32_bf16 v[32:35], v[72:75], v[40:43], v[32:35]
  s_waitcnt lgkmcnt(0)
  v_mfma_f32_16x16x32_bf16 v[36:39], v[44:47], v[40:43], v[36:39]
  s_waitcnt vmcnt(10)
  s_barrier
  ds_read_b64_tr_b16 v[44:45], v88 offset:0
  ds_read_b64_tr_b16 v[46:47], v88 offset:1152
  ds_read_b128 v[40:43], v76 offset:0
  ds_read_b64_tr_b16 v[48:49], v88 offset:32
  ds_read_b64_tr_b16 v[50:51], v88 offset:1184
  ds_read_b64_tr_b16 v[52:53], v88 offset:64
  ds_read_b64_tr_b16 v[54:55], v88 offset:1216
  ds_read_b64_tr_b16 v[56:57], v88 offset:96
  ds_read_b64_tr_b16 v[58:59], v88 offset:1248
  ds_read_b64_tr_b16 v[60:61], v88 offset:128
  ds_read_b64_tr_b16 v[62:63], v88 offset:1280
  ds_read_b64_tr_b16 v[64:65], v88 offset:160
  ds_read_b64_tr_b16 v[66:67], v88 offset:1312
  ds_read_b64_tr_b16 v[68:69], v88 offset:192
  ds_read_b64_tr_b16 v[70:71], v88 offset:1344
  ds_read_b64_tr_b16 v[72:73], v88 offset:224
  ds_read_b64_tr_b16 v[74:75], v88 offset:1376
  s_waitcnt lgkmcnt(14)
  v_mfma_f32_16x16x32_bf16 v[4:7], v[44:47], v[40:43], v[4:7]
  ds_read_b64_tr_b16 v[44:45], v88 offset:256
  ds_read_b64_tr_b16 v[46:47], v88 offset:1408
  s_waitcnt lgkmcnt(14)
  v_mfma_f32_16x16x32_bf16 v[8:11], v[48:51], v[40:43], v[8:11]
  s_waitcnt lgkmcnt(12)
  v_mfma_f32_16x16x32_bf16 v[12:15], v[52:55], v[40:43], v[12:15]
  s_waitcnt lgkmcnt(10)
  v_mfma_f32_16x16x32_bf16 v[16:19], v[56:59], v[40:43], v[16:19]
  s_waitcnt lgkmcnt(8)
  v_mfma_f32_16x16x32_bf16 v[20:23], v[60:63], v[40:43], v[20:23]
  s_waitcnt lgkmcnt(6)
  v_mfma_f32_16x16x32_bf16 v[24:27], v[64:67], v[40:43], v[24:27]
  s_waitcnt lgkmcnt(4)
  v_mfma_f32_16x16x32_bf16 v[28:31], v[68:71], v[40:43], v[28:31]
  s_waitcnt lgkmcnt(2)
  v_mfma_f32_16x16x32_bf16 v[32:35], v[72:75], v[40:43], v[32:35]
  s_waitcnt lgkmcnt(0)
  v_mfma_f32_16x16x32_bf16 v[36:39], v[44:47], v[40:43], v[36:39]
  s_waitcnt vmcnt(5)
  s_barrier
  ds_read_b64_tr_b16 v[44:45], v89 offset:0
  ds_read_b64_tr_b16 v[46:47], v89 offset:1152
  ds_read_b128 v[40:43], v78 offset:0
  ds_read_b64_tr_b16 v[48:49], v89 offset:32
  ds_read_b64_tr_b16 v[50:51], v89 offset:1184
  ds_read_b64_tr_b16 v[52:53], v89 offset:64
  ds_read_b64_tr_b16 v[54:55], v89 offset:1216
  ds_read_b64_tr_b16 v[56:57], v89 offset:96
  ds_read_b64_tr_b16 v[58:59], v89 offset:1248
  ds_read_b64_tr_b16 v[60:61], v89 offset:128
  ds_read_b64_tr_b16 v[62:63], v89 offset:1280
  ds_read_b64_tr_b16 v[64:65], v89 offset:160
  ds_read_b64_tr_b16 v[66:67], v89 offset:1312
  ds_read_b64_tr_b16 v[68:69], v89 offset:192
  ds_read_b64_tr_b16 v[70:71], v89 offset:1344
  ds_read_b64_tr_b16 v[72:73], v89 offset:224
  ds_read_b64_tr_b16 v[74:75], v89 offset:1376
  s_waitcnt lgkmcnt(14)
  v_mfma_f32_16x16x32_bf16 v[4:7], v[44:47], v[40:43], v[4:7]
  ds_read_b64_tr_b16 v[44:45], v89 offset:256
  ds_read_b64_tr_b16 v[46:47], v89 offset:1408
  s_waitcnt lgkmcnt(14)
  v_mfma_f32_16x16x32_bf16 v[8:11], v[48:51], v[40:43], v[8:11]
  s_waitcnt lgkmcnt(12)
  v_mfma_f32_16x16x32_bf16 v[12:15], v[52:55], v[40:43], v[12:15]
  s_waitcnt lgkmcnt(10)
  v_mfma_f32_16x16x32_bf16 v[16:19], v[56:59], v[40:43], v[16:19]
  s_waitcnt lgkmcnt(8)
  v_mfma_f32_16x16x32_bf16 v[20:23], v[60:63], v[40:43], v[20:23]
  s_waitcnt lgkmcnt(6)
  v_mfma_f32_16x16x32_bf16 v[24:27], v[64:67], v[40:43], v[24:27]
  s_waitcnt lgkmcnt(4)
  v_mfma_f32_16x16x32_bf16 v[28:31], v[68:71], v[40:43], v[28:31]
  s_waitcnt lgkmcnt(2)
  v_mfma_f32_16x16x32_bf16 v[32:35], v[72:75], v[40:43], v[32:35]
  s_waitcnt lgkmcnt(0)
  v_mfma_f32_16x16x32_bf16 v[36:39], v[44:47], v[40:43], v[36:39]
  s_waitcnt vmcnt(0)
  s_barrier
  ds_read_b64_tr_b16 v[44:45], v90 offset:0
  ds_read_b64_tr_b16 v[46:47], v90 offset:1152
  ds_read_b128 v[40:43], v80 offset:0
  ds_read_b64_tr_b16 v[48:49], v90 offset:32
  ds_read_b64_tr_b16 v[50:51], v90 offset:1184
  ds_read_b64_tr_b16 v[52:53], v90 offset:64
  ds_read_b64_tr_b16 v[54:55], v90 offset:1216
  ds_read_b64_tr_b16 v[56:57], v90 offset:96
  ds_read_b64_tr_b16 v[58:59], v90 offset:1248
  ds_read_b64_tr_b16 v[60:61], v90 offset:128
  ds_read_b64_tr_b16 v[62:63], v90 offset:1280
  ds_read_b64_tr_b16 v[64:65], v90 offset:160
  ds_read_b64_tr_b16 v[66:67], v90 offset:1312
  ds_read_b64_tr_b16 v[68:69], v90 offset:192
  ds_read_b64_tr_b16 v[70:71], v90 offset:1344
  ds_read_b64_tr_b16 v[72:73], v90 offset:224
  ds_read_b64_tr_b16 v[74:75], v90 offset:1376
  s_waitcnt lgkmcnt(14)
  v_mfma_f32_16x16x32_bf16 v[4:7], v[44:47], v[40:43], v[4:7]
  ds_read_b64_tr_b16 v[44:45], v90 offset:256
  ds_read_b64_tr_b16 v[46:47], v90 offset:1408
  s_waitcnt lgkmcnt(14)
  v_mfma_f32_16x16x32_bf16 v[8:11], v[48:51], v[40:43], v[8:11]
  s_waitcnt lgkmcnt(12)
  v_mfma_f32_16x16x32_bf16 v[12:15], v[52:55], v[40:43], v[12:15]
  s_waitcnt lgkmcnt(10)
  v_mfma_f32_16x16x32_bf16 v[16:19], v[56:59], v[40:43], v[16:19]
  s_waitcnt lgkmcnt(8)
  v_mfma_f32_16x16x32_bf16 v[20:23], v[60:63], v[40:43], v[20:23]
  s_waitcnt lgkmcnt(6)
  v_mfma_f32_16x16x32_bf16 v[24:27], v[64:67], v[40:43], v[24:27]
  s_waitcnt lgkmcnt(4)
  v_mfma_f32_16x16x32_bf16 v[28:31], v[68:71], v[40:43], v[28:31]
  s_waitcnt lgkmcnt(2)
  v_mfma_f32_16x16x32_bf16 v[32:35], v[72:75], v[40:43], v[32:35]
  s_waitcnt lgkmcnt(0)
  v_mfma_f32_16x16x32_bf16 v[36:39], v[44:47], v[40:43], v[36:39]
  s_nop 7
  s_nop 7
  s_barrier
  s_mul_i32 s36, s41, 9216
  v_add_u32 v108, s36, v111
  s_cmp_eq_u32 s42, 0
  s_cbranch_scc1 final_kernel_wk013
  ds_write_b128 v108, v[4:7] offset:0
  ds_write_b128 v108, v[8:11] offset:1024
  ds_write_b128 v108, v[12:15] offset:2048
  ds_write_b128 v108, v[16:19] offset:3072
  ds_write_b128 v108, v[20:23] offset:4096
  ds_write_b128 v108, v[24:27] offset:5120
  ds_write_b128 v108, v[28:31] offset:6144
  ds_write_b128 v108, v[32:35] offset:7168
  ds_write_b128 v108, v[36:39] offset:8192
  s_waitcnt lgkmcnt(0)
  s_barrier
  s_endpgm
final_kernel_wk013:
  s_barrier
  ds_read_b128 v[112:115], v108 offset:0
  ds_read_b128 v[116:119], v108 offset:1024
  ds_read_b128 v[120:123], v108 offset:2048
  ds_read_b128 v[124:127], v108 offset:3072
  ds_read_b128 v[128:131], v108 offset:4096
  ds_read_b128 v[132:135], v108 offset:5120
  ds_read_b128 v[136:139], v108 offset:6144
  ds_read_b128 v[140:143], v108 offset:7168
  ds_read_b128 v[144:147], v108 offset:8192
  s_waitcnt lgkmcnt(8)
  v_add_f32 v4, v4, v112
  v_add_f32 v5, v5, v113
  v_add_f32 v6, v6, v114
  v_add_f32 v7, v7, v115
  v_cvt_pk_bf16_f32 v4, v4, v5
  v_cvt_pk_bf16_f32 v5, v6, v7
  buffer_store_dwordx2 v[4:5], v110, s[24:27], s34 offen offset:0
  s_waitcnt lgkmcnt(7)
  v_add_f32 v8, v8, v116
  v_add_f32 v9, v9, v117
  v_add_f32 v10, v10, v118
  v_add_f32 v11, v11, v119
  v_cvt_pk_bf16_f32 v8, v8, v9
  v_cvt_pk_bf16_f32 v9, v10, v11
  buffer_store_dwordx2 v[8:9], v110, s[24:27], s34 offen offset:32
  s_waitcnt lgkmcnt(6)
  v_add_f32 v12, v12, v120
  v_add_f32 v13, v13, v121
  v_add_f32 v14, v14, v122
  v_add_f32 v15, v15, v123
  v_cvt_pk_bf16_f32 v12, v12, v13
  v_cvt_pk_bf16_f32 v13, v14, v15
  buffer_store_dwordx2 v[12:13], v110, s[24:27], s34 offen offset:64
  s_waitcnt lgkmcnt(5)
  v_add_f32 v16, v16, v124
  v_add_f32 v17, v17, v125
  v_add_f32 v18, v18, v126
  v_add_f32 v19, v19, v127
  v_cvt_pk_bf16_f32 v16, v16, v17
  v_cvt_pk_bf16_f32 v17, v18, v19
  buffer_store_dwordx2 v[16:17], v110, s[24:27], s34 offen offset:96
  s_waitcnt lgkmcnt(4)
  v_add_f32 v20, v20, v128
  v_add_f32 v21, v21, v129
  v_add_f32 v22, v22, v130
  v_add_f32 v23, v23, v131
  v_cvt_pk_bf16_f32 v20, v20, v21
  v_cvt_pk_bf16_f32 v21, v22, v23
  buffer_store_dwordx2 v[20:21], v110, s[24:27], s34 offen offset:128
  s_waitcnt lgkmcnt(3)
  v_add_f32 v24, v24, v132
  v_add_f32 v25, v25, v133
  v_add_f32 v26, v26, v134
  v_add_f32 v27, v27, v135
  v_cvt_pk_bf16_f32 v24, v24, v25
  v_cvt_pk_bf16_f32 v25, v26, v27
  buffer_store_dwordx2 v[24:25], v110, s[24:27], s34 offen offset:160
  s_waitcnt lgkmcnt(2)
  v_add_f32 v28, v28, v136
  v_add_f32 v29, v29, v137
  v_add_f32 v30, v30, v138
  v_add_f32 v31, v31, v139
  v_cvt_pk_bf16_f32 v28, v28, v29
  v_cvt_pk_bf16_f32 v29, v30, v31
  buffer_store_dwordx2 v[28:29], v110, s[24:27], s34 offen offset:192
  s_waitcnt lgkmcnt(1)
  v_add_f32 v32, v32, v140
  v_add_f32 v33, v33, v141
  v_add_f32 v34, v34, v142
  v_add_f32 v35, v35, v143
  v_cvt_pk_bf16_f32 v32, v32, v33
  v_cvt_pk_bf16_f32 v33, v34, v35
  buffer_store_dwordx2 v[32:33], v110, s[24:27], s34 offen offset:224
  s_waitcnt lgkmcnt(0)
  v_add_f32 v36, v36, v144
  v_add_f32 v37, v37, v145
  v_add_f32 v38, v38, v146
  v_add_f32 v39, v39, v147
  v_cvt_pk_bf16_f32 v36, v36, v37
  v_cvt_pk_bf16_f32 v37, v38, v39
  buffer_store_dwordx2 v[36:37], v110, s[24:27], s34 offen offset:256
final_kernel_done1:
  s_endpgm
.section .rodata,"a"
.p2align 6
.amdhsa_kernel ln_kernel
  .amdhsa_next_free_vgpr 80
  .amdhsa_next_free_sgpr 40
  .amdhsa_accum_offset 80
  .amdhsa_group_segment_fixed_size 0
  .amdhsa_kernarg_size 104
  .amdhsa_user_sgpr_count 2
  .amdhsa_user_sgpr_kernarg_segment_ptr 1
  .amdhsa_system_sgpr_workgroup_id_x 1
.end_amdhsa_kernel
.p2align 6
.amdhsa_kernel gemm1_kernel
  .amdhsa_next_free_vgpr 123
  .amdhsa_next_free_sgpr 60
  .amdhsa_accum_offset 124
  .amdhsa_group_segment_fixed_size 0
  .amdhsa_kernarg_size 104
  .amdhsa_user_sgpr_count 2
  .amdhsa_user_sgpr_kernarg_segment_ptr 1
  .amdhsa_system_sgpr_workgroup_id_x 1
.end_amdhsa_kernel
.p2align 6
.amdhsa_kernel gemm2_kernel
  .amdhsa_next_free_vgpr 118
  .amdhsa_next_free_sgpr 72
  .amdhsa_accum_offset 120
  .amdhsa_group_segment_fixed_size 0
  .amdhsa_kernarg_size 104
  .amdhsa_user_sgpr_count 2
  .amdhsa_user_sgpr_kernarg_segment_ptr 1
  .amdhsa_system_sgpr_workgroup_id_x 1
.end_amdhsa_kernel
.p2align 6
.amdhsa_kernel final_kernel
  .amdhsa_next_free_vgpr 184
  .amdhsa_next_free_sgpr 60
  .amdhsa_accum_offset 184
  .amdhsa_group_segment_fixed_size 0
  .amdhsa_kernarg_size 104
  .amdhsa_user_sgpr_count 2
  .amdhsa_user_sgpr_kernarg_segment_ptr 1
  .amdhsa_system_sgpr_workgroup_id_x 1
.end_amdhsa_kernel
```
